```python
import torch

def _softmax(x, axis=-1):
    return torch.softmax(x, dim=axis)
def _gelu(x):
    return torch.nn.functional.gelu(x, approximate="tanh")
def _silu(x):
    return torch.nn.functional.silu(x)
def _sigmoid(x):
    return torch.sigmoid(x)
def _layernorm(x, axis=-1, eps=1e-5):
    m = x.mean(dim=axis, keepdim=True)
    v = x.var(dim=axis, keepdim=True, unbiased=False)
    return (x - m) / torch.sqrt(v + eps)
def _scatter_add(tgt, idx, src, axis=0):
    return tgt.clone().index_add_(axis, idx, src)
def _segment_sum(src, seg, n):
    out = torch.zeros((n,) + src.shape[1:], dtype=src.dtype)
    return out.index_add_(0, seg, src)
def _pad(x, pw):
    flat = tuple(v for pair in reversed(pw) for v in pair)
    return torch.nn.functional.pad(x, flat)

kernel_name = 'recurrent_scan__ssm_conv_h3__geglu_ffn__prompt'

def setup_inputs():

    _w = (lambda a: (lambda t: t.to(torch.bfloat16) if t.is_floating_point() else t)(torch.as_tensor(a)))
    def _A_setup():
        B, S, D = 1, 2048, 1024
        ks = 4
        return {
            "q": _w((lambda *s: torch.randn(*s, dtype=torch.bfloat16) * 0.05)(B, S, D)),
            "k": _w((lambda *s: torch.randn(*s, dtype=torch.bfloat16) * 0.2)(B, S, D)),
            "v": _w((lambda *s: torch.randn(*s, dtype=torch.bfloat16) * 0.2)(B, S, D)),
            "shift_k": _w((lambda *s: torch.randn(*s, dtype=torch.bfloat16) * 0.2)(D, ks) * 0.5),
            "ssm_k": _w((lambda *s: torch.randn(*s, dtype=torch.bfloat16) * 0.2)(D, S) * (1.0 / S ** 0.5)),
            "ssm_D": _w((lambda *s: torch.randn(*s, dtype=torch.bfloat16) * 0.2)(D)),
        }
    _A_in = _A_setup()

    def _B_setup():
        B, S, D, F = 1, 2048, 1024, 3584
        return {
            "x": _w((lambda *s: torch.randn(*s, dtype=torch.bfloat16) * 0.05)(B, S, D)),
            "w_gate": _w((lambda *s: torch.randn(*s, dtype=torch.bfloat16) * 0.1)(D, F)),
            "w_up": _w((lambda *s: torch.randn(*s, dtype=torch.bfloat16) * 0.1)(D, F)),
            "w_down": _w((lambda *s: torch.randn(*s, dtype=torch.bfloat16) * 0.1)(F, D)),
        }
    _B_in = _B_setup()

    return {
        "A_q": _A_in["q"],
        "A_k": _A_in["k"],
        "A_v": _A_in["v"],
        "A_shift_k": _A_in["shift_k"],
        "A_ssm_k": _A_in["ssm_k"],
        "A_ssm_D": _A_in["ssm_D"],
        "B_x": _B_in["x"],
        "B_w_gate": _B_in["w_gate"],
        "B_w_up": _B_in["w_up"],
        "B_w_down": _B_in["w_down"],
    }

def reference(A_q, A_k, A_v, A_shift_k, A_ssm_k, A_ssm_D, B_x, B_w_gate, B_w_up, B_w_down):
    def _A_ref(q, k, v, shift_k, ssm_k, ssm_D):
        B, S, D = q.shape
        ks = shift_k.shape[-1]
        k_pad = _pad(k, ((0, 0), (ks - 1, 0), (0, 0)))
        k_shift = torch.zeros_like(k)
        for t in range(ks):
            k_shift = k_shift + k_pad[:, t:t + S, :] * shift_k[:, ks - 1 - t][None, None, :]
        kv = k_shift * v
        L = 2 * S
        kv_pad = _pad(kv, ((0, 0), (0, S), (0, 0)))
        kf_pad = _pad(ssm_k, ((0, 0), (0, S)))
        kv_f = (lambda x, axes=(-2,-1): torch.fft.rfft2(x.float(), dim=axes))(kv_pad[:, None, :, :], axes=(1, 2))
        kf_f = (lambda x, axes=(-2,-1): torch.fft.rfft2(x.float(), dim=axes))(kf_pad[:, None, :], axes=(1, 2))
        kf_f = (lambda x, *d: x.permute(*d))(kf_f, 1, 2, 0)
        y_f = kv_f * kf_f[None, :, :, :]
        y = (lambda x, s, axes=(-2,-1): torch.fft.irfft2(x, s=s, dim=axes).to(torch.bfloat16))(y_f, (1, L), axes=(1, 2))[:, 0, :S, :]
        y = y + kv * ssm_D[None, None, :]
        return q * y

    def _B_ref(x, w_gate, w_up, w_down):
        return (_gelu(x @ w_gate) * (x @ w_up)) @ w_down

    x = A_q
    xn = _layernorm(x, axis=-1)
    s = _A_ref(xn, A_k, A_v, A_shift_k, A_ssm_k, A_ssm_D)
    g = _silu(_B_ref(xn, B_w_gate, B_w_up, B_w_down))
    return x + s * g
```

```asm
; @launch grid=(256,1,1) block=(512,1,1) lds=163840
.amdgcn_target "amdgcn-amd-amdhsa--gfx950"
.text
.globl recurrent_scan__ssm_conv_h3__geglu_ffn__prompt_kernel
.p2align 8
.type recurrent_scan__ssm_conv_h3__geglu_ffn__prompt_kernel,@function
recurrent_scan__ssm_conv_h3__geglu_ffn__prompt_kernel:
    s_cmp_ge_u32 s2, 256
    s_cbranch_scc1 L_end
    s_load_dwordx2 s[20:21], s[0:1], 56
    s_load_dwordx2 s[24:25], s[0:1], 64
    s_load_dwordx2 s[28:29], s[0:1], 0
    s_load_dwordx2 s[32:33], s[0:1], 96
    s_load_dwordx2 s[36:37], s[0:1], 88
    s_load_dwordx2 s[40:41], s[0:1], 8
    s_load_dwordx2 s[44:45], s[0:1], 16
    s_load_dwordx2 s[48:49], s[0:1], 24
    s_load_dwordx2 s[52:53], s[0:1], 72
    s_load_dwordx2 s[56:57], s[0:1], 32
    s_load_dwordx2 s[60:61], s[0:1], 40
    s_load_dwordx2 s[4:5], s[0:1], 80
    v_lshrrev_b32 v1, 6, v0
    v_and_b32 v2, 63, v0
    v_lshrrev_b32 v3, 4, v2
    v_readfirstlane_b32 s3, v1
    v_and_b32 v4, 15, v2
    s_lshr_b32 s16, s2, 3
    s_bfe_u32 s17, s2, 0x20001
    s_mul_i32 s17, s17, 1792
    s_and_b32 s18, s2, 1
    s_mul_i32 s18, s18, 1024
    s_add_u32 s17, s17, s18
    s_mul_i32 s18, s16, 28672
    s_add_u32 s17, s17, s18
    v_lshrrev_b32 v16, 3, v2
    v_min_u32 v16, 3, v16
    v_mul_u32_u24 v16, 7168, v16
    v_and_b32 v17, 7, v2
    v_lshl_add_u32 v16, v17, 7, v16
    s_lshl_b32 s18, s16, 17
    v_lshlrev_b32 v17, 11, v2
    s_waitcnt lgkmcnt(0)
    s_and_b32 s21, s21, 0xffff
    s_mov_b32 s22, 0x700000
    s_mov_b32 s23, 0x20000
    s_and_b32 s25, s25, 0xffff
    s_mov_b32 s26, 0x700000
    s_mov_b32 s27, 0x20000
    s_and_b32 s29, s29, 0xffff
    s_mov_b32 s30, 0x400000
    s_mov_b32 s31, 0x20000
    s_cmp_lg_u32 s3, 0
    s_cbranch_scc1 L_p0
    buffer_load_dword v34, v17, s[28:31], s18 offen
L_p0:
    s_cmp_lg_u32 s3, 1
    s_cbranch_scc1 L_p1
    buffer_load_dword v34, v16, s[20:23], s17 offen
L_p1:
    s_cmp_lg_u32 s3, 2
    s_cbranch_scc1 L_p2
    buffer_load_dword v34, v16, s[24:27], s17 offen
L_p2:
    s_cmp_lg_u32 s3, 3
    s_cbranch_scc1 L_p3
    buffer_load_dword v34, v17, s[28:31], s18 offen offset:128
L_p3:
    s_mov_b32 s101, s2
    s_bfe_u32 s16, s101, 0x20001
    s_lshr_b32 s17, s101, 3
    s_mul_i32 s18, s16, 56
    s_add_u32 s18, s18, s17
    s_add_u32 s18, s18, 32
    s_add_u32 s19, s18, 24
    s_lshl_b32 s16, s16, 3
    s_add_u32 s16, s16, s17
    s_cmp_lt_u32 s17, 8
    s_cselect_b32 s19, s16, s19
    s_bitcmp1_b32 s101, 0
    s_cselect_b32 s2, s19, s18
    s_cmp_lt_u32 s2, 32
    s_cbranch_scc1 L_helper
L_code0:
    s_sub_u32 s16, s2, 32
    s_and_b32 s17, s16, 7
    s_lshr_b32 s18, s16, 3
    s_and_b32 s14, s16, 7
    s_lshr_b32 s15, s16, 3
    s_lshl_b32 s17, s3, 2
    v_add_u32 v16, s17, v3
    v_mul_u32_u24 v16, 7168, v16
    s_lshr_b32 s18, s3, 1
    s_and_b32 s18, s18, 1
    s_lshl_b32 s18, s18, 2
    v_or_b32 v17, s18, v3
    v_lshlrev_b32 v17, 1, v17
    v_xor_b32 v17, v17, v4
    v_lshl_add_u32 v11, v17, 4, v16
    v_lshrrev_b32 v16, 3, v2
    s_lshl_b32 s18, s3, 3
    v_add_u32 v16, s18, v16
    v_lshlrev_b32 v16, 11, v16
    v_add_u32 v17, s17, v3
    v_and_b32 v17, 7, v17
    v_and_b32 v18, 7, v2
    v_xor_b32 v17, v17, v18
    v_lshl_add_u32 v12, v17, 4, v16
    s_lshl_b32 s64, s15, 8
    s_lshl_b32 s65, s14, 19
    s_lshl_b32 s66, s3, 10
    s_waitcnt lgkmcnt(0)
    s_and_b32 s21, s21, 0xffff
    s_mov_b32 s22, 0x700000
    s_mov_b32 s23, 0x20000
    s_and_b32 s25, s25, 0xffff
    s_mov_b32 s26, 0x700000
    s_mov_b32 s27, 0x20000
    s_and_b32 s29, s29, 0xffff
    s_mov_b32 s30, 0x400000
    s_mov_b32 s31, 0x20000
    s_bitcmp1_b32 s14, 0
    s_cbranch_scc1 L_a1
    s_add_u32 m0, s66, 0
    s_add_u32 s67, s64, 0
    buffer_load_dwordx4 v11, s[20:23], s67 offen  lds
    s_add_u32 m0, s66, 8192
    s_add_u32 s67, s64, 0
    buffer_load_dwordx4 v11, s[24:27], s67 offen  lds
    s_add_u32 s17, s15, 0
    s_and_b32 s17, s17, 3
    s_lshl_b32 s18, s17, 13
    s_add_u32 s18, s18, s66
    s_add_u32 m0, s18, 65536
    s_lshl_b32 s17, s17, 17
    s_add_u32 s67, s65, s17
    buffer_load_dwordx4 v12, s[28:31], s67 offen  lds
    s_add_u32 s17, s15, 1
    s_and_b32 s17, s17, 3
    s_lshl_b32 s18, s17, 13
    s_add_u32 s18, s18, s66
    s_add_u32 m0, s18, 65536
    s_lshl_b32 s17, s17, 17
    s_add_u32 s67, s65, s17
    buffer_load_dwordx4 v12, s[28:31], s67 offen  lds
    s_add_u32 s17, s15, 2
    s_and_b32 s17, s17, 3
    s_lshl_b32 s18, s17, 13
    s_add_u32 s18, s18, s66
    s_add_u32 m0, s18, 65536
    s_lshl_b32 s17, s17, 17
    s_add_u32 s67, s65, s17
    buffer_load_dwordx4 v12, s[28:31], s67 offen  lds
    s_add_u32 s17, s15, 3
    s_and_b32 s17, s17, 3
    s_lshl_b32 s18, s17, 13
    s_add_u32 s18, s18, s66
    s_add_u32 m0, s18, 65536
    s_lshl_b32 s17, s17, 17
    s_add_u32 s67, s65, s17
    buffer_load_dwordx4 v12, s[28:31], s67 offen  lds
    s_branch L_a2
L_a1:
    s_add_u32 s17, s15, 0
    s_and_b32 s17, s17, 3
    s_lshl_b32 s18, s17, 13
    s_add_u32 s18, s18, s66
    s_add_u32 m0, s18, 65536
    s_lshl_b32 s17, s17, 17
    s_add_u32 s67, s65, s17
    buffer_load_dwordx4 v12, s[28:31], s67 offen  lds
    s_add_u32 s17, s15, 1
    s_and_b32 s17, s17, 3
    s_lshl_b32 s18, s17, 13
    s_add_u32 s18, s18, s66
    s_add_u32 m0, s18, 65536
    s_lshl_b32 s17, s17, 17
    s_add_u32 s67, s65, s17
    buffer_load_dwordx4 v12, s[28:31], s67 offen  lds
    s_add_u32 s17, s15, 2
    s_and_b32 s17, s17, 3
    s_lshl_b32 s18, s17, 13
    s_add_u32 s18, s18, s66
    s_add_u32 m0, s18, 65536
    s_lshl_b32 s17, s17, 17
    s_add_u32 s67, s65, s17
    buffer_load_dwordx4 v12, s[28:31], s67 offen  lds
    s_add_u32 s17, s15, 3
    s_and_b32 s17, s17, 3
    s_lshl_b32 s18, s17, 13
    s_add_u32 s18, s18, s66
    s_add_u32 m0, s18, 65536
    s_lshl_b32 s17, s17, 17
    s_add_u32 s67, s65, s17
    buffer_load_dwordx4 v12, s[28:31], s67 offen  lds
    s_add_u32 m0, s66, 8192
    s_add_u32 s67, s64, 0
    buffer_load_dwordx4 v11, s[24:27], s67 offen  lds
    s_add_u32 m0, s66, 0
    s_add_u32 s67, s64, 0
    buffer_load_dwordx4 v11, s[20:23], s67 offen  lds
L_a2:
    s_add_u32 m0, s66, 16384
    s_add_u32 s67, s64, 229376
    buffer_load_dwordx4 v11, s[20:23], s67 offen  lds
    s_add_u32 m0, s66, 24576
    s_add_u32 s67, s64, 229376
    buffer_load_dwordx4 v11, s[24:27], s67 offen  lds
    s_and_b32 s33, s33, 0xffff
    s_mov_b32 s34, 0x10000000
    s_mov_b32 s35, 0x20000
    s_and_b32 s37, s37, 0xffff
    s_mov_b32 s38, 0x100
    s_mov_b32 s39, 0x20000
    s_and_b32 s41, s41, 0xffff
    s_mov_b32 s42, 0x400000
    s_mov_b32 s43, 0x20000
    s_and_b32 s45, s45, 0xffff
    s_mov_b32 s46, 0x400000
    s_mov_b32 s47, 0x20000
    s_and_b32 s49, s49, 0xffff
    s_mov_b32 s50, 0x2000
    s_mov_b32 s51, 0x20000
    s_and_b32 s53, s53, 0xffff
    s_mov_b32 s54, 0x700000
    s_mov_b32 s55, 0x20000
    s_and_b32 s57, s57, 0xffff
    s_mov_b32 s58, 0x400000
    s_mov_b32 s59, 0x20000
    s_and_b32 s61, s61, 0xffff
    s_mov_b32 s62, 0x800
    s_mov_b32 s63, 0x20000
    s_and_b32 s5, s5, 0xffff
    s_mov_b32 s6, 0x400000
    s_mov_b32 s7, 0x20000
    v_lshrrev_b32 v16, 2, v2
    v_and_b32 v16, 3, v16
    v_lshl_add_u32 v17, v3, 3, v16
    v_lshlrev_b32 v17, 8, v17
    v_and_b32 v18, 3, v2
    v_lshl_add_u32 v17, v18, 3, v17
    v_and_b32 v18, 1, v3
    v_lshl_add_u32 v16, v18, 2, v16
    s_and_b32 s17, s3, 3
    s_lshl_b32 s17, s17, 1
    v_xor_b32 v18, s17, v16
    v_lshl_add_u32 v5, v18, 5, v17
    v_xor_b32 v6, 32, v5
    s_lshr_b32 s17, s3, 2
    s_lshl_b32 s17, s17, 14
    s_add_u32 s17, s17, 65536
    v_lshlrev_b32 v16, 7, v4
    v_add_u32 v16, s17, v16
    v_lshrrev_b32 v17, 1, v4
    v_xor_b32 v17, v17, v3
    v_lshl_add_u32 v7, v17, 4, v16
    v_xor_b32 v8, 64, v7
    v_add_u32 v9, 0x10000, v7
    v_add_u32 v10, 0x10000, v8
    v_mov_b32 v128, 0
    v_mov_b32 v129, 0
    v_mov_b32 v130, 0
    v_mov_b32 v131, 0
    v_mov_b32 v132, 0
    v_mov_b32 v133, 0
    v_mov_b32 v134, 0
    v_mov_b32 v135, 0
    v_mov_b32 v136, 0
    v_mov_b32 v137, 0
    v_mov_b32 v138, 0
    v_mov_b32 v139, 0
    v_mov_b32 v140, 0
    v_mov_b32 v141, 0
    v_mov_b32 v142, 0
    v_mov_b32 v143, 0
    v_mov_b32 v144, 0
    v_mov_b32 v145, 0
    v_mov_b32 v146, 0
    v_mov_b32 v147, 0
    v_mov_b32 v148, 0
    v_mov_b32 v149, 0
    v_mov_b32 v150, 0
    v_mov_b32 v151, 0
    v_mov_b32 v152, 0
    v_mov_b32 v153, 0
    v_mov_b32 v154, 0
    v_mov_b32 v155, 0
    v_mov_b32 v156, 0
    v_mov_b32 v157, 0
    v_mov_b32 v158, 0
    v_mov_b32 v159, 0
    v_mov_b32 v160, 0
    v_mov_b32 v161, 0
    v_mov_b32 v162, 0
    v_mov_b32 v163, 0
    v_mov_b32 v164, 0
    v_mov_b32 v165, 0
    v_mov_b32 v166, 0
    v_mov_b32 v167, 0
    v_mov_b32 v168, 0
    v_mov_b32 v169, 0
    v_mov_b32 v170, 0
    v_mov_b32 v171, 0
    v_mov_b32 v172, 0
    v_mov_b32 v173, 0
    v_mov_b32 v174, 0
    v_mov_b32 v175, 0
    v_mov_b32 v176, 0
    v_mov_b32 v177, 0
    v_mov_b32 v178, 0
    v_mov_b32 v179, 0
    v_mov_b32 v180, 0
    v_mov_b32 v181, 0
    v_mov_b32 v182, 0
    v_mov_b32 v183, 0
    v_mov_b32 v184, 0
    v_mov_b32 v185, 0
    v_mov_b32 v186, 0
    v_mov_b32 v187, 0
    v_mov_b32 v188, 0
    v_mov_b32 v189, 0
    v_mov_b32 v190, 0
    v_mov_b32 v191, 0
    v_mov_b32 v192, 0
    v_mov_b32 v193, 0
    v_mov_b32 v194, 0
    v_mov_b32 v195, 0
    v_mov_b32 v196, 0
    v_mov_b32 v197, 0
    v_mov_b32 v198, 0
    v_mov_b32 v199, 0
    v_mov_b32 v200, 0
    v_mov_b32 v201, 0
    v_mov_b32 v202, 0
    v_mov_b32 v203, 0
    v_mov_b32 v204, 0
    v_mov_b32 v205, 0
    v_mov_b32 v206, 0
    v_mov_b32 v207, 0
    v_mov_b32 v208, 0
    v_mov_b32 v209, 0
    v_mov_b32 v210, 0
    v_mov_b32 v211, 0
    v_mov_b32 v212, 0
    v_mov_b32 v213, 0
    v_mov_b32 v214, 0
    v_mov_b32 v215, 0
    v_mov_b32 v216, 0
    v_mov_b32 v217, 0
    v_mov_b32 v218, 0
    v_mov_b32 v219, 0
    v_mov_b32 v220, 0
    v_mov_b32 v221, 0
    v_mov_b32 v222, 0
    v_mov_b32 v223, 0
    v_mov_b32 v224, 0
    v_mov_b32 v225, 0
    v_mov_b32 v226, 0
    v_mov_b32 v227, 0
    v_mov_b32 v228, 0
    v_mov_b32 v229, 0
    v_mov_b32 v230, 0
    v_mov_b32 v231, 0
    v_mov_b32 v232, 0
    v_mov_b32 v233, 0
    v_mov_b32 v234, 0
    v_mov_b32 v235, 0
    v_mov_b32 v236, 0
    v_mov_b32 v237, 0
    v_mov_b32 v238, 0
    v_mov_b32 v239, 0
    v_mov_b32 v240, 0
    v_mov_b32 v241, 0
    v_mov_b32 v242, 0
    v_mov_b32 v243, 0
    v_mov_b32 v244, 0
    v_mov_b32 v245, 0
    v_mov_b32 v246, 0
    v_mov_b32 v247, 0
    v_mov_b32 v248, 0
    v_mov_b32 v249, 0
    v_mov_b32 v250, 0
    v_mov_b32 v251, 0
    v_mov_b32 v252, 0
    v_mov_b32 v253, 0
    v_mov_b32 v254, 0
    v_mov_b32 v255, 0
    v_mov_b32 v48, 0
    v_mov_b32 v49, 0
    v_mov_b32 v50, 0
    v_mov_b32 v51, 0
    v_mov_b32 v52, 0
    v_mov_b32 v53, 0
    v_mov_b32 v54, 0
    v_mov_b32 v55, 0
    v_mov_b32 v56, 0
    v_mov_b32 v57, 0
    v_mov_b32 v58, 0
    v_mov_b32 v59, 0
    v_mov_b32 v60, 0
    v_mov_b32 v61, 0
    v_mov_b32 v62, 0
    v_mov_b32 v63, 0
    v_mov_b32 v16, 0x3f803f80
    v_mov_b32 v17, 0x3f803f80
    v_mov_b32 v18, 0x3f803f80
    v_mov_b32 v19, 0x3f803f80
    s_lshr_b32 s68, s3, 2
    s_lshl_b32 s69, s14, 1
    s_add_u32 s69, s69, s68
    s_lshl_b32 s68, s68, 5
    s_add_u32 s68, s68, s14
    s_add_u32 s68, s68, 16
    s_cmp_eq_u32 s69, 14
    s_cselect_b32 s68, 15, s68
    s_cmp_eq_u32 s69, 15
    s_cselect_b32 s69, 16, s69
    s_waitcnt vmcnt(2)
    s_barrier
    ds_read_b64_tr_b16 v[64:65], v5 offset:0
    ds_read_b64_tr_b16 v[66:67], v5 offset:1024
    ds_read_b64_tr_b16 v[68:69], v6 offset:0
    ds_read_b64_tr_b16 v[70:71], v6 offset:1024
    ds_read_b64_tr_b16 v[72:73], v5 offset:8192
    ds_read_b64_tr_b16 v[74:75], v5 offset:9216
    ds_read_b64_tr_b16 v[76:77], v6 offset:8192
    ds_read_b64_tr_b16 v[78:79], v6 offset:9216
    ds_read_b128 v[96:99], v7 offset:0
    ds_read_b128 v[100:103], v7 offset:2048
    ds_read_b128 v[104:107], v7 offset:4096
    ds_read_b128 v[108:111], v7 offset:6144
    ds_read_b128 v[112:115], v7 offset:8192
    ds_read_b128 v[116:119], v7 offset:10240
    ds_read_b128 v[120:123], v7 offset:12288
    ds_read_b128 v[124:127], v7 offset:14336
    s_add_u32 m0, s66, 32768
    s_add_u32 s67, s64, 458752
    buffer_load_dwordx4 v11, s[20:23], s67 offen  lds
    s_add_u32 m0, s66, 40960
    s_add_u32 s67, s64, 458752
    buffer_load_dwordx4 v11, s[24:27], s67 offen  lds
    s_add_u32 m0, s66, 98304
    s_add_u32 s67, s65, 128
    buffer_load_dwordx4 v12, s[28:31], s67 offen  lds
    s_add_u32 m0, s66, 106496
    s_add_u32 s67, s65, 131200
    buffer_load_dwordx4 v12, s[28:31], s67 offen  lds
    s_add_u32 m0, s66, 114688
    s_add_u32 s67, s65, 262272
    buffer_load_dwordx4 v12, s[28:31], s67 offen  lds
    s_add_u32 m0, s66, 122880
    s_add_u32 s67, s65, 393344
    buffer_load_dwordx4 v12, s[28:31], s67 offen  lds
    s_waitcnt lgkmcnt(7)
    v_mfma_f32_16x16x32_bf16 v[128:131], v[64:67], v[96:99], v[128:131]
    v_mfma_f32_16x16x32_bf16 v[132:135], v[68:71], v[96:99], v[132:135]
    v_mfma_f32_16x16x32_bf16 v[136:139], v[72:75], v[96:99], v[136:139]
    v_mfma_f32_16x16x32_bf16 v[140:143], v[76:79], v[96:99], v[140:143]
    s_waitcnt vmcnt(6) lgkmcnt(0)
    s_barrier
    v_mfma_f32_16x16x32_bf16 v[156:159], v[76:79], v[100:103], v[156:159]
    ds_read_b128 v[96:99], v8 offset:0
    s_add_u32 m0, s66, 49152
    v_mfma_f32_16x16x32_bf16 v[152:155], v[72:75], v[100:103], v[152:155]
    s_add_u32 s67, s64, 688128
    v_mfma_f32_16x16x32_bf16 v[148:151], v[68:71], v[100:103], v[148:151]
    ds_read_b64_tr_b16 v[80:81], v5 offset:16384
    buffer_load_dwordx4 v11, s[20:23], s67 offen  lds
    v_mfma_f32_16x16x32_bf16 v[144:147], v[64:67], v[100:103], v[144:147]
    s_add_u32 m0, s66, 57344
    ds_read_b128 v[100:103], v8 offset:2048
    v_mfma_f32_16x16x32_bf16 v[160:163], v[64:67], v[104:107], v[160:163]
    ds_read_b64_tr_b16 v[82:83], v5 offset:17408
    s_add_u32 s67, s64, 688128
    v_mfma_f32_16x16x32_bf16 v[164:167], v[68:71], v[104:107], v[164:167]
    buffer_load_dwordx4 v11, s[24:27], s67 offen  lds
    v_mfma_f32_16x16x32_bf16 v[168:171], v[72:75], v[104:107], v[168:171]
    ds_read_b64_tr_b16 v[84:85], v6 offset:16384
    s_add_u32 m0, s66, 131072
    v_mfma_f32_16x16x32_bf16 v[172:175], v[76:79], v[104:107], v[172:175]
    s_add_u32 s67, s65, 256
    ds_read_b128 v[104:107], v8 offset:4096
    v_mfma_f32_16x16x32_bf16 v[188:191], v[76:79], v[108:111], v[188:191]
    ds_read_b64_tr_b16 v[86:87], v6 offset:17408
    buffer_load_dwordx4 v12, s[28:31], s67 offen  lds
    v_mfma_f32_16x16x32_bf16 v[184:187], v[72:75], v[108:111], v[184:187]
    s_add_u32 m0, s66, 139264
    v_mfma_f32_16x16x32_bf16 v[180:183], v[68:71], v[108:111], v[180:183]
    ds_read_b64_tr_b16 v[88:89], v5 offset:24576
    s_add_u32 s67, s65, 131328
    v_mfma_f32_16x16x32_bf16 v[176:179], v[64:67], v[108:111], v[176:179]
    buffer_load_dwordx4 v12, s[28:31], s67 offen  lds
    ds_read_b128 v[108:111], v8 offset:6144
    v_mfma_f32_16x16x32_bf16 v[192:195], v[64:67], v[112:115], v[192:195]
    ds_read_b64_tr_b16 v[90:91], v5 offset:25600
    s_add_u32 m0, s66, 0
    v_mfma_f32_16x16x32_bf16 v[196:199], v[68:71], v[112:115], v[196:199]
    v_mfma_f32_16x16x32_bf16 v[200:203], v[72:75], v[112:115], v[200:203]
    ds_read_b64_tr_b16 v[92:93], v6 offset:24576
    s_add_u32 s67, s64, 917504
    v_mfma_f32_16x16x32_bf16 v[204:207], v[76:79], v[112:115], v[204:207]
    buffer_load_dwordx4 v11, s[20:23], s67 offen  lds
    ds_read_b128 v[112:115], v8 offset:8192
    v_mfma_f32_16x16x32_bf16 v[220:223], v[76:79], v[116:119], v[220:223]
    ds_read_b64_tr_b16 v[94:95], v6 offset:25600
    s_add_u32 m0, s66, 8192
    v_mfma_f32_16x16x32_bf16 v[216:219], v[72:75], v[116:119], v[216:219]
    s_add_u32 s67, s64, 917504
    v_mfma_f32_16x16x32_bf16 v[212:215], v[68:71], v[116:119], v[212:215]
    buffer_load_dwordx4 v11, s[24:27], s67 offen  lds
    v_mfma_f32_16x16x32_bf16 v[208:211], v[64:67], v[116:119], v[208:211]
    s_add_u32 m0, s66, 147456
    ds_read_b128 v[116:119], v8 offset:10240
    v_mfma_f32_16x16x32_bf16 v[224:227], v[64:67], v[120:123], v[224:227]
    s_add_u32 s67, s65, 262400
    v_mfma_f32_16x16x32_bf16 v[228:231], v[68:71], v[120:123], v[228:231]
    buffer_load_dwordx4 v12, s[28:31], s67 offen  lds
    v_mfma_f32_16x16x32_bf16 v[232:235], v[72:75], v[120:123], v[232:235]
    s_add_u32 m0, s66, 155648
    v_mfma_f32_16x16x32_bf16 v[236:239], v[76:79], v[120:123], v[236:239]
    s_add_u32 s67, s65, 393472
    ds_read_b128 v[120:123], v8 offset:12288
    v_mfma_f32_16x16x32_bf16 v[252:255], v[76:79], v[124:127], v[252:255]
    buffer_load_dwordx4 v12, s[28:31], s67 offen  lds
    v_mfma_f32_16x16x32_bf16 v[248:251], v[72:75], v[124:127], v[248:251]
    s_cmp_eq_u32 s69, 0
    s_cbranch_scc1 L_y0
L_x0:
    v_mfma_f32_16x16x32_bf16 v[244:247], v[68:71], v[124:127], v[244:247]
    v_mfma_f32_16x16x32_bf16 v[240:243], v[64:67], v[124:127], v[240:243]
    ds_read_b128 v[124:127], v8 offset:14336
    s_waitcnt lgkmcnt(3)
    v_mfma_f32_16x16x32_bf16 v[128:131], v[80:83], v[96:99], v[128:131]
    v_mfma_f32_16x16x32_bf16 v[132:135], v[84:87], v[96:99], v[132:135]
    v_mfma_f32_16x16x32_bf16 v[136:139], v[88:91], v[96:99], v[136:139]
    v_mfma_f32_16x16x32_bf16 v[140:143], v[92:95], v[96:99], v[140:143]
    s_waitcnt vmcnt(8) lgkmcnt(0)
    s_barrier
    v_mfma_f32_16x16x32_bf16 v[156:159], v[92:95], v[100:103], v[156:159]
    ds_read_b128 v[96:99], v7 offset:32768
    s_add_u32 m0, s66, 16384
    v_mfma_f32_16x16x32_bf16 v[152:155], v[88:91], v[100:103], v[152:155]
    v_mfma_f32_16x16x32_bf16 v[148:151], v[84:87], v[100:103], v[148:151]
    ds_read_b64_tr_b16 v[64:65], v5 offset:32768
    s_add_u32 s67, s64, 1146880
    v_mfma_f32_16x16x32_bf16 v[144:147], v[80:83], v[100:103], v[144:147]
    ds_read_b128 v[100:103], v7 offset:34816
    v_mfma_f32_16x16x32_bf16 v[160:163], v[80:83], v[104:107], v[160:163]
    ds_read_b64_tr_b16 v[66:67], v5 offset:33792
    buffer_load_dwordx4 v11, s[20:23], s67 offen  lds
    v_mfma_f32_16x16x32_bf16 v[164:167], v[84:87], v[104:107], v[164:167]
    v_mfma_f32_16x16x32_bf16 v[168:171], v[88:91], v[104:107], v[168:171]
    ds_read_b64_tr_b16 v[68:69], v6 offset:32768
    s_add_u32 m0, s66, 24576
    v_mfma_f32_16x16x32_bf16 v[172:175], v[92:95], v[104:107], v[172:175]
    ds_read_b128 v[104:107], v7 offset:36864
    v_mfma_f32_16x16x32_bf16 v[188:191], v[92:95], v[108:111], v[188:191]
    ds_read_b64_tr_b16 v[70:71], v6 offset:33792
    s_add_u32 s67, s64, 1146880
    v_mfma_f32_16x16x32_bf16 v[184:187], v[88:91], v[108:111], v[184:187]
    v_mfma_f32_16x16x32_bf16 v[180:183], v[84:87], v[108:111], v[180:183]
    ds_read_b64_tr_b16 v[72:73], v5 offset:40960
    buffer_load_dwordx4 v11, s[24:27], s67 offen  lds
    v_mfma_f32_16x16x32_bf16 v[176:179], v[80:83], v[108:111], v[176:179]
    ds_read_b128 v[108:111], v7 offset:38912
    v_mfma_f32_16x16x32_bf16 v[192:195], v[80:83], v[112:115], v[192:195]
    ds_read_b64_tr_b16 v[74:75], v5 offset:41984
    s_add_u32 m0, s66, 65536
    v_mfma_f32_16x16x32_bf16 v[196:199], v[84:87], v[112:115], v[196:199]
    v_mfma_f32_16x16x32_bf16 v[200:203], v[88:91], v[112:115], v[200:203]
    ds_read_b64_tr_b16 v[76:77], v6 offset:40960
    s_add_u32 s67, s65, 384
    v_mfma_f32_16x16x32_bf16 v[204:207], v[92:95], v[112:115], v[204:207]
    ds_read_b128 v[112:115], v7 offset:40960
    v_mfma_f32_16x16x32_bf16 v[220:223], v[92:95], v[116:119], v[220:223]
    ds_read_b64_tr_b16 v[78:79], v6 offset:41984
    buffer_load_dwordx4 v12, s[28:31], s67 offen  lds
    v_mfma_f32_16x16x32_bf16 v[216:219], v[88:91], v[116:119], v[216:219]
    v_mfma_f32_16x16x32_bf16 v[212:215], v[84:87], v[116:119], v[212:215]
    s_add_u32 m0, s66, 73728
    v_mfma_f32_16x16x32_bf16 v[208:211], v[80:83], v[116:119], v[208:211]
    ds_read_b128 v[116:119], v7 offset:43008
    v_mfma_f32_16x16x32_bf16 v[224:227], v[80:83], v[120:123], v[224:227]
    s_add_u32 s67, s65, 131456
    v_mfma_f32_16x16x32_bf16 v[228:231], v[84:87], v[120:123], v[228:231]
    v_mfma_f32_16x16x32_bf16 v[232:235], v[88:91], v[120:123], v[232:235]
    buffer_load_dwordx4 v12, s[28:31], s67 offen  lds
    v_mfma_f32_16x16x32_bf16 v[236:239], v[92:95], v[120:123], v[236:239]
    ds_read_b128 v[120:123], v7 offset:45056
    v_mfma_f32_16x16x32_bf16 v[252:255], v[92:95], v[124:127], v[252:255]
    s_cmp_eq_u32 s69, 1
    s_cbranch_scc1 L_y1
L_x1:
    v_mfma_f32_16x16x32_bf16 v[248:251], v[88:91], v[124:127], v[248:251]
    v_mfma_f32_16x16x32_bf16 v[244:247], v[84:87], v[124:127], v[244:247]
    v_mfma_f32_16x16x32_bf16 v[240:243], v[80:83], v[124:127], v[240:243]
    ds_read_b128 v[124:127], v7 offset:47104
    s_waitcnt lgkmcnt(3)
    v_mfma_f32_16x16x32_bf16 v[128:131], v[64:67], v[96:99], v[128:131]
    v_mfma_f32_16x16x32_bf16 v[132:135], v[68:71], v[96:99], v[132:135]
    v_mfma_f32_16x16x32_bf16 v[136:139], v[72:75], v[96:99], v[136:139]
    v_mfma_f32_16x16x32_bf16 v[140:143], v[76:79], v[96:99], v[140:143]
    s_waitcnt vmcnt(10) lgkmcnt(0)
    s_barrier
    v_mfma_f32_16x16x32_bf16 v[156:159], v[76:79], v[100:103], v[156:159]
    ds_read_b128 v[96:99], v8 offset:32768
    s_add_u32 m0, s66, 32768
    v_mfma_f32_16x16x32_bf16 v[152:155], v[72:75], v[100:103], v[152:155]
    v_mfma_f32_16x16x32_bf16 v[148:151], v[68:71], v[100:103], v[148:151]
    ds_read_b64_tr_b16 v[80:81], v5 offset:49152
    s_add_u32 s67, s64, 1376256
    v_mfma_f32_16x16x32_bf16 v[144:147], v[64:67], v[100:103], v[144:147]
    ds_read_b128 v[100:103], v8 offset:34816
    v_mfma_f32_16x16x32_bf16 v[160:163], v[64:67], v[104:107], v[160:163]
    ds_read_b64_tr_b16 v[82:83], v5 offset:50176
    buffer_load_dwordx4 v11, s[20:23], s67 offen  lds
    v_mfma_f32_16x16x32_bf16 v[164:167], v[68:71], v[104:107], v[164:167]
    v_mfma_f32_16x16x32_bf16 v[168:171], v[72:75], v[104:107], v[168:171]
    ds_read_b64_tr_b16 v[84:85], v6 offset:49152
    s_add_u32 m0, s66, 40960
    v_mfma_f32_16x16x32_bf16 v[172:175], v[76:79], v[104:107], v[172:175]
    ds_read_b128 v[104:107], v8 offset:36864
    v_mfma_f32_16x16x32_bf16 v[188:191], v[76:79], v[108:111], v[188:191]
    ds_read_b64_tr_b16 v[86:87], v6 offset:50176
    s_add_u32 s67, s64, 1376256
    v_mfma_f32_16x16x32_bf16 v[184:187], v[72:75], v[108:111], v[184:187]
    v_mfma_f32_16x16x32_bf16 v[180:183], v[68:71], v[108:111], v[180:183]
    ds_read_b64_tr_b16 v[88:89], v5 offset:57344
    buffer_load_dwordx4 v11, s[24:27], s67 offen  lds
    v_mfma_f32_16x16x32_bf16 v[176:179], v[64:67], v[108:111], v[176:179]
    ds_read_b128 v[108:111], v8 offset:38912
    v_mfma_f32_16x16x32_bf16 v[192:195], v[64:67], v[112:115], v[192:195]
    ds_read_b64_tr_b16 v[90:91], v5 offset:58368
    s_add_u32 m0, s66, 81920
    v_mfma_f32_16x16x32_bf16 v[196:199], v[68:71], v[112:115], v[196:199]
    v_mfma_f32_16x16x32_bf16 v[200:203], v[72:75], v[112:115], v[200:203]
    ds_read_b64_tr_b16 v[92:93], v6 offset:57344
    s_add_u32 s67, s65, 262528
    v_mfma_f32_16x16x32_bf16 v[204:207], v[76:79], v[112:115], v[204:207]
    ds_read_b128 v[112:115], v8 offset:40960
    v_mfma_f32_16x16x32_bf16 v[220:223], v[76:79], v[116:119], v[220:223]
    ds_read_b64_tr_b16 v[94:95], v6 offset:58368
    buffer_load_dwordx4 v12, s[28:31], s67 offen  lds
    v_mfma_f32_16x16x32_bf16 v[216:219], v[72:75], v[116:119], v[216:219]
    v_mfma_f32_16x16x32_bf16 v[212:215], v[68:71], v[116:119], v[212:215]
    s_add_u32 m0, s66, 90112
    v_mfma_f32_16x16x32_bf16 v[208:211], v[64:67], v[116:119], v[208:211]
    ds_read_b128 v[116:119], v8 offset:43008
    v_mfma_f32_16x16x32_bf16 v[224:227], v[64:67], v[120:123], v[224:227]
    s_add_u32 s67, s65, 393600
    v_mfma_f32_16x16x32_bf16 v[228:231], v[68:71], v[120:123], v[228:231]
    v_mfma_f32_16x16x32_bf16 v[232:235], v[72:75], v[120:123], v[232:235]
    buffer_load_dwordx4 v12, s[28:31], s67 offen  lds
    v_mfma_f32_16x16x32_bf16 v[236:239], v[76:79], v[120:123], v[236:239]
    ds_read_b128 v[120:123], v8 offset:45056
    v_mfma_f32_16x16x32_bf16 v[252:255], v[76:79], v[124:127], v[252:255]
    s_cmp_eq_u32 s69, 2
    s_cbranch_scc1 L_y2
L_x2:
    v_mfma_f32_16x16x32_bf16 v[248:251], v[72:75], v[124:127], v[248:251]
    v_mfma_f32_16x16x32_bf16 v[244:247], v[68:71], v[124:127], v[244:247]
    v_mfma_f32_16x16x32_bf16 v[240:243], v[64:67], v[124:127], v[240:243]
    ds_read_b128 v[124:127], v8 offset:47104
    s_waitcnt lgkmcnt(3)
    v_mfma_f32_16x16x32_bf16 v[128:131], v[80:83], v[96:99], v[128:131]
    v_mfma_f32_16x16x32_bf16 v[132:135], v[84:87], v[96:99], v[132:135]
    v_mfma_f32_16x16x32_bf16 v[136:139], v[88:91], v[96:99], v[136:139]
    v_mfma_f32_16x16x32_bf16 v[140:143], v[92:95], v[96:99], v[140:143]
    s_waitcnt vmcnt(8) lgkmcnt(0)
    s_barrier
    v_mfma_f32_16x16x32_bf16 v[156:159], v[92:95], v[100:103], v[156:159]
    ds_read_b128 v[96:99], v9 offset:0
    s_add_u32 m0, s66, 49152
    v_mfma_f32_16x16x32_bf16 v[152:155], v[88:91], v[100:103], v[152:155]
    v_mfma_f32_16x16x32_bf16 v[148:151], v[84:87], v[100:103], v[148:151]
    ds_read_b64_tr_b16 v[64:65], v5 offset:0
    s_add_u32 s67, s64, 1605632
    v_mfma_f32_16x16x32_bf16 v[144:147], v[80:83], v[100:103], v[144:147]
    ds_read_b128 v[100:103], v9 offset:2048
    v_mfma_f32_16x16x32_bf16 v[160:163], v[80:83], v[104:107], v[160:163]
    ds_read_b64_tr_b16 v[66:67], v5 offset:1024
    buffer_load_dwordx4 v11, s[20:23], s67 offen  lds
    v_mfma_f32_16x16x32_bf16 v[164:167], v[84:87], v[104:107], v[164:167]
    v_mfma_f32_16x16x32_bf16 v[168:171], v[88:91], v[104:107], v[168:171]
    ds_read_b64_tr_b16 v[68:69], v6 offset:0
    s_add_u32 m0, s66, 57344
    v_mfma_f32_16x16x32_bf16 v[172:175], v[92:95], v[104:107], v[172:175]
    ds_read_b128 v[104:107], v9 offset:4096
    v_mfma_f32_16x16x32_bf16 v[188:191], v[92:95], v[108:111], v[188:191]
    ds_read_b64_tr_b16 v[70:71], v6 offset:1024
    s_add_u32 s67, s64, 1605632
    v_mfma_f32_16x16x32_bf16 v[184:187], v[88:91], v[108:111], v[184:187]
    v_mfma_f32_16x16x32_bf16 v[180:183], v[84:87], v[108:111], v[180:183]
    ds_read_b64_tr_b16 v[72:73], v5 offset:8192
    buffer_load_dwordx4 v11, s[24:27], s67 offen  lds
    v_mfma_f32_16x16x32_bf16 v[176:179], v[80:83], v[108:111], v[176:179]
    ds_read_b128 v[108:111], v9 offset:6144
    v_mfma_f32_16x16x32_bf16 v[192:195], v[80:83], v[112:115], v[192:195]
    ds_read_b64_tr_b16 v[74:75], v5 offset:9216
    s_add_u32 m0, s66, 98304
    v_mfma_f32_16x16x32_bf16 v[196:199], v[84:87], v[112:115], v[196:199]
    v_mfma_f32_16x16x32_bf16 v[200:203], v[88:91], v[112:115], v[200:203]
    ds_read_b64_tr_b16 v[76:77], v6 offset:8192
    s_add_u32 s67, s65, 512
    v_mfma_f32_16x16x32_bf16 v[204:207], v[92:95], v[112:115], v[204:207]
    ds_read_b128 v[112:115], v9 offset:8192
    v_mfma_f32_16x16x32_bf16 v[220:223], v[92:95], v[116:119], v[220:223]
    ds_read_b64_tr_b16 v[78:79], v6 offset:9216
    buffer_load_dwordx4 v12, s[28:31], s67 offen  lds
    v_mfma_f32_16x16x32_bf16 v[216:219], v[88:91], v[116:119], v[216:219]
    v_mfma_f32_16x16x32_bf16 v[212:215], v[84:87], v[116:119], v[212:215]
    s_add_u32 m0, s66, 106496
    v_mfma_f32_16x16x32_bf16 v[208:211], v[80:83], v[116:119], v[208:211]
    ds_read_b128 v[116:119], v9 offset:10240
    v_mfma_f32_16x16x32_bf16 v[224:227], v[80:83], v[120:123], v[224:227]
    s_add_u32 s67, s65, 131584
    v_mfma_f32_16x16x32_bf16 v[228:231], v[84:87], v[120:123], v[228:231]
    v_mfma_f32_16x16x32_bf16 v[232:235], v[88:91], v[120:123], v[232:235]
    buffer_load_dwordx4 v12, s[28:31], s67 offen  lds
    v_mfma_f32_16x16x32_bf16 v[236:239], v[92:95], v[120:123], v[236:239]
    ds_read_b128 v[120:123], v9 offset:12288
    v_mfma_f32_16x16x32_bf16 v[252:255], v[92:95], v[124:127], v[252:255]
    s_cmp_eq_u32 s69, 3
    s_cbranch_scc1 L_y3
L_x3:
    v_mfma_f32_16x16x32_bf16 v[248:251], v[88:91], v[124:127], v[248:251]
    v_mfma_f32_16x16x32_bf16 v[244:247], v[84:87], v[124:127], v[244:247]
    v_mfma_f32_16x16x32_bf16 v[240:243], v[80:83], v[124:127], v[240:243]
    ds_read_b128 v[124:127], v9 offset:14336
    s_waitcnt lgkmcnt(3)
    v_mfma_f32_16x16x32_bf16 v[128:131], v[64:67], v[96:99], v[128:131]
    v_mfma_f32_16x16x32_bf16 v[132:135], v[68:71], v[96:99], v[132:135]
    v_mfma_f32_16x16x32_bf16 v[136:139], v[72:75], v[96:99], v[136:139]
    v_mfma_f32_16x16x32_bf16 v[140:143], v[76:79], v[96:99], v[140:143]
    s_waitcnt vmcnt(10) lgkmcnt(0)
    s_barrier
    v_mfma_f32_16x16x32_bf16 v[156:159], v[76:79], v[100:103], v[156:159]
    ds_read_b128 v[96:99], v10 offset:0
    s_add_u32 m0, s66, 0
    v_mfma_f32_16x16x32_bf16 v[152:155], v[72:75], v[100:103], v[152:155]
    v_mfma_f32_16x16x32_bf16 v[148:151], v[68:71], v[100:103], v[148:151]
    ds_read_b64_tr_b16 v[80:81], v5 offset:16384
    s_add_u32 s67, s64, 1835008
    v_mfma_f32_16x16x32_bf16 v[144:147], v[64:67], v[100:103], v[144:147]
    ds_read_b128 v[100:103], v10 offset:2048
    v_mfma_f32_16x16x32_bf16 v[160:163], v[64:67], v[104:107], v[160:163]
    ds_read_b64_tr_b16 v[82:83], v5 offset:17408
    buffer_load_dwordx4 v11, s[20:23], s67 offen  lds
    v_mfma_f32_16x16x32_bf16 v[164:167], v[68:71], v[104:107], v[164:167]
    v_mfma_f32_16x16x32_bf16 v[168:171], v[72:75], v[104:107], v[168:171]
    ds_read_b64_tr_b16 v[84:85], v6 offset:16384
    s_add_u32 m0, s66, 8192
    v_mfma_f32_16x16x32_bf16 v[172:175], v[76:79], v[104:107], v[172:175]
    ds_read_b128 v[104:107], v10 offset:4096
    v_mfma_f32_16x16x32_bf16 v[188:191], v[76:79], v[108:111], v[188:191]
    ds_read_b64_tr_b16 v[86:87], v6 offset:17408
    s_add_u32 s67, s64, 1835008
    v_mfma_f32_16x16x32_bf16 v[184:187], v[72:75], v[108:111], v[184:187]
    v_mfma_f32_16x16x32_bf16 v[180:183], v[68:71], v[108:111], v[180:183]
    ds_read_b64_tr_b16 v[88:89], v5 offset:24576
    buffer_load_dwordx4 v11, s[24:27], s67 offen  lds
    v_mfma_f32_16x16x32_bf16 v[176:179], v[64:67], v[108:111], v[176:179]
    ds_read_b128 v[108:111], v10 offset:6144
    v_mfma_f32_16x16x32_bf16 v[192:195], v[64:67], v[112:115], v[192:195]
    ds_read_b64_tr_b16 v[90:91], v5 offset:25600
    s_add_u32 m0, s66, 114688
    v_mfma_f32_16x16x32_bf16 v[196:199], v[68:71], v[112:115], v[196:199]
    v_mfma_f32_16x16x32_bf16 v[200:203], v[72:75], v[112:115], v[200:203]
    ds_read_b64_tr_b16 v[92:93], v6 offset:24576
    s_add_u32 s67, s65, 262656
    v_mfma_f32_16x16x32_bf16 v[204:207], v[76:79], v[112:115], v[204:207]
    ds_read_b128 v[112:115], v10 offset:8192
    v_mfma_f32_16x16x32_bf16 v[220:223], v[76:79], v[116:119], v[220:223]
    ds_read_b64_tr_b16 v[94:95], v6 offset:25600
    buffer_load_dwordx4 v12, s[28:31], s67 offen  lds
    v_mfma_f32_16x16x32_bf16 v[216:219], v[72:75], v[116:119], v[216:219]
    v_mfma_f32_16x16x32_bf16 v[212:215], v[68:71], v[116:119], v[212:215]
    s_add_u32 m0, s66, 122880
    v_mfma_f32_16x16x32_bf16 v[208:211], v[64:67], v[116:119], v[208:211]
    ds_read_b128 v[116:119], v10 offset:10240
    v_mfma_f32_16x16x32_bf16 v[224:227], v[64:67], v[120:123], v[224:227]
    s_add_u32 s67, s65, 393728
    v_mfma_f32_16x16x32_bf16 v[228:231], v[68:71], v[120:123], v[228:231]
    v_mfma_f32_16x16x32_bf16 v[232:235], v[72:75], v[120:123], v[232:235]
    buffer_load_dwordx4 v12, s[28:31], s67 offen  lds
    v_mfma_f32_16x16x32_bf16 v[236:239], v[76:79], v[120:123], v[236:239]
    ds_read_b128 v[120:123], v10 offset:12288
    v_mfma_f32_16x16x32_bf16 v[252:255], v[76:79], v[124:127], v[252:255]
    s_cmp_eq_u32 s69, 4
    s_cbranch_scc1 L_y4
L_x4:
    v_mfma_f32_16x16x32_bf16 v[248:251], v[72:75], v[124:127], v[248:251]
    v_mfma_f32_16x16x32_bf16 v[244:247], v[68:71], v[124:127], v[244:247]
    v_mfma_f32_16x16x32_bf16 v[240:243], v[64:67], v[124:127], v[240:243]
    ds_read_b128 v[124:127], v10 offset:14336
    s_waitcnt lgkmcnt(3)
    v_mfma_f32_16x16x32_bf16 v[128:131], v[80:83], v[96:99], v[128:131]
    v_mfma_f32_16x16x32_bf16 v[132:135], v[84:87], v[96:99], v[132:135]
    v_mfma_f32_16x16x32_bf16 v[136:139], v[88:91], v[96:99], v[136:139]
    v_mfma_f32_16x16x32_bf16 v[140:143], v[92:95], v[96:99], v[140:143]
    s_waitcnt vmcnt(8) lgkmcnt(0)
    s_barrier
    v_mfma_f32_16x16x32_bf16 v[156:159], v[92:95], v[100:103], v[156:159]
    ds_read_b128 v[96:99], v7 offset:0
    s_add_u32 m0, s66, 16384
    v_mfma_f32_16x16x32_bf16 v[152:155], v[88:91], v[100:103], v[152:155]
    v_mfma_f32_16x16x32_bf16 v[148:151], v[84:87], v[100:103], v[148:151]
    ds_read_b64_tr_b16 v[64:65], v5 offset:32768
    s_add_u32 s67, s64, 2064384
    v_mfma_f32_16x16x32_bf16 v[144:147], v[80:83], v[100:103], v[144:147]
    ds_read_b128 v[100:103], v7 offset:2048
    v_mfma_f32_16x16x32_bf16 v[160:163], v[80:83], v[104:107], v[160:163]
    ds_read_b64_tr_b16 v[66:67], v5 offset:33792
    buffer_load_dwordx4 v11, s[20:23], s67 offen  lds
    v_mfma_f32_16x16x32_bf16 v[164:167], v[84:87], v[104:107], v[164:167]
    v_mfma_f32_16x16x32_bf16 v[168:171], v[88:91], v[104:107], v[168:171]
    ds_read_b64_tr_b16 v[68:69], v6 offset:32768
    s_add_u32 m0, s66, 24576
    v_mfma_f32_16x16x32_bf16 v[172:175], v[92:95], v[104:107], v[172:175]
    ds_read_b128 v[104:107], v7 offset:4096
    v_mfma_f32_16x16x32_bf16 v[188:191], v[92:95], v[108:111], v[188:191]
    ds_read_b64_tr_b16 v[70:71], v6 offset:33792
    s_add_u32 s67, s64, 2064384
    v_mfma_f32_16x16x32_bf16 v[184:187], v[88:91], v[108:111], v[184:187]
    v_mfma_f32_16x16x32_bf16 v[180:183], v[84:87], v[108:111], v[180:183]
    ds_read_b64_tr_b16 v[72:73], v5 offset:40960
    buffer_load_dwordx4 v11, s[24:27], s67 offen  lds
    v_mfma_f32_16x16x32_bf16 v[176:179], v[80:83], v[108:111], v[176:179]
    ds_read_b128 v[108:111], v7 offset:6144
    v_mfma_f32_16x16x32_bf16 v[192:195], v[80:83], v[112:115], v[192:195]
    ds_read_b64_tr_b16 v[74:75], v5 offset:41984
    s_add_u32 m0, s66, 131072
    v_mfma_f32_16x16x32_bf16 v[196:199], v[84:87], v[112:115], v[196:199]
    v_mfma_f32_16x16x32_bf16 v[200:203], v[88:91], v[112:115], v[200:203]
    ds_read_b64_tr_b16 v[76:77], v6 offset:40960
    s_add_u32 s67, s65, 640
    v_mfma_f32_16x16x32_bf16 v[204:207], v[92:95], v[112:115], v[204:207]
    ds_read_b128 v[112:115], v7 offset:8192
    v_mfma_f32_16x16x32_bf16 v[220:223], v[92:95], v[116:119], v[220:223]
    ds_read_b64_tr_b16 v[78:79], v6 offset:41984
    buffer_load_dwordx4 v12, s[28:31], s67 offen  lds
    v_mfma_f32_16x16x32_bf16 v[216:219], v[88:91], v[116:119], v[216:219]
    v_mfma_f32_16x16x32_bf16 v[212:215], v[84:87], v[116:119], v[212:215]
    s_add_u32 m0, s66, 139264
    v_mfma_f32_16x16x32_bf16 v[208:211], v[80:83], v[116:119], v[208:211]
    ds_read_b128 v[116:119], v7 offset:10240
    v_mfma_f32_16x16x32_bf16 v[224:227], v[80:83], v[120:123], v[224:227]
    s_add_u32 s67, s65, 131712
    v_mfma_f32_16x16x32_bf16 v[228:231], v[84:87], v[120:123], v[228:231]
    v_mfma_f32_16x16x32_bf16 v[232:235], v[88:91], v[120:123], v[232:235]
    buffer_load_dwordx4 v12, s[28:31], s67 offen  lds
    v_mfma_f32_16x16x32_bf16 v[236:239], v[92:95], v[120:123], v[236:239]
    ds_read_b128 v[120:123], v7 offset:12288
    v_mfma_f32_16x16x32_bf16 v[252:255], v[92:95], v[124:127], v[252:255]
    s_cmp_eq_u32 s69, 5
    s_cbranch_scc1 L_y5
L_x5:
    v_mfma_f32_16x16x32_bf16 v[248:251], v[88:91], v[124:127], v[248:251]
    v_mfma_f32_16x16x32_bf16 v[244:247], v[84:87], v[124:127], v[244:247]
    v_mfma_f32_16x16x32_bf16 v[240:243], v[80:83], v[124:127], v[240:243]
    ds_read_b128 v[124:127], v7 offset:14336
    s_waitcnt lgkmcnt(3)
    v_mfma_f32_16x16x32_bf16 v[128:131], v[64:67], v[96:99], v[128:131]
    v_mfma_f32_16x16x32_bf16 v[132:135], v[68:71], v[96:99], v[132:135]
    v_mfma_f32_16x16x32_bf16 v[136:139], v[72:75], v[96:99], v[136:139]
    v_mfma_f32_16x16x32_bf16 v[140:143], v[76:79], v[96:99], v[140:143]
    s_waitcnt vmcnt(10) lgkmcnt(0)
    s_barrier
    v_mfma_f32_16x16x32_bf16 v[156:159], v[76:79], v[100:103], v[156:159]
    ds_read_b128 v[96:99], v8 offset:0
    s_add_u32 m0, s66, 32768
    v_mfma_f32_16x16x32_bf16 v[152:155], v[72:75], v[100:103], v[152:155]
    v_mfma_f32_16x16x32_bf16 v[148:151], v[68:71], v[100:103], v[148:151]
    ds_read_b64_tr_b16 v[80:81], v5 offset:49152
    s_add_u32 s67, s64, 2293760
    v_mfma_f32_16x16x32_bf16 v[144:147], v[64:67], v[100:103], v[144:147]
    ds_read_b128 v[100:103], v8 offset:2048
    v_mfma_f32_16x16x32_bf16 v[160:163], v[64:67], v[104:107], v[160:163]
    ds_read_b64_tr_b16 v[82:83], v5 offset:50176
    buffer_load_dwordx4 v11, s[20:23], s67 offen  lds
    v_mfma_f32_16x16x32_bf16 v[164:167], v[68:71], v[104:107], v[164:167]
    v_mfma_f32_16x16x32_bf16 v[168:171], v[72:75], v[104:107], v[168:171]
    ds_read_b64_tr_b16 v[84:85], v6 offset:49152
    s_add_u32 m0, s66, 40960
    v_mfma_f32_16x16x32_bf16 v[172:175], v[76:79], v[104:107], v[172:175]
    ds_read_b128 v[104:107], v8 offset:4096
    v_mfma_f32_16x16x32_bf16 v[188:191], v[76:79], v[108:111], v[188:191]
    ds_read_b64_tr_b16 v[86:87], v6 offset:50176
    s_add_u32 s67, s64, 2293760
    v_mfma_f32_16x16x32_bf16 v[184:187], v[72:75], v[108:111], v[184:187]
    v_mfma_f32_16x16x32_bf16 v[180:183], v[68:71], v[108:111], v[180:183]
    ds_read_b64_tr_b16 v[88:89], v5 offset:57344
    buffer_load_dwordx4 v11, s[24:27], s67 offen  lds
    v_mfma_f32_16x16x32_bf16 v[176:179], v[64:67], v[108:111], v[176:179]
    ds_read_b128 v[108:111], v8 offset:6144
    v_mfma_f32_16x16x32_bf16 v[192:195], v[64:67], v[112:115], v[192:195]
    ds_read_b64_tr_b16 v[90:91], v5 offset:58368
    s_add_u32 m0, s66, 147456
    v_mfma_f32_16x16x32_bf16 v[196:199], v[68:71], v[112:115], v[196:199]
    v_mfma_f32_16x16x32_bf16 v[200:203], v[72:75], v[112:115], v[200:203]
    ds_read_b64_tr_b16 v[92:93], v6 offset:57344
    s_add_u32 s67, s65, 262784
    v_mfma_f32_16x16x32_bf16 v[204:207], v[76:79], v[112:115], v[204:207]
    ds_read_b128 v[112:115], v8 offset:8192
    v_mfma_f32_16x16x32_bf16 v[220:223], v[76:79], v[116:119], v[220:223]
    ds_read_b64_tr_b16 v[94:95], v6 offset:58368
    buffer_load_dwordx4 v12, s[28:31], s67 offen  lds
    v_mfma_f32_16x16x32_bf16 v[216:219], v[72:75], v[116:119], v[216:219]
    v_mfma_f32_16x16x32_bf16 v[212:215], v[68:71], v[116:119], v[212:215]
    s_add_u32 m0, s66, 155648
    v_mfma_f32_16x16x32_bf16 v[208:211], v[64:67], v[116:119], v[208:211]
    ds_read_b128 v[116:119], v8 offset:10240
    v_mfma_f32_16x16x32_bf16 v[224:227], v[64:67], v[120:123], v[224:227]
    s_add_u32 s67, s65, 393856
    v_mfma_f32_16x16x32_bf16 v[228:231], v[68:71], v[120:123], v[228:231]
    v_mfma_f32_16x16x32_bf16 v[232:235], v[72:75], v[120:123], v[232:235]
    buffer_load_dwordx4 v12, s[28:31], s67 offen  lds
    v_mfma_f32_16x16x32_bf16 v[236:239], v[76:79], v[120:123], v[236:239]
    ds_read_b128 v[120:123], v8 offset:12288
    v_mfma_f32_16x16x32_bf16 v[252:255], v[76:79], v[124:127], v[252:255]
    s_cmp_eq_u32 s69, 6
    s_cbranch_scc1 L_y6
L_x6:
    v_mfma_f32_16x16x32_bf16 v[248:251], v[72:75], v[124:127], v[248:251]
    v_mfma_f32_16x16x32_bf16 v[244:247], v[68:71], v[124:127], v[244:247]
    v_mfma_f32_16x16x32_bf16 v[240:243], v[64:67], v[124:127], v[240:243]
    ds_read_b128 v[124:127], v8 offset:14336
    s_waitcnt lgkmcnt(3)
    v_mfma_f32_16x16x32_bf16 v[128:131], v[80:83], v[96:99], v[128:131]
    v_mfma_f32_16x16x32_bf16 v[132:135], v[84:87], v[96:99], v[132:135]
    v_mfma_f32_16x16x32_bf16 v[136:139], v[88:91], v[96:99], v[136:139]
    v_mfma_f32_16x16x32_bf16 v[140:143], v[92:95], v[96:99], v[140:143]
    s_waitcnt vmcnt(8) lgkmcnt(0)
    s_barrier
    v_mfma_f32_16x16x32_bf16 v[156:159], v[92:95], v[100:103], v[156:159]
    ds_read_b128 v[96:99], v7 offset:32768
    s_add_u32 m0, s66, 49152
    v_mfma_f32_16x16x32_bf16 v[152:155], v[88:91], v[100:103], v[152:155]
    v_mfma_f32_16x16x32_bf16 v[148:151], v[84:87], v[100:103], v[148:151]
    ds_read_b64_tr_b16 v[64:65], v5 offset:0
    s_add_u32 s67, s64, 2523136
    v_mfma_f32_16x16x32_bf16 v[144:147], v[80:83], v[100:103], v[144:147]
    ds_read_b128 v[100:103], v7 offset:34816
    v_mfma_f32_16x16x32_bf16 v[160:163], v[80:83], v[104:107], v[160:163]
    ds_read_b64_tr_b16 v[66:67], v5 offset:1024
    buffer_load_dwordx4 v11, s[20:23], s67 offen  lds
    v_mfma_f32_16x16x32_bf16 v[164:167], v[84:87], v[104:107], v[164:167]
    v_mfma_f32_16x16x32_bf16 v[168:171], v[88:91], v[104:107], v[168:171]
    ds_read_b64_tr_b16 v[68:69], v6 offset:0
    s_add_u32 m0, s66, 57344
    v_mfma_f32_16x16x32_bf16 v[172:175], v[92:95], v[104:107], v[172:175]
    ds_read_b128 v[104:107], v7 offset:36864
    v_mfma_f32_16x16x32_bf16 v[188:191], v[92:95], v[108:111], v[188:191]
    ds_read_b64_tr_b16 v[70:71], v6 offset:1024
    s_add_u32 s67, s64, 2523136
    v_mfma_f32_16x16x32_bf16 v[184:187], v[88:91], v[108:111], v[184:187]
    v_mfma_f32_16x16x32_bf16 v[180:183], v[84:87], v[108:111], v[180:183]
    ds_read_b64_tr_b16 v[72:73], v5 offset:8192
    buffer_load_dwordx4 v11, s[24:27], s67 offen  lds
    v_mfma_f32_16x16x32_bf16 v[176:179], v[80:83], v[108:111], v[176:179]
    ds_read_b128 v[108:111], v7 offset:38912
    v_mfma_f32_16x16x32_bf16 v[192:195], v[80:83], v[112:115], v[192:195]
    ds_read_b64_tr_b16 v[74:75], v5 offset:9216
    s_add_u32 m0, s66, 65536
    v_mfma_f32_16x16x32_bf16 v[196:199], v[84:87], v[112:115], v[196:199]
    v_mfma_f32_16x16x32_bf16 v[200:203], v[88:91], v[112:115], v[200:203]
    ds_read_b64_tr_b16 v[76:77], v6 offset:8192
    s_add_u32 s67, s65, 768
    v_mfma_f32_16x16x32_bf16 v[204:207], v[92:95], v[112:115], v[204:207]
    ds_read_b128 v[112:115], v7 offset:40960
    v_mfma_f32_16x16x32_bf16 v[220:223], v[92:95], v[116:119], v[220:223]
    ds_read_b64_tr_b16 v[78:79], v6 offset:9216
    buffer_load_dwordx4 v12, s[28:31], s67 offen  lds
    v_mfma_f32_16x16x32_bf16 v[216:219], v[88:91], v[116:119], v[216:219]
    v_mfma_f32_16x16x32_bf16 v[212:215], v[84:87], v[116:119], v[212:215]
    s_add_u32 m0, s66, 73728
    v_mfma_f32_16x16x32_bf16 v[208:211], v[80:83], v[116:119], v[208:211]
    ds_read_b128 v[116:119], v7 offset:43008
    v_mfma_f32_16x16x32_bf16 v[224:227], v[80:83], v[120:123], v[224:227]
    s_add_u32 s67, s65, 131840
    v_mfma_f32_16x16x32_bf16 v[228:231], v[84:87], v[120:123], v[228:231]
    v_mfma_f32_16x16x32_bf16 v[232:235], v[88:91], v[120:123], v[232:235]
    buffer_load_dwordx4 v12, s[28:31], s67 offen  lds
    v_mfma_f32_16x16x32_bf16 v[236:239], v[92:95], v[120:123], v[236:239]
    ds_read_b128 v[120:123], v7 offset:45056
    v_mfma_f32_16x16x32_bf16 v[252:255], v[92:95], v[124:127], v[252:255]
    s_cmp_eq_u32 s69, 7
    s_cbranch_scc1 L_y7
L_x7:
    v_mfma_f32_16x16x32_bf16 v[248:251], v[88:91], v[124:127], v[248:251]
    v_mfma_f32_16x16x32_bf16 v[244:247], v[84:87], v[124:127], v[244:247]
    v_mfma_f32_16x16x32_bf16 v[240:243], v[80:83], v[124:127], v[240:243]
    ds_read_b128 v[124:127], v7 offset:47104
    s_waitcnt lgkmcnt(3)
    v_mfma_f32_16x16x32_bf16 v[128:131], v[64:67], v[96:99], v[128:131]
    v_mfma_f32_16x16x32_bf16 v[132:135], v[68:71], v[96:99], v[132:135]
    v_mfma_f32_16x16x32_bf16 v[136:139], v[72:75], v[96:99], v[136:139]
    v_mfma_f32_16x16x32_bf16 v[140:143], v[76:79], v[96:99], v[140:143]
    s_waitcnt vmcnt(10) lgkmcnt(0)
    s_barrier
    v_mfma_f32_16x16x32_bf16 v[156:159], v[76:79], v[100:103], v[156:159]
    ds_read_b128 v[96:99], v8 offset:32768
    s_add_u32 m0, s66, 0
    v_mfma_f32_16x16x32_bf16 v[152:155], v[72:75], v[100:103], v[152:155]
    v_mfma_f32_16x16x32_bf16 v[148:151], v[68:71], v[100:103], v[148:151]
    ds_read_b64_tr_b16 v[80:81], v5 offset:16384
    s_add_u32 s67, s64, 2752512
    v_mfma_f32_16x16x32_bf16 v[144:147], v[64:67], v[100:103], v[144:147]
    ds_read_b128 v[100:103], v8 offset:34816
    v_mfma_f32_16x16x32_bf16 v[160:163], v[64:67], v[104:107], v[160:163]
    ds_read_b64_tr_b16 v[82:83], v5 offset:17408
    buffer_load_dwordx4 v11, s[20:23], s67 offen  lds
    v_mfma_f32_16x16x32_bf16 v[164:167], v[68:71], v[104:107], v[164:167]
    v_mfma_f32_16x16x32_bf16 v[168:171], v[72:75], v[104:107], v[168:171]
    ds_read_b64_tr_b16 v[84:85], v6 offset:16384
    s_add_u32 m0, s66, 8192
    v_mfma_f32_16x16x32_bf16 v[172:175], v[76:79], v[104:107], v[172:175]
    ds_read_b128 v[104:107], v8 offset:36864
    v_mfma_f32_16x16x32_bf16 v[188:191], v[76:79], v[108:111], v[188:191]
    ds_read_b64_tr_b16 v[86:87], v6 offset:17408
    s_add_u32 s67, s64, 2752512
    v_mfma_f32_16x16x32_bf16 v[184:187], v[72:75], v[108:111], v[184:187]
    v_mfma_f32_16x16x32_bf16 v[180:183], v[68:71], v[108:111], v[180:183]
    ds_read_b64_tr_b16 v[88:89], v5 offset:24576
    buffer_load_dwordx4 v11, s[24:27], s67 offen  lds
    v_mfma_f32_16x16x32_bf16 v[176:179], v[64:67], v[108:111], v[176:179]
    ds_read_b128 v[108:111], v8 offset:38912
    v_mfma_f32_16x16x32_bf16 v[192:195], v[64:67], v[112:115], v[192:195]
    ds_read_b64_tr_b16 v[90:91], v5 offset:25600
    s_add_u32 m0, s66, 81920
    v_mfma_f32_16x16x32_bf16 v[196:199], v[68:71], v[112:115], v[196:199]
    v_mfma_f32_16x16x32_bf16 v[200:203], v[72:75], v[112:115], v[200:203]
    ds_read_b64_tr_b16 v[92:93], v6 offset:24576
    s_add_u32 s67, s65, 262912
    v_mfma_f32_16x16x32_bf16 v[204:207], v[76:79], v[112:115], v[204:207]
    ds_read_b128 v[112:115], v8 offset:40960
    v_mfma_f32_16x16x32_bf16 v[220:223], v[76:79], v[116:119], v[220:223]
    ds_read_b64_tr_b16 v[94:95], v6 offset:25600
    buffer_load_dwordx4 v12, s[28:31], s67 offen  lds
    v_mfma_f32_16x16x32_bf16 v[216:219], v[72:75], v[116:119], v[216:219]
    v_mfma_f32_16x16x32_bf16 v[212:215], v[68:71], v[116:119], v[212:215]
    s_add_u32 m0, s66, 90112
    v_mfma_f32_16x16x32_bf16 v[208:211], v[64:67], v[116:119], v[208:211]
    ds_read_b128 v[116:119], v8 offset:43008
    v_mfma_f32_16x16x32_bf16 v[224:227], v[64:67], v[120:123], v[224:227]
    s_add_u32 s67, s65, 393984
    v_mfma_f32_16x16x32_bf16 v[228:231], v[68:71], v[120:123], v[228:231]
    v_mfma_f32_16x16x32_bf16 v[232:235], v[72:75], v[120:123], v[232:235]
    buffer_load_dwordx4 v12, s[28:31], s67 offen  lds
    v_mfma_f32_16x16x32_bf16 v[236:239], v[76:79], v[120:123], v[236:239]
    ds_read_b128 v[120:123], v8 offset:45056
    v_mfma_f32_16x16x32_bf16 v[252:255], v[76:79], v[124:127], v[252:255]
    s_cmp_eq_u32 s69, 8
    s_cbranch_scc1 L_y8
L_x8:
    v_mfma_f32_16x16x32_bf16 v[248:251], v[72:75], v[124:127], v[248:251]
    v_mfma_f32_16x16x32_bf16 v[244:247], v[68:71], v[124:127], v[244:247]
    v_mfma_f32_16x16x32_bf16 v[240:243], v[64:67], v[124:127], v[240:243]
    ds_read_b128 v[124:127], v8 offset:47104
    s_waitcnt lgkmcnt(3)
    v_mfma_f32_16x16x32_bf16 v[128:131], v[80:83], v[96:99], v[128:131]
    v_mfma_f32_16x16x32_bf16 v[132:135], v[84:87], v[96:99], v[132:135]
    v_mfma_f32_16x16x32_bf16 v[136:139], v[88:91], v[96:99], v[136:139]
    v_mfma_f32_16x16x32_bf16 v[140:143], v[92:95], v[96:99], v[140:143]
    s_waitcnt vmcnt(8) lgkmcnt(0)
    s_barrier
    v_mfma_f32_16x16x32_bf16 v[156:159], v[92:95], v[100:103], v[156:159]
    ds_read_b128 v[96:99], v9 offset:0
    s_add_u32 m0, s66, 16384
    v_mfma_f32_16x16x32_bf16 v[152:155], v[88:91], v[100:103], v[152:155]
    v_mfma_f32_16x16x32_bf16 v[148:151], v[84:87], v[100:103], v[148:151]
    ds_read_b64_tr_b16 v[64:65], v5 offset:32768
    s_add_u32 s67, s64, 2981888
    v_mfma_f32_16x16x32_bf16 v[144:147], v[80:83], v[100:103], v[144:147]
    ds_read_b128 v[100:103], v9 offset:2048
    v_mfma_f32_16x16x32_bf16 v[160:163], v[80:83], v[104:107], v[160:163]
    ds_read_b64_tr_b16 v[66:67], v5 offset:33792
    buffer_load_dwordx4 v11, s[20:23], s67 offen  lds
    v_mfma_f32_16x16x32_bf16 v[164:167], v[84:87], v[104:107], v[164:167]
    v_mfma_f32_16x16x32_bf16 v[168:171], v[88:91], v[104:107], v[168:171]
    ds_read_b64_tr_b16 v[68:69], v6 offset:32768
    s_add_u32 m0, s66, 24576
    v_mfma_f32_16x16x32_bf16 v[172:175], v[92:95], v[104:107], v[172:175]
    ds_read_b128 v[104:107], v9 offset:4096
    v_mfma_f32_16x16x32_bf16 v[188:191], v[92:95], v[108:111], v[188:191]
    ds_read_b64_tr_b16 v[70:71], v6 offset:33792
    s_add_u32 s67, s64, 2981888
    v_mfma_f32_16x16x32_bf16 v[184:187], v[88:91], v[108:111], v[184:187]
    v_mfma_f32_16x16x32_bf16 v[180:183], v[84:87], v[108:111], v[180:183]
    ds_read_b64_tr_b16 v[72:73], v5 offset:40960
    buffer_load_dwordx4 v11, s[24:27], s67 offen  lds
    v_mfma_f32_16x16x32_bf16 v[176:179], v[80:83], v[108:111], v[176:179]
    ds_read_b128 v[108:111], v9 offset:6144
    v_mfma_f32_16x16x32_bf16 v[192:195], v[80:83], v[112:115], v[192:195]
    ds_read_b64_tr_b16 v[74:75], v5 offset:41984
    s_add_u32 m0, s66, 98304
    v_mfma_f32_16x16x32_bf16 v[196:199], v[84:87], v[112:115], v[196:199]
    v_mfma_f32_16x16x32_bf16 v[200:203], v[88:91], v[112:115], v[200:203]
    ds_read_b64_tr_b16 v[76:77], v6 offset:40960
    s_add_u32 s67, s65, 896
    v_mfma_f32_16x16x32_bf16 v[204:207], v[92:95], v[112:115], v[204:207]
    ds_read_b128 v[112:115], v9 offset:8192
    v_mfma_f32_16x16x32_bf16 v[220:223], v[92:95], v[116:119], v[220:223]
    ds_read_b64_tr_b16 v[78:79], v6 offset:41984
    buffer_load_dwordx4 v12, s[28:31], s67 offen  lds
    v_mfma_f32_16x16x32_bf16 v[216:219], v[88:91], v[116:119], v[216:219]
    v_mfma_f32_16x16x32_bf16 v[212:215], v[84:87], v[116:119], v[212:215]
    s_add_u32 m0, s66, 106496
    v_mfma_f32_16x16x32_bf16 v[208:211], v[80:83], v[116:119], v[208:211]
    ds_read_b128 v[116:119], v9 offset:10240
    v_mfma_f32_16x16x32_bf16 v[224:227], v[80:83], v[120:123], v[224:227]
    s_add_u32 s67, s65, 131968
    v_mfma_f32_16x16x32_bf16 v[228:231], v[84:87], v[120:123], v[228:231]
    v_mfma_f32_16x16x32_bf16 v[232:235], v[88:91], v[120:123], v[232:235]
    buffer_load_dwordx4 v12, s[28:31], s67 offen  lds
    v_mfma_f32_16x16x32_bf16 v[236:239], v[92:95], v[120:123], v[236:239]
    ds_read_b128 v[120:123], v9 offset:12288
    v_mfma_f32_16x16x32_bf16 v[252:255], v[92:95], v[124:127], v[252:255]
    s_cmp_eq_u32 s69, 9
    s_cbranch_scc1 L_y9
L_x9:
    v_mfma_f32_16x16x32_bf16 v[248:251], v[88:91], v[124:127], v[248:251]
    v_mfma_f32_16x16x32_bf16 v[244:247], v[84:87], v[124:127], v[244:247]
    v_mfma_f32_16x16x32_bf16 v[240:243], v[80:83], v[124:127], v[240:243]
    ds_read_b128 v[124:127], v9 offset:14336
    s_waitcnt lgkmcnt(3)
    v_mfma_f32_16x16x32_bf16 v[128:131], v[64:67], v[96:99], v[128:131]
    v_mfma_f32_16x16x32_bf16 v[132:135], v[68:71], v[96:99], v[132:135]
    v_mfma_f32_16x16x32_bf16 v[136:139], v[72:75], v[96:99], v[136:139]
    v_mfma_f32_16x16x32_bf16 v[140:143], v[76:79], v[96:99], v[140:143]
    s_waitcnt vmcnt(10) lgkmcnt(0)
    s_barrier
    v_mfma_f32_16x16x32_bf16 v[156:159], v[76:79], v[100:103], v[156:159]
    ds_read_b128 v[96:99], v10 offset:0
    s_add_u32 m0, s66, 32768
    v_mfma_f32_16x16x32_bf16 v[152:155], v[72:75], v[100:103], v[152:155]
    v_mfma_f32_16x16x32_bf16 v[148:151], v[68:71], v[100:103], v[148:151]
    ds_read_b64_tr_b16 v[80:81], v5 offset:49152
    s_add_u32 s67, s64, 3211264
    v_mfma_f32_16x16x32_bf16 v[144:147], v[64:67], v[100:103], v[144:147]
    ds_read_b128 v[100:103], v10 offset:2048
    v_mfma_f32_16x16x32_bf16 v[160:163], v[64:67], v[104:107], v[160:163]
    ds_read_b64_tr_b16 v[82:83], v5 offset:50176
    buffer_load_dwordx4 v11, s[20:23], s67 offen  lds
    v_mfma_f32_16x16x32_bf16 v[164:167], v[68:71], v[104:107], v[164:167]
    v_mfma_f32_16x16x32_bf16 v[168:171], v[72:75], v[104:107], v[168:171]
    ds_read_b64_tr_b16 v[84:85], v6 offset:49152
    s_add_u32 m0, s66, 40960
    v_mfma_f32_16x16x32_bf16 v[172:175], v[76:79], v[104:107], v[172:175]
    ds_read_b128 v[104:107], v10 offset:4096
    v_mfma_f32_16x16x32_bf16 v[188:191], v[76:79], v[108:111], v[188:191]
    ds_read_b64_tr_b16 v[86:87], v6 offset:50176
    s_add_u32 s67, s64, 3211264
    v_mfma_f32_16x16x32_bf16 v[184:187], v[72:75], v[108:111], v[184:187]
    v_mfma_f32_16x16x32_bf16 v[180:183], v[68:71], v[108:111], v[180:183]
    ds_read_b64_tr_b16 v[88:89], v5 offset:57344
    buffer_load_dwordx4 v11, s[24:27], s67 offen  lds
    v_mfma_f32_16x16x32_bf16 v[176:179], v[64:67], v[108:111], v[176:179]
    ds_read_b128 v[108:111], v10 offset:6144
    v_mfma_f32_16x16x32_bf16 v[192:195], v[64:67], v[112:115], v[192:195]
    ds_read_b64_tr_b16 v[90:91], v5 offset:58368
    s_add_u32 m0, s66, 114688
    v_mfma_f32_16x16x32_bf16 v[196:199], v[68:71], v[112:115], v[196:199]
    v_mfma_f32_16x16x32_bf16 v[200:203], v[72:75], v[112:115], v[200:203]
    ds_read_b64_tr_b16 v[92:93], v6 offset:57344
    s_add_u32 s67, s65, 263040
    v_mfma_f32_16x16x32_bf16 v[204:207], v[76:79], v[112:115], v[204:207]
    ds_read_b128 v[112:115], v10 offset:8192
    v_mfma_f32_16x16x32_bf16 v[220:223], v[76:79], v[116:119], v[220:223]
    ds_read_b64_tr_b16 v[94:95], v6 offset:58368
    buffer_load_dwordx4 v12, s[28:31], s67 offen  lds
    v_mfma_f32_16x16x32_bf16 v[216:219], v[72:75], v[116:119], v[216:219]
    v_mfma_f32_16x16x32_bf16 v[212:215], v[68:71], v[116:119], v[212:215]
    s_add_u32 m0, s66, 122880
    v_mfma_f32_16x16x32_bf16 v[208:211], v[64:67], v[116:119], v[208:211]
    ds_read_b128 v[116:119], v10 offset:10240
    v_mfma_f32_16x16x32_bf16 v[224:227], v[64:67], v[120:123], v[224:227]
    s_add_u32 s67, s65, 394112
    v_mfma_f32_16x16x32_bf16 v[228:231], v[68:71], v[120:123], v[228:231]
    v_mfma_f32_16x16x32_bf16 v[232:235], v[72:75], v[120:123], v[232:235]
    buffer_load_dwordx4 v12, s[28:31], s67 offen  lds
    v_mfma_f32_16x16x32_bf16 v[236:239], v[76:79], v[120:123], v[236:239]
    ds_read_b128 v[120:123], v10 offset:12288
    v_mfma_f32_16x16x32_bf16 v[252:255], v[76:79], v[124:127], v[252:255]
    s_cmp_eq_u32 s69, 10
    s_cbranch_scc1 L_y10
L_x10:
    v_mfma_f32_16x16x32_bf16 v[248:251], v[72:75], v[124:127], v[248:251]
    v_mfma_f32_16x16x32_bf16 v[244:247], v[68:71], v[124:127], v[244:247]
    v_mfma_f32_16x16x32_bf16 v[240:243], v[64:67], v[124:127], v[240:243]
    ds_read_b128 v[124:127], v10 offset:14336
    s_waitcnt lgkmcnt(3)
    v_mfma_f32_16x16x32_bf16 v[128:131], v[80:83], v[96:99], v[128:131]
    v_mfma_f32_16x16x32_bf16 v[132:135], v[84:87], v[96:99], v[132:135]
    v_mfma_f32_16x16x32_bf16 v[136:139], v[88:91], v[96:99], v[136:139]
    v_mfma_f32_16x16x32_bf16 v[140:143], v[92:95], v[96:99], v[140:143]
    s_waitcnt vmcnt(8) lgkmcnt(0)
    s_barrier
    v_mfma_f32_16x16x32_bf16 v[156:159], v[92:95], v[100:103], v[156:159]
    ds_read_b128 v[96:99], v7 offset:0
    s_add_u32 m0, s66, 49152
    v_mfma_f32_16x16x32_bf16 v[152:155], v[88:91], v[100:103], v[152:155]
    v_mfma_f32_16x16x32_bf16 v[148:151], v[84:87], v[100:103], v[148:151]
    ds_read_b64_tr_b16 v[64:65], v5 offset:0
    s_add_u32 s67, s64, 3440640
    v_mfma_f32_16x16x32_bf16 v[144:147], v[80:83], v[100:103], v[144:147]
    ds_read_b128 v[100:103], v7 offset:2048
    v_mfma_f32_16x16x32_bf16 v[160:163], v[80:83], v[104:107], v[160:163]
    ds_read_b64_tr_b16 v[66:67], v5 offset:1024
    buffer_load_dwordx4 v11, s[20:23], s67 offen  lds
    v_mfma_f32_16x16x32_bf16 v[164:167], v[84:87], v[104:107], v[164:167]
    v_mfma_f32_16x16x32_bf16 v[168:171], v[88:91], v[104:107], v[168:171]
    ds_read_b64_tr_b16 v[68:69], v6 offset:0
    s_add_u32 m0, s66, 57344
    v_mfma_f32_16x16x32_bf16 v[172:175], v[92:95], v[104:107], v[172:175]
    ds_read_b128 v[104:107], v7 offset:4096
    v_mfma_f32_16x16x32_bf16 v[188:191], v[92:95], v[108:111], v[188:191]
    ds_read_b64_tr_b16 v[70:71], v6 offset:1024
    s_add_u32 s67, s64, 3440640
    v_mfma_f32_16x16x32_bf16 v[184:187], v[88:91], v[108:111], v[184:187]
    v_mfma_f32_16x16x32_bf16 v[180:183], v[84:87], v[108:111], v[180:183]
    ds_read_b64_tr_b16 v[72:73], v5 offset:8192
    buffer_load_dwordx4 v11, s[24:27], s67 offen  lds
    v_mfma_f32_16x16x32_bf16 v[176:179], v[80:83], v[108:111], v[176:179]
    ds_read_b128 v[108:111], v7 offset:6144
    v_mfma_f32_16x16x32_bf16 v[192:195], v[80:83], v[112:115], v[192:195]
    ds_read_b64_tr_b16 v[74:75], v5 offset:9216
    s_add_u32 m0, s66, 131072
    v_mfma_f32_16x16x32_bf16 v[196:199], v[84:87], v[112:115], v[196:199]
    v_mfma_f32_16x16x32_bf16 v[200:203], v[88:91], v[112:115], v[200:203]
    ds_read_b64_tr_b16 v[76:77], v6 offset:8192
    s_add_u32 s67, s65, 1024
    v_mfma_f32_16x16x32_bf16 v[204:207], v[92:95], v[112:115], v[204:207]
    ds_read_b128 v[112:115], v7 offset:8192
    v_mfma_f32_16x16x32_bf16 v[220:223], v[92:95], v[116:119], v[220:223]
    ds_read_b64_tr_b16 v[78:79], v6 offset:9216
    buffer_load_dwordx4 v12, s[28:31], s67 offen  lds
    v_mfma_f32_16x16x32_bf16 v[216:219], v[88:91], v[116:119], v[216:219]
    v_mfma_f32_16x16x32_bf16 v[212:215], v[84:87], v[116:119], v[212:215]
    s_add_u32 m0, s66, 139264
    v_mfma_f32_16x16x32_bf16 v[208:211], v[80:83], v[116:119], v[208:211]
    ds_read_b128 v[116:119], v7 offset:10240
    v_mfma_f32_16x16x32_bf16 v[224:227], v[80:83], v[120:123], v[224:227]
    s_add_u32 s67, s65, 132096
    v_mfma_f32_16x16x32_bf16 v[228:231], v[84:87], v[120:123], v[228:231]
    v_mfma_f32_16x16x32_bf16 v[232:235], v[88:91], v[120:123], v[232:235]
    buffer_load_dwordx4 v12, s[28:31], s67 offen  lds
    v_mfma_f32_16x16x32_bf16 v[236:239], v[92:95], v[120:123], v[236:239]
    ds_read_b128 v[120:123], v7 offset:12288
    v_mfma_f32_16x16x32_bf16 v[252:255], v[92:95], v[124:127], v[252:255]
    s_cmp_eq_u32 s69, 11
    s_cbranch_scc1 L_y11
L_x11:
    v_mfma_f32_16x16x32_bf16 v[248:251], v[88:91], v[124:127], v[248:251]
    v_mfma_f32_16x16x32_bf16 v[244:247], v[84:87], v[124:127], v[244:247]
    v_mfma_f32_16x16x32_bf16 v[240:243], v[80:83], v[124:127], v[240:243]
    ds_read_b128 v[124:127], v7 offset:14336
    s_waitcnt lgkmcnt(3)
    v_mfma_f32_16x16x32_bf16 v[128:131], v[64:67], v[96:99], v[128:131]
    v_mfma_f32_16x16x32_bf16 v[132:135], v[68:71], v[96:99], v[132:135]
    v_mfma_f32_16x16x32_bf16 v[136:139], v[72:75], v[96:99], v[136:139]
    v_mfma_f32_16x16x32_bf16 v[140:143], v[76:79], v[96:99], v[140:143]
    s_waitcnt vmcnt(10) lgkmcnt(0)
    s_barrier
    v_mfma_f32_16x16x32_bf16 v[156:159], v[76:79], v[100:103], v[156:159]
    ds_read_b128 v[96:99], v8 offset:0
    s_add_u32 m0, s66, 0
    v_mfma_f32_16x16x32_bf16 v[152:155], v[72:75], v[100:103], v[152:155]
    v_mfma_f32_16x16x32_bf16 v[148:151], v[68:71], v[100:103], v[148:151]
    ds_read_b64_tr_b16 v[80:81], v5 offset:16384
    s_add_u32 s67, s64, 3670016
    v_mfma_f32_16x16x32_bf16 v[144:147], v[64:67], v[100:103], v[144:147]
    ds_read_b128 v[100:103], v8 offset:2048
    v_mfma_f32_16x16x32_bf16 v[160:163], v[64:67], v[104:107], v[160:163]
    ds_read_b64_tr_b16 v[82:83], v5 offset:17408
    buffer_load_dwordx4 v11, s[20:23], s67 offen  lds
    v_mfma_f32_16x16x32_bf16 v[164:167], v[68:71], v[104:107], v[164:167]
    v_mfma_f32_16x16x32_bf16 v[168:171], v[72:75], v[104:107], v[168:171]
    ds_read_b64_tr_b16 v[84:85], v6 offset:16384
    s_add_u32 m0, s66, 8192
    v_mfma_f32_16x16x32_bf16 v[172:175], v[76:79], v[104:107], v[172:175]
    ds_read_b128 v[104:107], v8 offset:4096
    v_mfma_f32_16x16x32_bf16 v[188:191], v[76:79], v[108:111], v[188:191]
    ds_read_b64_tr_b16 v[86:87], v6 offset:17408
    s_add_u32 s67, s64, 3670016
    v_mfma_f32_16x16x32_bf16 v[184:187], v[72:75], v[108:111], v[184:187]
    v_mfma_f32_16x16x32_bf16 v[180:183], v[68:71], v[108:111], v[180:183]
    ds_read_b64_tr_b16 v[88:89], v5 offset:24576
    buffer_load_dwordx4 v11, s[24:27], s67 offen  lds
    v_mfma_f32_16x16x32_bf16 v[176:179], v[64:67], v[108:111], v[176:179]
    ds_read_b128 v[108:111], v8 offset:6144
    v_mfma_f32_16x16x32_bf16 v[192:195], v[64:67], v[112:115], v[192:195]
    ds_read_b64_tr_b16 v[90:91], v5 offset:25600
    s_add_u32 m0, s66, 147456
    v_mfma_f32_16x16x32_bf16 v[196:199], v[68:71], v[112:115], v[196:199]
    v_mfma_f32_16x16x32_bf16 v[200:203], v[72:75], v[112:115], v[200:203]
    ds_read_b64_tr_b16 v[92:93], v6 offset:24576
    s_add_u32 s67, s65, 263168
    v_mfma_f32_16x16x32_bf16 v[204:207], v[76:79], v[112:115], v[204:207]
    ds_read_b128 v[112:115], v8 offset:8192
    v_mfma_f32_16x16x32_bf16 v[220:223], v[76:79], v[116:119], v[220:223]
    ds_read_b64_tr_b16 v[94:95], v6 offset:25600
    buffer_load_dwordx4 v12, s[28:31], s67 offen  lds
    v_mfma_f32_16x16x32_bf16 v[216:219], v[72:75], v[116:119], v[216:219]
    v_mfma_f32_16x16x32_bf16 v[212:215], v[68:71], v[116:119], v[212:215]
    s_add_u32 m0, s66, 155648
    v_mfma_f32_16x16x32_bf16 v[208:211], v[64:67], v[116:119], v[208:211]
    ds_read_b128 v[116:119], v8 offset:10240
    v_mfma_f32_16x16x32_bf16 v[224:227], v[64:67], v[120:123], v[224:227]
    s_add_u32 s67, s65, 394240
    v_mfma_f32_16x16x32_bf16 v[228:231], v[68:71], v[120:123], v[228:231]
    v_mfma_f32_16x16x32_bf16 v[232:235], v[72:75], v[120:123], v[232:235]
    buffer_load_dwordx4 v12, s[28:31], s67 offen  lds
    v_mfma_f32_16x16x32_bf16 v[236:239], v[76:79], v[120:123], v[236:239]
    ds_read_b128 v[120:123], v8 offset:12288
    v_mfma_f32_16x16x32_bf16 v[252:255], v[76:79], v[124:127], v[252:255]
    s_cmp_eq_u32 s69, 12
    s_cbranch_scc1 L_y12
L_x12:
    v_mfma_f32_16x16x32_bf16 v[248:251], v[72:75], v[124:127], v[248:251]
    v_mfma_f32_16x16x32_bf16 v[244:247], v[68:71], v[124:127], v[244:247]
    v_mfma_f32_16x16x32_bf16 v[240:243], v[64:67], v[124:127], v[240:243]
    ds_read_b128 v[124:127], v8 offset:14336
    s_waitcnt lgkmcnt(3)
    v_mfma_f32_16x16x32_bf16 v[128:131], v[80:83], v[96:99], v[128:131]
    v_mfma_f32_16x16x32_bf16 v[132:135], v[84:87], v[96:99], v[132:135]
    v_mfma_f32_16x16x32_bf16 v[136:139], v[88:91], v[96:99], v[136:139]
    v_mfma_f32_16x16x32_bf16 v[140:143], v[92:95], v[96:99], v[140:143]
    s_waitcnt vmcnt(8) lgkmcnt(0)
    s_barrier
    v_mfma_f32_16x16x32_bf16 v[156:159], v[92:95], v[100:103], v[156:159]
    ds_read_b128 v[96:99], v7 offset:32768
    s_add_u32 m0, s66, 16384
    v_mfma_f32_16x16x32_bf16 v[152:155], v[88:91], v[100:103], v[152:155]
    v_mfma_f32_16x16x32_bf16 v[148:151], v[84:87], v[100:103], v[148:151]
    ds_read_b64_tr_b16 v[64:65], v5 offset:32768
    s_add_u32 s67, s64, 3899392
    v_mfma_f32_16x16x32_bf16 v[144:147], v[80:83], v[100:103], v[144:147]
    ds_read_b128 v[100:103], v7 offset:34816
    v_mfma_f32_16x16x32_bf16 v[160:163], v[80:83], v[104:107], v[160:163]
    ds_read_b64_tr_b16 v[66:67], v5 offset:33792
    buffer_load_dwordx4 v11, s[20:23], s67 offen  lds
    v_mfma_f32_16x16x32_bf16 v[164:167], v[84:87], v[104:107], v[164:167]
    v_mfma_f32_16x16x32_bf16 v[168:171], v[88:91], v[104:107], v[168:171]
    ds_read_b64_tr_b16 v[68:69], v6 offset:32768
    s_add_u32 m0, s66, 24576
    v_mfma_f32_16x16x32_bf16 v[172:175], v[92:95], v[104:107], v[172:175]
    ds_read_b128 v[104:107], v7 offset:36864
    v_mfma_f32_16x16x32_bf16 v[188:191], v[92:95], v[108:111], v[188:191]
    ds_read_b64_tr_b16 v[70:71], v6 offset:33792
    s_add_u32 s67, s64, 3899392
    v_mfma_f32_16x16x32_bf16 v[184:187], v[88:91], v[108:111], v[184:187]
    v_mfma_f32_16x16x32_bf16 v[180:183], v[84:87], v[108:111], v[180:183]
    ds_read_b64_tr_b16 v[72:73], v5 offset:40960
    buffer_load_dwordx4 v11, s[24:27], s67 offen  lds
    v_mfma_f32_16x16x32_bf16 v[176:179], v[80:83], v[108:111], v[176:179]
    ds_read_b128 v[108:111], v7 offset:38912
    v_mfma_f32_16x16x32_bf16 v[192:195], v[80:83], v[112:115], v[192:195]
    ds_read_b64_tr_b16 v[74:75], v5 offset:41984
    s_add_u32 m0, s66, 65536
    v_mfma_f32_16x16x32_bf16 v[196:199], v[84:87], v[112:115], v[196:199]
    v_mfma_f32_16x16x32_bf16 v[200:203], v[88:91], v[112:115], v[200:203]
    ds_read_b64_tr_b16 v[76:77], v6 offset:40960
    s_add_u32 s67, s65, 1152
    v_mfma_f32_16x16x32_bf16 v[204:207], v[92:95], v[112:115], v[204:207]
    ds_read_b128 v[112:115], v7 offset:40960
    v_mfma_f32_16x16x32_bf16 v[220:223], v[92:95], v[116:119], v[220:223]
    ds_read_b64_tr_b16 v[78:79], v6 offset:41984
    buffer_load_dwordx4 v12, s[28:31], s67 offen  lds
    v_mfma_f32_16x16x32_bf16 v[216:219], v[88:91], v[116:119], v[216:219]
    v_mfma_f32_16x16x32_bf16 v[212:215], v[84:87], v[116:119], v[212:215]
    s_add_u32 m0, s66, 73728
    v_mfma_f32_16x16x32_bf16 v[208:211], v[80:83], v[116:119], v[208:211]
    ds_read_b128 v[116:119], v7 offset:43008
    v_mfma_f32_16x16x32_bf16 v[224:227], v[80:83], v[120:123], v[224:227]
    s_add_u32 s67, s65, 132224
    v_mfma_f32_16x16x32_bf16 v[228:231], v[84:87], v[120:123], v[228:231]
    v_mfma_f32_16x16x32_bf16 v[232:235], v[88:91], v[120:123], v[232:235]
    buffer_load_dwordx4 v12, s[28:31], s67 offen  lds
    v_mfma_f32_16x16x32_bf16 v[236:239], v[92:95], v[120:123], v[236:239]
    ds_read_b128 v[120:123], v7 offset:45056
    v_mfma_f32_16x16x32_bf16 v[252:255], v[92:95], v[124:127], v[252:255]
    s_cmp_eq_u32 s69, 13
    s_cbranch_scc1 L_y13
L_x13:
    v_mfma_f32_16x16x32_bf16 v[248:251], v[88:91], v[124:127], v[248:251]
    v_mfma_f32_16x16x32_bf16 v[244:247], v[84:87], v[124:127], v[244:247]
    v_mfma_f32_16x16x32_bf16 v[240:243], v[80:83], v[124:127], v[240:243]
    ds_read_b128 v[124:127], v7 offset:47104
    s_waitcnt lgkmcnt(3)
    v_mfma_f32_16x16x32_bf16 v[128:131], v[64:67], v[96:99], v[128:131]
    v_mfma_f32_16x16x32_bf16 v[132:135], v[68:71], v[96:99], v[132:135]
    v_mfma_f32_16x16x32_bf16 v[136:139], v[72:75], v[96:99], v[136:139]
    v_mfma_f32_16x16x32_bf16 v[140:143], v[76:79], v[96:99], v[140:143]
    s_waitcnt vmcnt(10) lgkmcnt(0)
    s_barrier
    v_mfma_f32_16x16x32_bf16 v[156:159], v[76:79], v[100:103], v[156:159]
    ds_read_b128 v[96:99], v8 offset:32768
    s_add_u32 m0, s66, 32768
    v_mfma_f32_16x16x32_bf16 v[152:155], v[72:75], v[100:103], v[152:155]
    v_mfma_f32_16x16x32_bf16 v[148:151], v[68:71], v[100:103], v[148:151]
    ds_read_b64_tr_b16 v[80:81], v5 offset:49152
    s_add_u32 s67, s64, 4128768
    v_mfma_f32_16x16x32_bf16 v[144:147], v[64:67], v[100:103], v[144:147]
    ds_read_b128 v[100:103], v8 offset:34816
    v_mfma_f32_16x16x32_bf16 v[160:163], v[64:67], v[104:107], v[160:163]
    ds_read_b64_tr_b16 v[82:83], v5 offset:50176
    buffer_load_dwordx4 v11, s[20:23], s67 offen  lds
    v_mfma_f32_16x16x32_bf16 v[164:167], v[68:71], v[104:107], v[164:167]
    v_mfma_f32_16x16x32_bf16 v[168:171], v[72:75], v[104:107], v[168:171]
    ds_read_b64_tr_b16 v[84:85], v6 offset:49152
    s_add_u32 m0, s66, 40960
    v_mfma_f32_16x16x32_bf16 v[172:175], v[76:79], v[104:107], v[172:175]
    ds_read_b128 v[104:107], v8 offset:36864
    v_mfma_f32_16x16x32_bf16 v[188:191], v[76:79], v[108:111], v[188:191]
    ds_read_b64_tr_b16 v[86:87], v6 offset:50176
    s_add_u32 s67, s64, 4128768
    v_mfma_f32_16x16x32_bf16 v[184:187], v[72:75], v[108:111], v[184:187]
    v_mfma_f32_16x16x32_bf16 v[180:183], v[68:71], v[108:111], v[180:183]
    ds_read_b64_tr_b16 v[88:89], v5 offset:57344
    buffer_load_dwordx4 v11, s[24:27], s67 offen  lds
    v_mfma_f32_16x16x32_bf16 v[176:179], v[64:67], v[108:111], v[176:179]
    ds_read_b128 v[108:111], v8 offset:38912
    v_mfma_f32_16x16x32_bf16 v[192:195], v[64:67], v[112:115], v[192:195]
    ds_read_b64_tr_b16 v[90:91], v5 offset:58368
    s_add_u32 m0, s66, 81920
    v_mfma_f32_16x16x32_bf16 v[196:199], v[68:71], v[112:115], v[196:199]
    v_mfma_f32_16x16x32_bf16 v[200:203], v[72:75], v[112:115], v[200:203]
    ds_read_b64_tr_b16 v[92:93], v6 offset:57344
    s_add_u32 s67, s65, 263296
    v_mfma_f32_16x16x32_bf16 v[204:207], v[76:79], v[112:115], v[204:207]
    ds_read_b128 v[112:115], v8 offset:40960
    v_mfma_f32_16x16x32_bf16 v[220:223], v[76:79], v[116:119], v[220:223]
    ds_read_b64_tr_b16 v[94:95], v6 offset:58368
    buffer_load_dwordx4 v12, s[28:31], s67 offen  lds
    v_mfma_f32_16x16x32_bf16 v[216:219], v[72:75], v[116:119], v[216:219]
    v_mfma_f32_16x16x32_bf16 v[212:215], v[68:71], v[116:119], v[212:215]
    s_add_u32 m0, s66, 90112
    v_mfma_f32_16x16x32_bf16 v[208:211], v[64:67], v[116:119], v[208:211]
    ds_read_b128 v[116:119], v8 offset:43008
    v_mfma_f32_16x16x32_bf16 v[224:227], v[64:67], v[120:123], v[224:227]
    s_add_u32 s67, s65, 394368
    v_mfma_f32_16x16x32_bf16 v[228:231], v[68:71], v[120:123], v[228:231]
    v_mfma_f32_16x16x32_bf16 v[232:235], v[72:75], v[120:123], v[232:235]
    buffer_load_dwordx4 v12, s[28:31], s67 offen  lds
    v_mfma_f32_16x16x32_bf16 v[236:239], v[76:79], v[120:123], v[236:239]
    ds_read_b128 v[120:123], v8 offset:45056
    v_mfma_f32_16x16x32_bf16 v[252:255], v[76:79], v[124:127], v[252:255]
    s_cmp_eq_u32 s69, 14
    s_cbranch_scc1 L_y14
L_x14:
    v_mfma_f32_16x16x32_bf16 v[248:251], v[72:75], v[124:127], v[248:251]
    v_mfma_f32_16x16x32_bf16 v[244:247], v[68:71], v[124:127], v[244:247]
    v_mfma_f32_16x16x32_bf16 v[240:243], v[64:67], v[124:127], v[240:243]
    ds_read_b128 v[124:127], v8 offset:47104
    s_waitcnt lgkmcnt(3)
    v_mfma_f32_16x16x32_bf16 v[128:131], v[80:83], v[96:99], v[128:131]
    v_mfma_f32_16x16x32_bf16 v[132:135], v[84:87], v[96:99], v[132:135]
    v_mfma_f32_16x16x32_bf16 v[136:139], v[88:91], v[96:99], v[136:139]
    v_mfma_f32_16x16x32_bf16 v[140:143], v[92:95], v[96:99], v[140:143]
    s_waitcnt vmcnt(8) lgkmcnt(0)
    s_barrier
    v_mfma_f32_16x16x32_bf16 v[156:159], v[92:95], v[100:103], v[156:159]
    ds_read_b128 v[96:99], v9 offset:0
    s_add_u32 m0, s66, 49152
    v_mfma_f32_16x16x32_bf16 v[152:155], v[88:91], v[100:103], v[152:155]
    v_mfma_f32_16x16x32_bf16 v[148:151], v[84:87], v[100:103], v[148:151]
    ds_read_b64_tr_b16 v[64:65], v5 offset:0
    s_add_u32 s67, s64, 4358144
    v_mfma_f32_16x16x32_bf16 v[144:147], v[80:83], v[100:103], v[144:147]
    ds_read_b128 v[100:103], v9 offset:2048
    v_mfma_f32_16x16x32_bf16 v[160:163], v[80:83], v[104:107], v[160:163]
    ds_read_b64_tr_b16 v[66:67], v5 offset:1024
    buffer_load_dwordx4 v11, s[20:23], s67 offen  lds
    v_mfma_f32_16x16x32_bf16 v[164:167], v[84:87], v[104:107], v[164:167]
    v_mfma_f32_16x16x32_bf16 v[168:171], v[88:91], v[104:107], v[168:171]
    ds_read_b64_tr_b16 v[68:69], v6 offset:0
    s_add_u32 m0, s66, 57344
    v_mfma_f32_16x16x32_bf16 v[172:175], v[92:95], v[104:107], v[172:175]
    ds_read_b128 v[104:107], v9 offset:4096
    v_mfma_f32_16x16x32_bf16 v[188:191], v[92:95], v[108:111], v[188:191]
    ds_read_b64_tr_b16 v[70:71], v6 offset:1024
    s_add_u32 s67, s64, 4358144
    v_mfma_f32_16x16x32_bf16 v[184:187], v[88:91], v[108:111], v[184:187]
    v_mfma_f32_16x16x32_bf16 v[180:183], v[84:87], v[108:111], v[180:183]
    ds_read_b64_tr_b16 v[72:73], v5 offset:8192
    buffer_load_dwordx4 v11, s[24:27], s67 offen  lds
    v_mfma_f32_16x16x32_bf16 v[176:179], v[80:83], v[108:111], v[176:179]
    ds_read_b128 v[108:111], v9 offset:6144
    v_mfma_f32_16x16x32_bf16 v[192:195], v[80:83], v[112:115], v[192:195]
    ds_read_b64_tr_b16 v[74:75], v5 offset:9216
    s_add_u32 m0, s66, 98304
    v_mfma_f32_16x16x32_bf16 v[196:199], v[84:87], v[112:115], v[196:199]
    v_mfma_f32_16x16x32_bf16 v[200:203], v[88:91], v[112:115], v[200:203]
    ds_read_b64_tr_b16 v[76:77], v6 offset:8192
    s_add_u32 s67, s65, 1280
    v_mfma_f32_16x16x32_bf16 v[204:207], v[92:95], v[112:115], v[204:207]
    ds_read_b128 v[112:115], v9 offset:8192
    v_mfma_f32_16x16x32_bf16 v[220:223], v[92:95], v[116:119], v[220:223]
    ds_read_b64_tr_b16 v[78:79], v6 offset:9216
    buffer_load_dwordx4 v12, s[28:31], s67 offen  lds
    v_mfma_f32_16x16x32_bf16 v[216:219], v[88:91], v[116:119], v[216:219]
    v_mfma_f32_16x16x32_bf16 v[212:215], v[84:87], v[116:119], v[212:215]
    s_add_u32 m0, s66, 106496
    v_mfma_f32_16x16x32_bf16 v[208:211], v[80:83], v[116:119], v[208:211]
    ds_read_b128 v[116:119], v9 offset:10240
    v_mfma_f32_16x16x32_bf16 v[224:227], v[80:83], v[120:123], v[224:227]
    s_add_u32 s67, s65, 132352
    v_mfma_f32_16x16x32_bf16 v[228:231], v[84:87], v[120:123], v[228:231]
    v_mfma_f32_16x16x32_bf16 v[232:235], v[88:91], v[120:123], v[232:235]
    buffer_load_dwordx4 v12, s[28:31], s67 offen  lds
    v_mfma_f32_16x16x32_bf16 v[236:239], v[92:95], v[120:123], v[236:239]
    ds_read_b128 v[120:123], v9 offset:12288
    v_mfma_f32_16x16x32_bf16 v[252:255], v[92:95], v[124:127], v[252:255]
    s_cmp_eq_u32 s68, 15
    s_cbranch_scc1 L_y15
L_x15:
    v_mfma_f32_16x16x32_bf16 v[248:251], v[88:91], v[124:127], v[248:251]
    v_mfma_f32_16x16x32_bf16 v[244:247], v[84:87], v[124:127], v[244:247]
    v_mfma_f32_16x16x32_bf16 v[240:243], v[80:83], v[124:127], v[240:243]
    ds_read_b128 v[124:127], v9 offset:14336
    s_waitcnt lgkmcnt(3)
    v_mfma_f32_16x16x32_bf16 v[128:131], v[64:67], v[96:99], v[128:131]
    v_mfma_f32_16x16x32_bf16 v[132:135], v[68:71], v[96:99], v[132:135]
    v_mfma_f32_16x16x32_bf16 v[136:139], v[72:75], v[96:99], v[136:139]
    v_mfma_f32_16x16x32_bf16 v[140:143], v[76:79], v[96:99], v[140:143]
    s_waitcnt vmcnt(10) lgkmcnt(0)
    s_barrier
    v_mfma_f32_16x16x32_bf16 v[156:159], v[76:79], v[100:103], v[156:159]
    ds_read_b128 v[96:99], v10 offset:0
    s_add_u32 m0, s66, 0
    v_mfma_f32_16x16x32_bf16 v[152:155], v[72:75], v[100:103], v[152:155]
    v_mfma_f32_16x16x32_bf16 v[148:151], v[68:71], v[100:103], v[148:151]
    ds_read_b64_tr_b16 v[80:81], v5 offset:16384
    s_add_u32 s67, s64, 4587520
    v_mfma_f32_16x16x32_bf16 v[144:147], v[64:67], v[100:103], v[144:147]
    ds_read_b128 v[100:103], v10 offset:2048
    v_mfma_f32_16x16x32_bf16 v[160:163], v[64:67], v[104:107], v[160:163]
    ds_read_b64_tr_b16 v[82:83], v5 offset:17408
    buffer_load_dwordx4 v11, s[20:23], s67 offen  lds
    v_mfma_f32_16x16x32_bf16 v[164:167], v[68:71], v[104:107], v[164:167]
    v_mfma_f32_16x16x32_bf16 v[168:171], v[72:75], v[104:107], v[168:171]
    ds_read_b64_tr_b16 v[84:85], v6 offset:16384
    s_add_u32 m0, s66, 8192
    v_mfma_f32_16x16x32_bf16 v[172:175], v[76:79], v[104:107], v[172:175]
    ds_read_b128 v[104:107], v10 offset:4096
    v_mfma_f32_16x16x32_bf16 v[188:191], v[76:79], v[108:111], v[188:191]
    ds_read_b64_tr_b16 v[86:87], v6 offset:17408
    s_add_u32 s67, s64, 4587520
    v_mfma_f32_16x16x32_bf16 v[184:187], v[72:75], v[108:111], v[184:187]
    v_mfma_f32_16x16x32_bf16 v[180:183], v[68:71], v[108:111], v[180:183]
    ds_read_b64_tr_b16 v[88:89], v5 offset:24576
    buffer_load_dwordx4 v11, s[24:27], s67 offen  lds
    v_mfma_f32_16x16x32_bf16 v[176:179], v[64:67], v[108:111], v[176:179]
    ds_read_b128 v[108:111], v10 offset:6144
    v_mfma_f32_16x16x32_bf16 v[192:195], v[64:67], v[112:115], v[192:195]
    ds_read_b64_tr_b16 v[90:91], v5 offset:25600
    s_add_u32 m0, s66, 114688
    v_mfma_f32_16x16x32_bf16 v[196:199], v[68:71], v[112:115], v[196:199]
    v_mfma_f32_16x16x32_bf16 v[200:203], v[72:75], v[112:115], v[200:203]
    ds_read_b64_tr_b16 v[92:93], v6 offset:24576
    s_add_u32 s67, s65, 263424
    v_mfma_f32_16x16x32_bf16 v[204:207], v[76:79], v[112:115], v[204:207]
    ds_read_b128 v[112:115], v10 offset:8192
    v_mfma_f32_16x16x32_bf16 v[220:223], v[76:79], v[116:119], v[220:223]
    ds_read_b64_tr_b16 v[94:95], v6 offset:25600
    buffer_load_dwordx4 v12, s[28:31], s67 offen  lds
    v_mfma_f32_16x16x32_bf16 v[216:219], v[72:75], v[116:119], v[216:219]
    v_mfma_f32_16x16x32_bf16 v[212:215], v[68:71], v[116:119], v[212:215]
    s_add_u32 m0, s66, 122880
    v_mfma_f32_16x16x32_bf16 v[208:211], v[64:67], v[116:119], v[208:211]
    ds_read_b128 v[116:119], v10 offset:10240
    v_mfma_f32_16x16x32_bf16 v[224:227], v[64:67], v[120:123], v[224:227]
    s_add_u32 s67, s65, 394496
    v_mfma_f32_16x16x32_bf16 v[228:231], v[68:71], v[120:123], v[228:231]
    v_mfma_f32_16x16x32_bf16 v[232:235], v[72:75], v[120:123], v[232:235]
    buffer_load_dwordx4 v12, s[28:31], s67 offen  lds
    v_mfma_f32_16x16x32_bf16 v[236:239], v[76:79], v[120:123], v[236:239]
    ds_read_b128 v[120:123], v10 offset:12288
    v_mfma_f32_16x16x32_bf16 v[252:255], v[76:79], v[124:127], v[252:255]
    s_cmp_eq_u32 s68, 16
    s_cbranch_scc1 L_y16
L_x16:
    v_mfma_f32_16x16x32_bf16 v[248:251], v[72:75], v[124:127], v[248:251]
    v_mfma_f32_16x16x32_bf16 v[244:247], v[68:71], v[124:127], v[244:247]
    v_mfma_f32_16x16x32_bf16 v[240:243], v[64:67], v[124:127], v[240:243]
    ds_read_b128 v[124:127], v10 offset:14336
    s_waitcnt lgkmcnt(3)
    v_mfma_f32_16x16x32_bf16 v[128:131], v[80:83], v[96:99], v[128:131]
    v_mfma_f32_16x16x32_bf16 v[132:135], v[84:87], v[96:99], v[132:135]
    v_mfma_f32_16x16x32_bf16 v[136:139], v[88:91], v[96:99], v[136:139]
    v_mfma_f32_16x16x32_bf16 v[140:143], v[92:95], v[96:99], v[140:143]
    s_waitcnt vmcnt(8) lgkmcnt(0)
    s_barrier
    v_mfma_f32_16x16x32_bf16 v[156:159], v[92:95], v[100:103], v[156:159]
    ds_read_b128 v[96:99], v7 offset:0
    s_add_u32 m0, s66, 16384
    v_mfma_f32_16x16x32_bf16 v[152:155], v[88:91], v[100:103], v[152:155]
    v_mfma_f32_16x16x32_bf16 v[148:151], v[84:87], v[100:103], v[148:151]
    ds_read_b64_tr_b16 v[64:65], v5 offset:32768
    s_add_u32 s67, s64, 4816896
    v_mfma_f32_16x16x32_bf16 v[144:147], v[80:83], v[100:103], v[144:147]
    ds_read_b128 v[100:103], v7 offset:2048
    v_mfma_f32_16x16x32_bf16 v[160:163], v[80:83], v[104:107], v[160:163]
    ds_read_b64_tr_b16 v[66:67], v5 offset:33792
    buffer_load_dwordx4 v11, s[20:23], s67 offen  lds
    v_mfma_f32_16x16x32_bf16 v[164:167], v[84:87], v[104:107], v[164:167]
    v_mfma_f32_16x16x32_bf16 v[168:171], v[88:91], v[104:107], v[168:171]
    ds_read_b64_tr_b16 v[68:69], v6 offset:32768
    s_add_u32 m0, s66, 24576
    v_mfma_f32_16x16x32_bf16 v[172:175], v[92:95], v[104:107], v[172:175]
    ds_read_b128 v[104:107], v7 offset:4096
    v_mfma_f32_16x16x32_bf16 v[188:191], v[92:95], v[108:111], v[188:191]
    ds_read_b64_tr_b16 v[70:71], v6 offset:33792
    s_add_u32 s67, s64, 4816896
    v_mfma_f32_16x16x32_bf16 v[184:187], v[88:91], v[108:111], v[184:187]
    v_mfma_f32_16x16x32_bf16 v[180:183], v[84:87], v[108:111], v[180:183]
    ds_read_b64_tr_b16 v[72:73], v5 offset:40960
    buffer_load_dwordx4 v11, s[24:27], s67 offen  lds
    v_mfma_f32_16x16x32_bf16 v[176:179], v[80:83], v[108:111], v[176:179]
    ds_read_b128 v[108:111], v7 offset:6144
    v_mfma_f32_16x16x32_bf16 v[192:195], v[80:83], v[112:115], v[192:195]
    ds_read_b64_tr_b16 v[74:75], v5 offset:41984
    s_add_u32 m0, s66, 131072
    v_mfma_f32_16x16x32_bf16 v[196:199], v[84:87], v[112:115], v[196:199]
    v_mfma_f32_16x16x32_bf16 v[200:203], v[88:91], v[112:115], v[200:203]
    ds_read_b64_tr_b16 v[76:77], v6 offset:40960
    s_add_u32 s67, s65, 1408
    v_mfma_f32_16x16x32_bf16 v[204:207], v[92:95], v[112:115], v[204:207]
    ds_read_b128 v[112:115], v7 offset:8192
    v_mfma_f32_16x16x32_bf16 v[220:223], v[92:95], v[116:119], v[220:223]
    ds_read_b64_tr_b16 v[78:79], v6 offset:41984
    buffer_load_dwordx4 v12, s[28:31], s67 offen  lds
    v_mfma_f32_16x16x32_bf16 v[216:219], v[88:91], v[116:119], v[216:219]
    v_mfma_f32_16x16x32_bf16 v[212:215], v[84:87], v[116:119], v[212:215]
    s_add_u32 m0, s66, 139264
    v_mfma_f32_16x16x32_bf16 v[208:211], v[80:83], v[116:119], v[208:211]
    ds_read_b128 v[116:119], v7 offset:10240
    v_mfma_f32_16x16x32_bf16 v[224:227], v[80:83], v[120:123], v[224:227]
    s_add_u32 s67, s65, 132480
    v_mfma_f32_16x16x32_bf16 v[228:231], v[84:87], v[120:123], v[228:231]
    v_mfma_f32_16x16x32_bf16 v[232:235], v[88:91], v[120:123], v[232:235]
    buffer_load_dwordx4 v12, s[28:31], s67 offen  lds
    v_mfma_f32_16x16x32_bf16 v[236:239], v[92:95], v[120:123], v[236:239]
    ds_read_b128 v[120:123], v7 offset:12288
    v_mfma_f32_16x16x32_bf16 v[252:255], v[92:95], v[124:127], v[252:255]
    s_cmp_eq_u32 s68, 17
    s_cbranch_scc1 L_y17
L_x17:
    v_mfma_f32_16x16x32_bf16 v[248:251], v[88:91], v[124:127], v[248:251]
    v_mfma_f32_16x16x32_bf16 v[244:247], v[84:87], v[124:127], v[244:247]
    v_mfma_f32_16x16x32_bf16 v[240:243], v[80:83], v[124:127], v[240:243]
    ds_read_b128 v[124:127], v7 offset:14336
    s_waitcnt lgkmcnt(3)
    v_mfma_f32_16x16x32_bf16 v[128:131], v[64:67], v[96:99], v[128:131]
    v_mfma_f32_16x16x32_bf16 v[132:135], v[68:71], v[96:99], v[132:135]
    v_mfma_f32_16x16x32_bf16 v[136:139], v[72:75], v[96:99], v[136:139]
    v_mfma_f32_16x16x32_bf16 v[140:143], v[76:79], v[96:99], v[140:143]
    s_waitcnt vmcnt(10) lgkmcnt(0)
    s_barrier
    v_mfma_f32_16x16x32_bf16 v[156:159], v[76:79], v[100:103], v[156:159]
    ds_read_b128 v[96:99], v8 offset:0
    v_mov_b32 v30, 16
    v_mfma_f32_16x16x32_bf16 v[152:155], v[72:75], v[100:103], v[152:155]
    s_cmp_eq_u32 s3, 0
    v_mfma_f32_16x16x32_bf16 v[148:151], v[68:71], v[100:103], v[148:151]
    ds_read_b64_tr_b16 v[80:81], v5 offset:49152
    v_mfma_f32_16x16x32_bf16 v[144:147], v[64:67], v[100:103], v[144:147]
    s_cselect_b32 s70, 0, 0x20000000
    ds_read_b128 v[100:103], v8 offset:2048
    v_mfma_f32_16x16x32_bf16 v[160:163], v[64:67], v[104:107], v[160:163]
    ds_read_b64_tr_b16 v[82:83], v5 offset:50176
    buffer_load_dword v31, v30, s[36:39], s70 offen sc1
    v_mfma_f32_16x16x32_bf16 v[164:167], v[68:71], v[104:107], v[164:167]
    v_mfma_f32_16x16x32_bf16 v[168:171], v[72:75], v[104:107], v[168:171]
    ds_read_b64_tr_b16 v[84:85], v6 offset:49152
    s_add_u32 m0, s66, 32768
    v_mfma_f32_16x16x32_bf16 v[172:175], v[76:79], v[104:107], v[172:175]
    s_add_u32 s67, s64, 5046272
    ds_read_b128 v[104:107], v8 offset:4096
    v_mfma_f32_16x16x32_bf16 v[188:191], v[76:79], v[108:111], v[188:191]
    ds_read_b64_tr_b16 v[86:87], v6 offset:50176
    v_mfma_f32_16x16x32_bf16 v[184:187], v[72:75], v[108:111], v[184:187]
    buffer_load_dwordx4 v11, s[20:23], s67 offen  lds
    v_mfma_f32_16x16x32_bf16 v[180:183], v[68:71], v[108:111], v[180:183]
    ds_read_b64_tr_b16 v[88:89], v5 offset:57344
    v_mfma_f32_16x16x32_bf16 v[176:179], v[64:67], v[108:111], v[176:179]
    s_add_u32 m0, s66, 40960
    ds_read_b128 v[108:111], v8 offset:6144
    v_mfma_f32_16x16x32_bf16 v[192:195], v[64:67], v[112:115], v[192:195]
    ds_read_b64_tr_b16 v[90:91], v5 offset:58368
    s_add_u32 s67, s64, 5046272
    v_mfma_f32_16x16x32_bf16 v[196:199], v[68:71], v[112:115], v[196:199]
    v_mfma_f32_16x16x32_bf16 v[200:203], v[72:75], v[112:115], v[200:203]
    ds_read_b64_tr_b16 v[92:93], v6 offset:57344
    buffer_load_dwordx4 v11, s[24:27], s67 offen  lds
    v_mfma_f32_16x16x32_bf16 v[204:207], v[76:79], v[112:115], v[204:207]
    s_add_u32 m0, s66, 147456
    ds_read_b128 v[112:115], v8 offset:8192
    v_mfma_f32_16x16x32_bf16 v[220:223], v[76:79], v[116:119], v[220:223]
    ds_read_b64_tr_b16 v[94:95], v6 offset:58368
    v_mfma_f32_16x16x32_bf16 v[216:219], v[72:75], v[116:119], v[216:219]
    s_add_u32 s67, s65, 263552
    v_mfma_f32_16x16x32_bf16 v[212:215], v[68:71], v[116:119], v[212:215]
    v_mfma_f32_16x16x32_bf16 v[208:211], v[64:67], v[116:119], v[208:211]
    buffer_load_dwordx4 v12, s[28:31], s67 offen  lds
    ds_read_b128 v[116:119], v8 offset:10240
    v_mfma_f32_16x16x32_bf16 v[224:227], v[64:67], v[120:123], v[224:227]
    s_add_u32 m0, s66, 155648
    v_mfma_f32_16x16x32_bf16 v[228:231], v[68:71], v[120:123], v[228:231]
    v_mfma_f32_16x16x32_bf16 v[232:235], v[72:75], v[120:123], v[232:235]
    s_add_u32 s67, s65, 394624
    v_mfma_f32_16x16x32_bf16 v[236:239], v[76:79], v[120:123], v[236:239]
    buffer_load_dwordx4 v12, s[28:31], s67 offen  lds
    ds_read_b128 v[120:123], v8 offset:12288
    v_mfma_f32_16x16x32_bf16 v[252:255], v[76:79], v[124:127], v[252:255]
    v_mfma_f32_16x16x32_bf16 v[248:251], v[72:75], v[124:127], v[248:251]
    s_cmp_eq_u32 s68, 18
    s_cbranch_scc1 L_y18
L_x18:
    v_mfma_f32_16x16x32_bf16 v[244:247], v[68:71], v[124:127], v[244:247]
    v_mfma_f32_16x16x32_bf16 v[240:243], v[64:67], v[124:127], v[240:243]
    ds_read_b128 v[124:127], v8 offset:14336
    s_waitcnt lgkmcnt(3)
    v_mfma_f32_16x16x32_bf16 v[128:131], v[80:83], v[96:99], v[128:131]
    v_mfma_f32_16x16x32_bf16 v[132:135], v[84:87], v[96:99], v[132:135]
    v_mfma_f32_16x16x32_bf16 v[136:139], v[88:91], v[96:99], v[136:139]
    v_mfma_f32_16x16x32_bf16 v[140:143], v[92:95], v[96:99], v[140:143]
    s_waitcnt vmcnt(9) lgkmcnt(0)
    s_barrier
    v_mfma_f32_16x16x32_bf16 v[156:159], v[92:95], v[100:103], v[156:159]
    ds_read_b128 v[96:99], v7 offset:32768
    s_add_u32 m0, s66, 49152
    v_mfma_f32_16x16x32_bf16 v[152:155], v[88:91], v[100:103], v[152:155]
    v_mfma_f32_16x16x32_bf16 v[148:151], v[84:87], v[100:103], v[148:151]
    ds_read_b64_tr_b16 v[64:65], v5 offset:0
    s_add_u32 s67, s64, 5275648
    v_mfma_f32_16x16x32_bf16 v[144:147], v[80:83], v[100:103], v[144:147]
    ds_read_b128 v[100:103], v7 offset:34816
    v_mfma_f32_16x16x32_bf16 v[160:163], v[80:83], v[104:107], v[160:163]
    ds_read_b64_tr_b16 v[66:67], v5 offset:1024
    buffer_load_dwordx4 v11, s[20:23], s67 offen  lds
    v_mfma_f32_16x16x32_bf16 v[164:167], v[84:87], v[104:107], v[164:167]
    v_mfma_f32_16x16x32_bf16 v[168:171], v[88:91], v[104:107], v[168:171]
    ds_read_b64_tr_b16 v[68:69], v6 offset:0
    s_add_u32 m0, s66, 57344
    v_mfma_f32_16x16x32_bf16 v[172:175], v[92:95], v[104:107], v[172:175]
    ds_read_b128 v[104:107], v7 offset:36864
    v_mfma_f32_16x16x32_bf16 v[188:191], v[92:95], v[108:111], v[188:191]
    ds_read_b64_tr_b16 v[70:71], v6 offset:1024
    s_add_u32 s67, s64, 5275648
    v_mfma_f32_16x16x32_bf16 v[184:187], v[88:91], v[108:111], v[184:187]
    v_mfma_f32_16x16x32_bf16 v[180:183], v[84:87], v[108:111], v[180:183]
    ds_read_b64_tr_b16 v[72:73], v5 offset:8192
    buffer_load_dwordx4 v11, s[24:27], s67 offen  lds
    v_mfma_f32_16x16x32_bf16 v[176:179], v[80:83], v[108:111], v[176:179]
    ds_read_b128 v[108:111], v7 offset:38912
    v_mfma_f32_16x16x32_bf16 v[192:195], v[80:83], v[112:115], v[192:195]
    ds_read_b64_tr_b16 v[74:75], v5 offset:9216
    s_add_u32 m0, s66, 65536
    v_mfma_f32_16x16x32_bf16 v[196:199], v[84:87], v[112:115], v[196:199]
    v_mfma_f32_16x16x32_bf16 v[200:203], v[88:91], v[112:115], v[200:203]
    ds_read_b64_tr_b16 v[76:77], v6 offset:8192
    s_add_u32 s67, s65, 1536
    v_mfma_f32_16x16x32_bf16 v[204:207], v[92:95], v[112:115], v[204:207]
    ds_read_b128 v[112:115], v7 offset:40960
    v_mfma_f32_16x16x32_bf16 v[220:223], v[92:95], v[116:119], v[220:223]
    ds_read_b64_tr_b16 v[78:79], v6 offset:9216
    buffer_load_dwordx4 v12, s[28:31], s67 offen  lds
    v_mfma_f32_16x16x32_bf16 v[216:219], v[88:91], v[116:119], v[216:219]
    v_mfma_f32_16x16x32_bf16 v[212:215], v[84:87], v[116:119], v[212:215]
    s_add_u32 m0, s66, 73728
    v_mfma_f32_16x16x32_bf16 v[208:211], v[80:83], v[116:119], v[208:211]
    ds_read_b128 v[116:119], v7 offset:43008
    v_mfma_f32_16x16x32_bf16 v[224:227], v[80:83], v[120:123], v[224:227]
    s_add_u32 s67, s65, 132608
    v_mfma_f32_16x16x32_bf16 v[228:231], v[84:87], v[120:123], v[228:231]
    v_mfma_f32_16x16x32_bf16 v[232:235], v[88:91], v[120:123], v[232:235]
    buffer_load_dwordx4 v12, s[28:31], s67 offen  lds
    v_mfma_f32_16x16x32_bf16 v[236:239], v[92:95], v[120:123], v[236:239]
    ds_read_b128 v[120:123], v7 offset:45056
    v_mfma_f32_16x16x32_bf16 v[252:255], v[92:95], v[124:127], v[252:255]
    s_cmp_eq_u32 s68, 19
    s_cbranch_scc1 L_y19
L_x19:
    v_mfma_f32_16x16x32_bf16 v[248:251], v[88:91], v[124:127], v[248:251]
    v_mfma_f32_16x16x32_bf16 v[244:247], v[84:87], v[124:127], v[244:247]
    v_mfma_f32_16x16x32_bf16 v[240:243], v[80:83], v[124:127], v[240:243]
    ds_read_b128 v[124:127], v7 offset:47104
    s_waitcnt lgkmcnt(3)
    v_mfma_f32_16x16x32_bf16 v[128:131], v[64:67], v[96:99], v[128:131]
    v_mfma_f32_16x16x32_bf16 v[132:135], v[68:71], v[96:99], v[132:135]
    v_mfma_f32_16x16x32_bf16 v[136:139], v[72:75], v[96:99], v[136:139]
    v_mfma_f32_16x16x32_bf16 v[140:143], v[76:79], v[96:99], v[140:143]
    s_waitcnt vmcnt(11) lgkmcnt(0)
    s_barrier
    v_mfma_f32_16x16x32_bf16 v[156:159], v[76:79], v[100:103], v[156:159]
    ds_read_b128 v[96:99], v8 offset:32768
    s_add_u32 m0, s66, 0
    v_mfma_f32_16x16x32_bf16 v[152:155], v[72:75], v[100:103], v[152:155]
    v_mfma_f32_16x16x32_bf16 v[148:151], v[68:71], v[100:103], v[148:151]
    ds_read_b64_tr_b16 v[80:81], v5 offset:16384
    s_add_u32 s67, s64, 5505024
    v_mfma_f32_16x16x32_bf16 v[144:147], v[64:67], v[100:103], v[144:147]
    ds_read_b128 v[100:103], v8 offset:34816
    v_mfma_f32_16x16x32_bf16 v[160:163], v[64:67], v[104:107], v[160:163]
    ds_read_b64_tr_b16 v[82:83], v5 offset:17408
    buffer_load_dwordx4 v11, s[20:23], s67 offen  lds
    v_mfma_f32_16x16x32_bf16 v[164:167], v[68:71], v[104:107], v[164:167]
    v_mfma_f32_16x16x32_bf16 v[168:171], v[72:75], v[104:107], v[168:171]
    ds_read_b64_tr_b16 v[84:85], v6 offset:16384
    s_add_u32 m0, s66, 8192
    v_mfma_f32_16x16x32_bf16 v[172:175], v[76:79], v[104:107], v[172:175]
    ds_read_b128 v[104:107], v8 offset:36864
    v_mfma_f32_16x16x32_bf16 v[188:191], v[76:79], v[108:111], v[188:191]
    ds_read_b64_tr_b16 v[86:87], v6 offset:17408
    s_add_u32 s67, s64, 5505024
    v_mfma_f32_16x16x32_bf16 v[184:187], v[72:75], v[108:111], v[184:187]
    v_mfma_f32_16x16x32_bf16 v[180:183], v[68:71], v[108:111], v[180:183]
    ds_read_b64_tr_b16 v[88:89], v5 offset:24576
    buffer_load_dwordx4 v11, s[24:27], s67 offen  lds
    v_mfma_f32_16x16x32_bf16 v[176:179], v[64:67], v[108:111], v[176:179]
    ds_read_b128 v[108:111], v8 offset:38912
    v_mfma_f32_16x16x32_bf16 v[192:195], v[64:67], v[112:115], v[192:195]
    ds_read_b64_tr_b16 v[90:91], v5 offset:25600
    s_add_u32 m0, s66, 81920
    v_mfma_f32_16x16x32_bf16 v[196:199], v[68:71], v[112:115], v[196:199]
    v_mfma_f32_16x16x32_bf16 v[200:203], v[72:75], v[112:115], v[200:203]
    ds_read_b64_tr_b16 v[92:93], v6 offset:24576
    s_add_u32 s67, s65, 263680
    v_mfma_f32_16x16x32_bf16 v[204:207], v[76:79], v[112:115], v[204:207]
    ds_read_b128 v[112:115], v8 offset:40960
    v_mfma_f32_16x16x32_bf16 v[220:223], v[76:79], v[116:119], v[220:223]
    ds_read_b64_tr_b16 v[94:95], v6 offset:25600
    buffer_load_dwordx4 v12, s[28:31], s67 offen  lds
    v_mfma_f32_16x16x32_bf16 v[216:219], v[72:75], v[116:119], v[216:219]
    v_mfma_f32_16x16x32_bf16 v[212:215], v[68:71], v[116:119], v[212:215]
    s_add_u32 m0, s66, 90112
    v_mfma_f32_16x16x32_bf16 v[208:211], v[64:67], v[116:119], v[208:211]
    ds_read_b128 v[116:119], v8 offset:43008
    v_mfma_f32_16x16x32_bf16 v[224:227], v[64:67], v[120:123], v[224:227]
    s_add_u32 s67, s65, 394752
    v_mfma_f32_16x16x32_bf16 v[228:231], v[68:71], v[120:123], v[228:231]
    v_mfma_f32_16x16x32_bf16 v[232:235], v[72:75], v[120:123], v[232:235]
    buffer_load_dwordx4 v12, s[28:31], s67 offen  lds
    v_mfma_f32_16x16x32_bf16 v[236:239], v[76:79], v[120:123], v[236:239]
    ds_read_b128 v[120:123], v8 offset:45056
    v_mfma_f32_16x16x32_bf16 v[252:255], v[76:79], v[124:127], v[252:255]
    s_cmp_eq_u32 s68, 20
    s_cbranch_scc1 L_y20
L_x20:
    v_mfma_f32_16x16x32_bf16 v[248:251], v[72:75], v[124:127], v[248:251]
    v_mfma_f32_16x16x32_bf16 v[244:247], v[68:71], v[124:127], v[244:247]
    v_mfma_f32_16x16x32_bf16 v[240:243], v[64:67], v[124:127], v[240:243]
    ds_read_b128 v[124:127], v8 offset:47104
    s_waitcnt lgkmcnt(3)
    v_mfma_f32_16x16x32_bf16 v[128:131], v[80:83], v[96:99], v[128:131]
    v_mfma_f32_16x16x32_bf16 v[132:135], v[84:87], v[96:99], v[132:135]
    v_mfma_f32_16x16x32_bf16 v[136:139], v[88:91], v[96:99], v[136:139]
    v_mfma_f32_16x16x32_bf16 v[140:143], v[92:95], v[96:99], v[140:143]
    s_waitcnt vmcnt(8) lgkmcnt(0)
    s_barrier
    v_mfma_f32_16x16x32_bf16 v[156:159], v[92:95], v[100:103], v[156:159]
    ds_read_b128 v[96:99], v9 offset:0
    s_add_u32 m0, s66, 16384
    v_mfma_f32_16x16x32_bf16 v[152:155], v[88:91], v[100:103], v[152:155]
    v_mfma_f32_16x16x32_bf16 v[148:151], v[84:87], v[100:103], v[148:151]
    ds_read_b64_tr_b16 v[64:65], v5 offset:32768
    s_add_u32 s67, s64, 5734400
    v_mfma_f32_16x16x32_bf16 v[144:147], v[80:83], v[100:103], v[144:147]
    ds_read_b128 v[100:103], v9 offset:2048
    v_mfma_f32_16x16x32_bf16 v[160:163], v[80:83], v[104:107], v[160:163]
    ds_read_b64_tr_b16 v[66:67], v5 offset:33792
    buffer_load_dwordx4 v11, s[20:23], s67 offen  lds
    v_mfma_f32_16x16x32_bf16 v[164:167], v[84:87], v[104:107], v[164:167]
    v_mfma_f32_16x16x32_bf16 v[168:171], v[88:91], v[104:107], v[168:171]
    ds_read_b64_tr_b16 v[68:69], v6 offset:32768
    s_add_u32 m0, s66, 24576
    v_mfma_f32_16x16x32_bf16 v[172:175], v[92:95], v[104:107], v[172:175]
    ds_read_b128 v[104:107], v9 offset:4096
    v_mfma_f32_16x16x32_bf16 v[188:191], v[92:95], v[108:111], v[188:191]
    ds_read_b64_tr_b16 v[70:71], v6 offset:33792
    s_add_u32 s67, s64, 5734400
    v_mfma_f32_16x16x32_bf16 v[184:187], v[88:91], v[108:111], v[184:187]
    v_mfma_f32_16x16x32_bf16 v[180:183], v[84:87], v[108:111], v[180:183]
    ds_read_b64_tr_b16 v[72:73], v5 offset:40960
    buffer_load_dwordx4 v11, s[24:27], s67 offen  lds
    v_mfma_f32_16x16x32_bf16 v[176:179], v[80:83], v[108:111], v[176:179]
    ds_read_b128 v[108:111], v9 offset:6144
    v_mfma_f32_16x16x32_bf16 v[192:195], v[80:83], v[112:115], v[192:195]
    ds_read_b64_tr_b16 v[74:75], v5 offset:41984
    s_add_u32 m0, s66, 98304
    v_mfma_f32_16x16x32_bf16 v[196:199], v[84:87], v[112:115], v[196:199]
    v_mfma_f32_16x16x32_bf16 v[200:203], v[88:91], v[112:115], v[200:203]
    ds_read_b64_tr_b16 v[76:77], v6 offset:40960
    s_add_u32 s67, s65, 1664
    v_mfma_f32_16x16x32_bf16 v[204:207], v[92:95], v[112:115], v[204:207]
    ds_read_b128 v[112:115], v9 offset:8192
    v_mfma_f32_16x16x32_bf16 v[220:223], v[92:95], v[116:119], v[220:223]
    ds_read_b64_tr_b16 v[78:79], v6 offset:41984
    buffer_load_dwordx4 v12, s[28:31], s67 offen  lds
    v_mfma_f32_16x16x32_bf16 v[216:219], v[88:91], v[116:119], v[216:219]
    v_mfma_f32_16x16x32_bf16 v[212:215], v[84:87], v[116:119], v[212:215]
    s_add_u32 m0, s66, 106496
    v_mfma_f32_16x16x32_bf16 v[208:211], v[80:83], v[116:119], v[208:211]
    ds_read_b128 v[116:119], v9 offset:10240
    v_mfma_f32_16x16x32_bf16 v[224:227], v[80:83], v[120:123], v[224:227]
    s_add_u32 s67, s65, 132736
    v_mfma_f32_16x16x32_bf16 v[228:231], v[84:87], v[120:123], v[228:231]
    v_mfma_f32_16x16x32_bf16 v[232:235], v[88:91], v[120:123], v[232:235]
    buffer_load_dwordx4 v12, s[28:31], s67 offen  lds
    v_mfma_f32_16x16x32_bf16 v[236:239], v[92:95], v[120:123], v[236:239]
    ds_read_b128 v[120:123], v9 offset:12288
    v_mfma_f32_16x16x32_bf16 v[252:255], v[92:95], v[124:127], v[252:255]
    s_cmp_eq_u32 s68, 21
    s_cbranch_scc1 L_y21
L_x21:
    v_mfma_f32_16x16x32_bf16 v[248:251], v[88:91], v[124:127], v[248:251]
    v_mfma_f32_16x16x32_bf16 v[244:247], v[84:87], v[124:127], v[244:247]
    v_mfma_f32_16x16x32_bf16 v[240:243], v[80:83], v[124:127], v[240:243]
    ds_read_b128 v[124:127], v9 offset:14336
    s_waitcnt lgkmcnt(3)
    v_mfma_f32_16x16x32_bf16 v[128:131], v[64:67], v[96:99], v[128:131]
    v_cmp_gt_u32 vcc, 32, v31
    s_cmp_eq_u32 s3, 0
    s_cselect_b64 s[18:19], vcc, 0
    s_cmp_lg_u64 s[18:19], 0
    s_cbranch_scc1 L_zsl
L_zok:
    v_mfma_f32_16x16x32_bf16 v[132:135], v[68:71], v[96:99], v[132:135]
    v_mfma_f32_16x16x32_bf16 v[136:139], v[72:75], v[96:99], v[136:139]
    v_mfma_f32_16x16x32_bf16 v[140:143], v[76:79], v[96:99], v[140:143]
    s_waitcnt vmcnt(10) lgkmcnt(0)
    s_barrier
    v_mfma_f32_16x16x32_bf16 v[156:159], v[76:79], v[100:103], v[156:159]
    ds_read_b128 v[96:99], v10 offset:0
    s_and_b32 s18, s3, 3
    s_lshl_b32 s18, s18, 5
    v_mfma_f32_16x16x32_bf16 v[152:155], v[72:75], v[100:103], v[152:155]
    s_lshl_b32 s19, s15, 7
    s_add_u32 s18, s18, s19
    v_mfma_f32_16x16x32_bf16 v[148:151], v[68:71], v[100:103], v[148:151]
    ds_read_b64_tr_b16 v[80:81], v5 offset:49152
    s_lshl_b32 s18, s18, 2
    s_add_u32 s18, s18, 4456448
    v_mfma_f32_16x16x32_bf16 v[144:147], v[64:67], v[100:103], v[144:147]
    s_add_u32 s19, s18, 14336
    ds_read_b128 v[100:103], v10 offset:2048
    v_mfma_f32_16x16x32_bf16 v[160:163], v[64:67], v[104:107], v[160:163]
    ds_read_b64_tr_b16 v[82:83], v5 offset:50176
    s_mul_i32 s17, s69, 28672
    s_add_u32 s18, s18, s17
    v_mfma_f32_16x16x32_bf16 v[164:167], v[68:71], v[104:107], v[164:167]
    v_and_b32 v24, 1, v4
    v_lshlrev_b32 v24, 6, v24
    v_mfma_f32_16x16x32_bf16 v[168:171], v[72:75], v[104:107], v[168:171]
    ds_read_b64_tr_b16 v[84:85], v6 offset:49152
    v_lshl_add_u32 v24, v3, 4, v24
    v_mfma_f32_16x16x32_bf16 v[172:175], v[76:79], v[104:107], v[172:175]
    v_and_b32 v25, 2, v4
    v_mul_u32_u24 v25, 7168, v25
    ds_read_b128 v[104:107], v10 offset:4096
    v_mfma_f32_16x16x32_bf16 v[188:191], v[76:79], v[108:111], v[188:191]
    ds_read_b64_tr_b16 v[86:87], v6 offset:50176
    v_add_u32 v24, v24, v25
    s_mov_b32 vcc_lo, 0x00020002
    v_mfma_f32_16x16x32_bf16 v[184:187], v[72:75], v[108:111], v[184:187]
    s_mov_b32 vcc_hi, 0x00020002
    v_cndmask_b32 v20, v48, v52, vcc
    v_mfma_f32_16x16x32_bf16 v[180:183], v[68:71], v[108:111], v[180:183]
    ds_read_b64_tr_b16 v[88:89], v5 offset:57344
    v_cndmask_b32 v21, v49, v53, vcc
    v_mfma_f32_16x16x32_bf16 v[176:179], v[64:67], v[108:111], v[176:179]
    v_cndmask_b32 v22, v50, v54, vcc
    v_cndmask_b32 v23, v51, v55, vcc
    ds_read_b128 v[108:111], v10 offset:6144
    v_mfma_f32_16x16x32_bf16 v[192:195], v[64:67], v[112:115], v[192:195]
    ds_read_b64_tr_b16 v[90:91], v5 offset:58368
    s_mov_b32 vcc_lo, 0x00040004
    s_mov_b32 vcc_hi, 0x00040004
    v_mfma_f32_16x16x32_bf16 v[196:199], v[68:71], v[112:115], v[196:199]
    v_cndmask_b32 v20, v20, v56, vcc
    v_mfma_f32_16x16x32_bf16 v[200:203], v[72:75], v[112:115], v[200:203]
    ds_read_b64_tr_b16 v[92:93], v6 offset:57344
    v_cndmask_b32 v21, v21, v57, vcc
    v_cndmask_b32 v22, v22, v58, vcc
    v_mfma_f32_16x16x32_bf16 v[204:207], v[76:79], v[112:115], v[204:207]
    v_cndmask_b32 v23, v23, v59, vcc
    s_mov_b32 vcc_lo, 0x00080008
    ds_read_b128 v[112:115], v10 offset:8192
    v_mfma_f32_16x16x32_bf16 v[220:223], v[76:79], v[116:119], v[220:223]
    ds_read_b64_tr_b16 v[94:95], v6 offset:58368
    s_mov_b32 vcc_hi, 0x00080008
    v_mfma_f32_16x16x32_bf16 v[216:219], v[72:75], v[116:119], v[216:219]
    v_cndmask_b32 v20, v20, v60, vcc
    v_cndmask_b32 v21, v21, v61, vcc
    v_mfma_f32_16x16x32_bf16 v[212:215], v[68:71], v[116:119], v[212:215]
    v_cndmask_b32 v22, v22, v62, vcc
    v_cndmask_b32 v23, v23, v63, vcc
    v_mfma_f32_16x16x32_bf16 v[208:211], v[64:67], v[116:119], v[208:211]
    s_mov_b32 exec_lo, 0x000f000f
    s_mov_b32 exec_hi, 0x000f000f
    buffer_store_dwordx4 v[20:23], v24, s[32:35], s18 offen sc1
    s_mov_b64 exec, -1
    s_add_u32 m0, s66, 32768
    ds_read_b128 v[116:119], v10 offset:10240
    v_mfma_f32_16x16x32_bf16 v[224:227], v[64:67], v[120:123], v[224:227]
    s_add_u32 s67, s64, 5963776
    v_mfma_f32_16x16x32_bf16 v[228:231], v[68:71], v[120:123], v[228:231]
    buffer_load_dwordx4 v11, s[20:23], s67 offen  lds
    s_add_u32 m0, s66, 40960
    v_mfma_f32_16x16x32_bf16 v[232:235], v[72:75], v[120:123], v[232:235]
    s_add_u32 s67, s64, 5963776
    buffer_load_dwordx4 v11, s[24:27], s67 offen  lds
    v_mfma_f32_16x16x32_bf16 v[236:239], v[76:79], v[120:123], v[236:239]
    s_add_u32 m0, s66, 114688
    ds_read_b128 v[120:123], v10 offset:12288
    v_mfma_f32_16x16x32_bf16 v[252:255], v[76:79], v[124:127], v[252:255]
    s_add_u32 s67, s65, 263808
    buffer_load_dwordx4 v12, s[28:31], s67 offen  lds
    v_mfma_f32_16x16x32_bf16 v[248:251], v[72:75], v[124:127], v[248:251]
    s_add_u32 m0, s66, 122880
    s_add_u32 s67, s65, 394880
    v_mfma_f32_16x16x32_bf16 v[244:247], v[68:71], v[124:127], v[244:247]
    buffer_load_dwordx4 v12, s[28:31], s67 offen  lds
    v_mfma_f32_16x16x32_bf16 v[240:243], v[64:67], v[124:127], v[240:243]
    ds_read_b128 v[124:127], v10 offset:14336
    s_waitcnt lgkmcnt(3)
    v_mfma_f32_16x16x32_bf16 v[128:131], v[80:83], v[96:99], v[128:131]
    v_mfma_f32_16x16x32_bf16 v[132:135], v[84:87], v[96:99], v[132:135]
    v_mfma_f32_16x16x32_bf16 v[136:139], v[88:91], v[96:99], v[136:139]
    v_mfma_f32_16x16x32_bf16 v[140:143], v[92:95], v[96:99], v[140:143]
    s_waitcnt vmcnt(9) lgkmcnt(0)
    s_barrier
    v_mfma_f32_16x16x32_bf16 v[156:159], v[92:95], v[100:103], v[156:159]
    ds_read_b128 v[96:99], v7 offset:0
    s_add_u32 m0, s66, 49152
    v_mfma_f32_16x16x32_bf16 v[152:155], v[88:91], v[100:103], v[152:155]
    v_mfma_f32_16x16x32_bf16 v[148:151], v[84:87], v[100:103], v[148:151]
    ds_read_b64_tr_b16 v[64:65], v5 offset:0
    s_add_u32 s67, s64, 6193152
    v_mfma_f32_16x16x32_bf16 v[144:147], v[80:83], v[100:103], v[144:147]
    ds_read_b128 v[100:103], v7 offset:2048
    v_mfma_f32_16x16x32_bf16 v[160:163], v[80:83], v[104:107], v[160:163]
    ds_read_b64_tr_b16 v[66:67], v5 offset:1024
    buffer_load_dwordx4 v11, s[20:23], s67 offen  lds
    v_mfma_f32_16x16x32_bf16 v[164:167], v[84:87], v[104:107], v[164:167]
    v_mfma_f32_16x16x32_bf16 v[168:171], v[88:91], v[104:107], v[168:171]
    ds_read_b64_tr_b16 v[68:69], v6 offset:0
    s_add_u32 m0, s66, 57344
    v_mfma_f32_16x16x32_bf16 v[172:175], v[92:95], v[104:107], v[172:175]
    ds_read_b128 v[104:107], v7 offset:4096
    v_mfma_f32_16x16x32_bf16 v[188:191], v[92:95], v[108:111], v[188:191]
    ds_read_b64_tr_b16 v[70:71], v6 offset:1024
    v_mfma_f32_16x16x32_bf16 v[184:187], v[88:91], v[108:111], v[184:187]
    s_add_u32 s67, s64, 6193152
    v_mfma_f32_16x16x32_bf16 v[180:183], v[84:87], v[108:111], v[180:183]
    ds_read_b64_tr_b16 v[72:73], v5 offset:8192
    v_mfma_f32_16x16x32_bf16 v[176:179], v[80:83], v[108:111], v[176:179]
    buffer_load_dwordx4 v11, s[24:27], s67 offen  lds
    ds_read_b128 v[108:111], v7 offset:6144
    v_mfma_f32_16x16x32_bf16 v[192:195], v[80:83], v[112:115], v[192:195]
    ds_read_b64_tr_b16 v[74:75], v5 offset:9216
    v_mfma_f32_16x16x32_bf16 v[196:199], v[84:87], v[112:115], v[196:199]
    s_add_u32 m0, s66, 131072
    v_mfma_f32_16x16x32_bf16 v[200:203], v[88:91], v[112:115], v[200:203]
    ds_read_b64_tr_b16 v[76:77], v6 offset:8192
    v_mfma_f32_16x16x32_bf16 v[204:207], v[92:95], v[112:115], v[204:207]
    s_add_u32 s67, s65, 1792
    ds_read_b128 v[112:115], v7 offset:8192
    v_mfma_f32_16x16x32_bf16 v[220:223], v[92:95], v[116:119], v[220:223]
    ds_read_b64_tr_b16 v[78:79], v6 offset:9216
    v_mfma_f32_16x16x32_bf16 v[216:219], v[88:91], v[116:119], v[216:219]
    v_mfma_f32_16x16x32_bf16 v[212:215], v[84:87], v[116:119], v[212:215]
    buffer_load_dwordx4 v12, s[28:31], s67 offen  lds
    v_mfma_f32_16x16x32_bf16 v[208:211], v[80:83], v[116:119], v[208:211]
    ds_read_b128 v[116:119], v7 offset:10240
    v_mfma_f32_16x16x32_bf16 v[224:227], v[80:83], v[120:123], v[224:227]
    s_add_u32 m0, s66, 139264
    v_mfma_f32_16x16x32_bf16 v[228:231], v[84:87], v[120:123], v[228:231]
    v_mfma_f32_16x16x32_bf16 v[232:235], v[88:91], v[120:123], v[232:235]
    s_add_u32 s67, s65, 132864
    v_mfma_f32_16x16x32_bf16 v[236:239], v[92:95], v[120:123], v[236:239]
    ds_read_b128 v[120:123], v7 offset:12288
    v_mfma_f32_16x16x32_bf16 v[252:255], v[92:95], v[124:127], v[252:255]
    buffer_load_dwordx4 v12, s[28:31], s67 offen  lds
    v_mfma_f32_16x16x32_bf16 v[248:251], v[88:91], v[124:127], v[248:251]
    v_mfma_f32_16x16x32_bf16 v[244:247], v[84:87], v[124:127], v[244:247]
    v_mfma_f32_16x16x32_bf16 v[240:243], v[80:83], v[124:127], v[240:243]
    ds_read_b128 v[124:127], v7 offset:14336
    s_waitcnt lgkmcnt(3)
    v_mfma_f32_16x16x32_bf16 v[128:131], v[64:67], v[96:99], v[128:131]
    v_mfma_f32_16x16x32_bf16 v[132:135], v[68:71], v[96:99], v[132:135]
    v_mfma_f32_16x16x32_bf16 v[136:139], v[72:75], v[96:99], v[136:139]
    v_mfma_f32_16x16x32_bf16 v[140:143], v[76:79], v[96:99], v[140:143]
    s_waitcnt vmcnt(11) lgkmcnt(0)
    s_barrier
    v_mfma_f32_16x16x32_bf16 v[156:159], v[76:79], v[100:103], v[156:159]
    ds_read_b128 v[96:99], v8 offset:0
    s_add_u32 m0, s66, 0
    v_mfma_f32_16x16x32_bf16 v[152:155], v[72:75], v[100:103], v[152:155]
    s_add_u32 s67, s64, 6422528
    v_mfma_f32_16x16x32_bf16 v[148:151], v[68:71], v[100:103], v[148:151]
    ds_read_b64_tr_b16 v[80:81], v5 offset:16384
    v_mfma_f32_16x16x32_bf16 v[144:147], v[64:67], v[100:103], v[144:147]
    buffer_load_dwordx4 v11, s[20:23], s67 offen  lds
    ds_read_b128 v[100:103], v8 offset:2048
    v_mfma_f32_16x16x32_bf16 v[160:163], v[64:67], v[104:107], v[160:163]
    ds_read_b64_tr_b16 v[82:83], v5 offset:17408
    s_add_u32 m0, s66, 8192
    v_mfma_f32_16x16x32_bf16 v[164:167], v[68:71], v[104:107], v[164:167]
    v_mfma_f32_16x16x32_bf16 v[168:171], v[72:75], v[104:107], v[168:171]
    ds_read_b64_tr_b16 v[84:85], v6 offset:16384
    s_add_u32 s67, s64, 6422528
    v_mfma_f32_16x16x32_bf16 v[172:175], v[76:79], v[104:107], v[172:175]
    buffer_load_dwordx4 v11, s[24:27], s67 offen  lds
    ds_read_b128 v[104:107], v8 offset:4096
    v_mfma_f32_16x16x32_bf16 v[188:191], v[76:79], v[108:111], v[188:191]
    ds_read_b64_tr_b16 v[86:87], v6 offset:17408
    v_mfma_f32_16x16x32_bf16 v[184:187], v[72:75], v[108:111], v[184:187]
    s_add_u32 m0, s66, 147456
    v_mfma_f32_16x16x32_bf16 v[180:183], v[68:71], v[108:111], v[180:183]
    ds_read_b64_tr_b16 v[88:89], v5 offset:24576
    v_mfma_f32_16x16x32_bf16 v[176:179], v[64:67], v[108:111], v[176:179]
    s_add_u32 s67, s65, 263936
    ds_read_b128 v[108:111], v8 offset:6144
    v_mfma_f32_16x16x32_bf16 v[192:195], v[64:67], v[112:115], v[192:195]
    ds_read_b64_tr_b16 v[90:91], v5 offset:25600
    buffer_load_dwordx4 v12, s[28:31], s67 offen  lds
    v_mfma_f32_16x16x32_bf16 v[196:199], v[68:71], v[112:115], v[196:199]
    v_mfma_f32_16x16x32_bf16 v[200:203], v[72:75], v[112:115], v[200:203]
    ds_read_b64_tr_b16 v[92:93], v6 offset:24576
    s_add_u32 m0, s66, 155648
    v_mfma_f32_16x16x32_bf16 v[204:207], v[76:79], v[112:115], v[204:207]
    s_add_u32 s67, s65, 395008
    ds_read_b128 v[112:115], v8 offset:8192
    v_mfma_f32_16x16x32_bf16 v[220:223], v[76:79], v[116:119], v[220:223]
    ds_read_b64_tr_b16 v[94:95], v6 offset:25600
    v_mfma_f32_16x16x32_bf16 v[216:219], v[72:75], v[116:119], v[216:219]
    buffer_load_dwordx4 v12, s[28:31], s67 offen  lds
    v_mfma_f32_16x16x32_bf16 v[212:215], v[68:71], v[116:119], v[212:215]
    v_mfma_f32_16x16x32_bf16 v[208:211], v[64:67], v[116:119], v[208:211]
    s_lshl_b32 s17, s2, 14
    ds_read_b128 v[116:119], v8 offset:10240
    v_mfma_f32_16x16x32_bf16 v[224:227], v[64:67], v[120:123], v[224:227]
    s_lshl_b32 s18, s3, 11
    v_mfma_f32_16x16x32_bf16 v[228:231], v[68:71], v[120:123], v[228:231]
    v_mfma_f32_16x16x32_bf16 v[232:235], v[72:75], v[120:123], v[232:235]
    s_add_u32 s17, s17, s18
    v_mfma_f32_16x16x32_bf16 v[236:239], v[76:79], v[120:123], v[236:239]
    v_lshlrev_b32 v32, 7, v4
    ds_read_b128 v[120:123], v8 offset:12288
    v_mfma_f32_16x16x32_bf16 v[252:255], v[76:79], v[124:127], v[252:255]
    v_mfma_f32_16x16x32_bf16 v[248:251], v[72:75], v[124:127], v[248:251]
    buffer_load_dword v32, v32, s[56:59], s17 offen
    v_mfma_f32_16x16x32_bf16 v[244:247], v[68:71], v[124:127], v[244:247]
    v_mfma_f32_16x16x32_bf16 v[240:243], v[64:67], v[124:127], v[240:243]
    ds_read_b128 v[124:127], v8 offset:14336
    s_waitcnt lgkmcnt(3)
    v_mfma_f32_16x16x32_bf16 v[128:131], v[80:83], v[96:99], v[128:131]
    v_mfma_f32_16x16x32_bf16 v[132:135], v[84:87], v[96:99], v[132:135]
    v_mfma_f32_16x16x32_bf16 v[136:139], v[88:91], v[96:99], v[136:139]
    v_mfma_f32_16x16x32_bf16 v[140:143], v[92:95], v[96:99], v[140:143]
    s_waitcnt vmcnt(9) lgkmcnt(0)
    s_barrier
    v_mfma_f32_16x16x32_bf16 v[156:159], v[92:95], v[100:103], v[156:159]
    ds_read_b128 v[96:99], v7 offset:32768
    s_lshl_b32 s70, s15, 3
    v_mfma_f32_16x16x32_bf16 v[152:155], v[88:91], v[100:103], v[152:155]
    s_add_u32 s70, s70, s14
    v_mfma_f32_16x16x32_bf16 v[148:151], v[84:87], v[100:103], v[148:151]
    ds_read_b64_tr_b16 v[64:65], v5 offset:32768
    s_lshl_b32 s70, s70, 7
    v_mfma_f32_16x16x32_bf16 v[144:147], v[80:83], v[100:103], v[144:147]
    s_add_u32 s70, s70, 32575488
    ds_read_b128 v[100:103], v7 offset:34816
    v_mfma_f32_16x16x32_bf16 v[160:163], v[80:83], v[104:107], v[160:163]
    ds_read_b64_tr_b16 v[66:67], v5 offset:33792
    v_mfma_f32_16x16x32_bf16 v[164:167], v[84:87], v[104:107], v[164:167]
    s_cmp_eq_u32 s3, 0
    v_mfma_f32_16x16x32_bf16 v[168:171], v[88:91], v[104:107], v[168:171]
    ds_read_b64_tr_b16 v[68:69], v6 offset:32768
    s_cselect_b32 s70, s70, 0x20000000
    v_mfma_f32_16x16x32_bf16 v[172:175], v[92:95], v[104:107], v[172:175]
    v_mov_b32 v26, 1
    ds_read_b128 v[104:107], v7 offset:36864
    v_mfma_f32_16x16x32_bf16 v[188:191], v[92:95], v[108:111], v[188:191]
    ds_read_b64_tr_b16 v[70:71], v6 offset:33792
    v_mfma_f32_16x16x32_bf16 v[184:187], v[88:91], v[108:111], v[184:187]
    v_mov_b32 v27, 0
    v_mfma_f32_16x16x32_bf16 v[180:183], v[84:87], v[108:111], v[180:183]
    ds_read_b64_tr_b16 v[72:73], v5 offset:40960
    buffer_store_dword v26, v27, s[32:35], s70 offen sc1
    v_mfma_f32_16x16x32_bf16 v[176:179], v[80:83], v[108:111], v[176:179]
    s_add_u32 m0, s66, 16384
    ds_read_b128 v[108:111], v7 offset:38912
    v_mfma_f32_16x16x32_bf16 v[192:195], v[80:83], v[112:115], v[192:195]
    ds_read_b64_tr_b16 v[74:75], v5 offset:41984
    s_add_u32 s67, s64, 6651904
    v_mfma_f32_16x16x32_bf16 v[196:199], v[84:87], v[112:115], v[196:199]
    v_mfma_f32_16x16x32_bf16 v[200:203], v[88:91], v[112:115], v[200:203]
    ds_read_b64_tr_b16 v[76:77], v6 offset:40960
    buffer_load_dwordx4 v11, s[20:23], s67 offen  lds
    v_mfma_f32_16x16x32_bf16 v[204:207], v[92:95], v[112:115], v[204:207]
    s_add_u32 m0, s66, 24576
    ds_read_b128 v[112:115], v7 offset:40960
    v_mfma_f32_16x16x32_bf16 v[220:223], v[92:95], v[116:119], v[220:223]
    ds_read_b64_tr_b16 v[78:79], v6 offset:41984
    s_add_u32 s67, s64, 6651904
    v_mfma_f32_16x16x32_bf16 v[216:219], v[88:91], v[116:119], v[216:219]
    v_mfma_f32_16x16x32_bf16 v[212:215], v[84:87], v[116:119], v[212:215]
    buffer_load_dwordx4 v11, s[24:27], s67 offen  lds
    v_mfma_f32_16x16x32_bf16 v[208:211], v[80:83], v[116:119], v[208:211]
    s_add_u32 m0, s66, 65536
    ds_read_b128 v[116:119], v7 offset:43008
    v_mfma_f32_16x16x32_bf16 v[224:227], v[80:83], v[120:123], v[224:227]
    s_add_u32 s67, s65, 1920
    v_mfma_f32_16x16x32_bf16 v[228:231], v[84:87], v[120:123], v[228:231]
    buffer_load_dwordx4 v12, s[28:31], s67 offen  lds
    v_mfma_f32_16x16x32_bf16 v[232:235], v[88:91], v[120:123], v[232:235]
    v_mfma_f32_16x16x32_bf16 v[236:239], v[92:95], v[120:123], v[236:239]
    s_add_u32 m0, s66, 73728
    ds_read_b128 v[120:123], v7 offset:45056
    v_mfma_f32_16x16x32_bf16 v[252:255], v[92:95], v[124:127], v[252:255]
    s_add_u32 s67, s65, 132992
    v_mfma_f32_16x16x32_bf16 v[248:251], v[88:91], v[124:127], v[248:251]
    buffer_load_dwordx4 v12, s[28:31], s67 offen  lds
    v_mfma_f32_16x16x32_bf16 v[244:247], v[84:87], v[124:127], v[244:247]
    v_mfma_f32_16x16x32_bf16 v[240:243], v[80:83], v[124:127], v[240:243]
    ds_read_b128 v[124:127], v7 offset:47104
L_code1:
    s_waitcnt lgkmcnt(3)
    v_mfma_f32_16x16x32_bf16 v[128:131], v[64:67], v[96:99], v[128:131]
    v_mfma_f32_16x16x32_bf16 v[132:135], v[68:71], v[96:99], v[132:135]
    v_mfma_f32_16x16x32_bf16 v[136:139], v[72:75], v[96:99], v[136:139]
    v_mfma_f32_16x16x32_bf16 v[140:143], v[76:79], v[96:99], v[140:143]
    s_waitcnt vmcnt(12) lgkmcnt(0)
    s_barrier
    v_mfma_f32_16x16x32_bf16 v[156:159], v[76:79], v[100:103], v[156:159]
    ds_read_b128 v[96:99], v8 offset:32768
    s_lshl_b32 s17, s15, 3
    v_mfma_f32_16x16x32_bf16 v[152:155], v[72:75], v[100:103], v[152:155]
    s_add_u32 s17, s17, 32
    v_mfma_f32_16x16x32_bf16 v[148:151], v[68:71], v[100:103], v[148:151]
    ds_read_b64_tr_b16 v[80:81], v5 offset:49152
    v_and_b32 v14, 7, v2
    v_mfma_f32_16x16x32_bf16 v[144:147], v[64:67], v[100:103], v[144:147]
    v_add_u32 v14, s17, v14
    ds_read_b128 v[100:103], v8 offset:34816
    v_mfma_f32_16x16x32_bf16 v[160:163], v[64:67], v[104:107], v[160:163]
    ds_read_b64_tr_b16 v[82:83], v5 offset:50176
    v_cmp_gt_u32 vcc, 32, v2
    v_mfma_f32_16x16x32_bf16 v[164:167], v[68:71], v[104:107], v[164:167]
    s_mov_b32 s72, 32571392
    v_mfma_f32_16x16x32_bf16 v[168:171], v[72:75], v[104:107], v[168:171]
    ds_read_b64_tr_b16 v[84:85], v6 offset:49152
    v_mfma_f32_16x16x32_bf16 v[172:175], v[76:79], v[104:107], v[172:175]
    s_cmp_eq_u32 s3, 0
    ds_read_b128 v[104:107], v8 offset:36864
    v_mfma_f32_16x16x32_bf16 v[188:191], v[76:79], v[108:111], v[188:191]
    ds_read_b64_tr_b16 v[86:87], v6 offset:50176
    s_cselect_b32 s72, s72, 0x20000000
    v_mfma_f32_16x16x32_bf16 v[184:187], v[72:75], v[108:111], v[184:187]
    v_cndmask_b32 v14, v14, v2, vcc
    v_mfma_f32_16x16x32_bf16 v[180:183], v[68:71], v[108:111], v[180:183]
    ds_read_b64_tr_b16 v[88:89], v5 offset:57344
    v_lshlrev_b32 v14, 7, v14
    v_mfma_f32_16x16x32_bf16 v[176:179], v[64:67], v[108:111], v[176:179]
    buffer_load_dword v35, v14, s[32:35], s72 offen sc1
    ds_read_b128 v[108:111], v8 offset:38912
    v_mfma_f32_16x16x32_bf16 v[192:195], v[64:67], v[112:115], v[192:195]
    ds_read_b64_tr_b16 v[90:91], v5 offset:58368
    s_add_u32 m0, s66, 32768
    v_mfma_f32_16x16x32_bf16 v[196:199], v[68:71], v[112:115], v[196:199]
    v_mfma_f32_16x16x32_bf16 v[200:203], v[72:75], v[112:115], v[200:203]
    ds_read_b64_tr_b16 v[92:93], v6 offset:57344
    s_add_u32 s67, s64, 6881280
    v_mfma_f32_16x16x32_bf16 v[204:207], v[76:79], v[112:115], v[204:207]
    buffer_load_dwordx4 v11, s[20:23], s67 offen  lds
    ds_read_b128 v[112:115], v8 offset:40960
    v_mfma_f32_16x16x32_bf16 v[220:223], v[76:79], v[116:119], v[220:223]
    ds_read_b64_tr_b16 v[94:95], v6 offset:58368
    s_add_u32 m0, s66, 40960
    v_mfma_f32_16x16x32_bf16 v[216:219], v[72:75], v[116:119], v[216:219]
    s_add_u32 s67, s64, 6881280
    v_mfma_f32_16x16x32_bf16 v[212:215], v[68:71], v[116:119], v[212:215]
    buffer_load_dwordx4 v11, s[24:27], s67 offen  lds
    v_mfma_f32_16x16x32_bf16 v[208:211], v[64:67], v[116:119], v[208:211]
    s_add_u32 m0, s66, 81920
    ds_read_b128 v[116:119], v8 offset:43008
    v_mfma_f32_16x16x32_bf16 v[224:227], v[64:67], v[120:123], v[224:227]
    v_mfma_f32_16x16x32_bf16 v[228:231], v[68:71], v[120:123], v[228:231]
    s_add_u32 s67, s65, 264064
    v_mfma_f32_16x16x32_bf16 v[232:235], v[72:75], v[120:123], v[232:235]
    buffer_load_dwordx4 v12, s[28:31], s67 offen  lds
    v_mfma_f32_16x16x32_bf16 v[236:239], v[76:79], v[120:123], v[236:239]
    s_add_u32 m0, s66, 90112
    ds_read_b128 v[120:123], v8 offset:45056
    v_mfma_f32_16x16x32_bf16 v[252:255], v[76:79], v[124:127], v[252:255]
    s_add_u32 s67, s65, 395136
    v_mfma_f32_16x16x32_bf16 v[248:251], v[72:75], v[124:127], v[248:251]
    buffer_load_dwordx4 v12, s[28:31], s67 offen  lds
    v_mfma_f32_16x16x32_bf16 v[244:247], v[68:71], v[124:127], v[244:247]
    v_mfma_f32_16x16x32_bf16 v[240:243], v[64:67], v[124:127], v[240:243]
    ds_read_b128 v[124:127], v8 offset:47104
    s_waitcnt lgkmcnt(3)
    v_mfma_f32_16x16x32_bf16 v[128:131], v[80:83], v[96:99], v[128:131]
    v_mfma_f32_16x16x32_bf16 v[132:135], v[84:87], v[96:99], v[132:135]
    v_mfma_f32_16x16x32_bf16 v[136:139], v[88:91], v[96:99], v[136:139]
    v_mfma_f32_16x16x32_bf16 v[140:143], v[92:95], v[96:99], v[140:143]
    s_waitcnt vmcnt(11) lgkmcnt(0)
    s_barrier
    v_mfma_f32_16x16x32_bf16 v[156:159], v[92:95], v[100:103], v[156:159]
    ds_read_b128 v[96:99], v9 offset:0
    s_add_u32 m0, s66, 49152
    v_mfma_f32_16x16x32_bf16 v[152:155], v[88:91], v[100:103], v[152:155]
    v_mfma_f32_16x16x32_bf16 v[148:151], v[84:87], v[100:103], v[148:151]
    ds_read_b64_tr_b16 v[64:65], v5 offset:0
    v_mfma_f32_16x16x32_bf16 v[144:147], v[80:83], v[100:103], v[144:147]
    ds_read_b128 v[100:103], v9 offset:2048
    v_mfma_f32_16x16x32_bf16 v[160:163], v[80:83], v[104:107], v[160:163]
    ds_read_b64_tr_b16 v[66:67], v5 offset:1024
    s_add_u32 s67, s64, 7110656
    v_mfma_f32_16x16x32_bf16 v[164:167], v[84:87], v[104:107], v[164:167]
    v_mfma_f32_16x16x32_bf16 v[168:171], v[88:91], v[104:107], v[168:171]
    ds_read_b64_tr_b16 v[68:69], v6 offset:0
    v_mfma_f32_16x16x32_bf16 v[172:175], v[92:95], v[104:107], v[172:175]
    ds_read_b128 v[104:107], v9 offset:4096
    v_mfma_f32_16x16x32_bf16 v[188:191], v[92:95], v[108:111], v[188:191]
    ds_read_b64_tr_b16 v[70:71], v6 offset:1024
    v_mfma_f32_16x16x32_bf16 v[184:187], v[88:91], v[108:111], v[184:187]
    buffer_load_dwordx4 v11, s[20:23], s67 offen  lds
    v_mfma_f32_16x16x32_bf16 v[180:183], v[84:87], v[108:111], v[180:183]
    ds_read_b64_tr_b16 v[72:73], v5 offset:8192
    v_mfma_f32_16x16x32_bf16 v[176:179], v[80:83], v[108:111], v[176:179]
    ds_read_b128 v[108:111], v9 offset:6144
    v_mfma_f32_16x16x32_bf16 v[192:195], v[80:83], v[112:115], v[192:195]
    ds_read_b64_tr_b16 v[74:75], v5 offset:9216
    v_mfma_f32_16x16x32_bf16 v[196:199], v[84:87], v[112:115], v[196:199]
    s_add_u32 m0, s66, 57344
    v_mfma_f32_16x16x32_bf16 v[200:203], v[88:91], v[112:115], v[200:203]
    ds_read_b64_tr_b16 v[76:77], v6 offset:8192
    v_mfma_f32_16x16x32_bf16 v[204:207], v[92:95], v[112:115], v[204:207]
    ds_read_b128 v[112:115], v9 offset:8192
    v_mfma_f32_16x16x32_bf16 v[220:223], v[92:95], v[116:119], v[220:223]
    ds_read_b64_tr_b16 v[78:79], v6 offset:9216
    v_mfma_f32_16x16x32_bf16 v[216:219], v[88:91], v[116:119], v[216:219]
    v_mfma_f32_16x16x32_bf16 v[212:215], v[84:87], v[116:119], v[212:215]
    s_add_u32 s67, s64, 7110656
    v_mfma_f32_16x16x32_bf16 v[208:211], v[80:83], v[116:119], v[208:211]
    ds_read_b128 v[116:119], v9 offset:10240
    v_mfma_f32_16x16x32_bf16 v[224:227], v[80:83], v[120:123], v[224:227]
    v_mfma_f32_16x16x32_bf16 v[228:231], v[84:87], v[120:123], v[228:231]
    v_mfma_f32_16x16x32_bf16 v[232:235], v[88:91], v[120:123], v[232:235]
    buffer_load_dwordx4 v11, s[24:27], s67 offen  lds
    v_mfma_f32_16x16x32_bf16 v[236:239], v[92:95], v[120:123], v[236:239]
    ds_read_b128 v[120:123], v9 offset:12288
    v_mfma_f32_16x16x32_bf16 v[252:255], v[92:95], v[124:127], v[252:255]
    v_mfma_f32_16x16x32_bf16 v[248:251], v[88:91], v[124:127], v[248:251]
    v_mfma_f32_16x16x32_bf16 v[244:247], v[84:87], v[124:127], v[244:247]
    v_mfma_f32_16x16x32_bf16 v[240:243], v[80:83], v[124:127], v[240:243]
    ds_read_b128 v[124:127], v9 offset:14336
    s_waitcnt lgkmcnt(3)
    v_mfma_f32_16x16x32_bf16 v[128:131], v[64:67], v[96:99], v[128:131]
    s_waitcnt vmcnt(6)
    v_cmp_ne_u32 vcc, 1, v35
    s_cmp_eq_u32 s3, 0
    s_cselect_b64 s[18:19], vcc, 0
    s_cmp_lg_u64 s[18:19], 0
    s_cbranch_scc1 L_csl
L_cok:
    v_mfma_f32_16x16x32_bf16 v[132:135], v[68:71], v[96:99], v[132:135]
    v_mfma_f32_16x16x32_bf16 v[136:139], v[72:75], v[96:99], v[136:139]
    v_mfma_f32_16x16x32_bf16 v[140:143], v[76:79], v[96:99], v[140:143]
    s_waitcnt vmcnt(9) lgkmcnt(0)
    s_barrier
    v_mfma_f32_16x16x32_bf16 v[156:159], v[76:79], v[100:103], v[156:159]
    ds_read_b128 v[96:99], v10 offset:0
    s_and_b32 s17, s3, 3
    v_mfma_f32_16x16x32_bf16 v[152:155], v[72:75], v[100:103], v[152:155]
    s_lshl_b32 s17, s17, 10
    v_mfma_f32_16x16x32_bf16 v[148:151], v[68:71], v[100:103], v[148:151]
    ds_read_b64_tr_b16 v[80:81], v5 offset:16384
    s_add_u32 m0, s17, 0
    v_mfma_f32_16x16x32_bf16 v[144:147], v[64:67], v[100:103], v[144:147]
    s_lshl_b32 s18, s14, 12
    ds_read_b128 v[100:103], v10 offset:2048
    v_mfma_f32_16x16x32_bf16 v[160:163], v[64:67], v[104:107], v[160:163]
    ds_read_b64_tr_b16 v[82:83], v5 offset:17408
    s_add_u32 s17, s17, s18
    v_mfma_f32_16x16x32_bf16 v[164:167], v[68:71], v[104:107], v[164:167]
    s_add_u32 s17, s17, 4259840
    v_mfma_f32_16x16x32_bf16 v[168:171], v[72:75], v[104:107], v[168:171]
    ds_read_b64_tr_b16 v[84:85], v6 offset:16384
    v_mfma_f32_16x16x32_bf16 v[172:175], v[76:79], v[104:107], v[172:175]
    v_lshlrev_b32 v15, 4, v2
    ds_read_b128 v[104:107], v10 offset:4096
    v_mfma_f32_16x16x32_bf16 v[188:191], v[76:79], v[108:111], v[188:191]
    ds_read_b64_tr_b16 v[86:87], v6 offset:17408
    buffer_load_dwordx4 v15, s[32:35], s17 offen sc1 lds
    v_mfma_f32_16x16x32_bf16 v[184:187], v[72:75], v[108:111], v[184:187]
    s_and_b32 s18, s3, 3
    v_mfma_f32_16x16x32_bf16 v[180:183], v[68:71], v[108:111], v[180:183]
    ds_read_b64_tr_b16 v[88:89], v5 offset:24576
    s_lshl_b32 s18, s18, 7
    v_mfma_f32_16x16x32_bf16 v[176:179], v[64:67], v[108:111], v[176:179]
    s_lshl_b32 s19, s15, 9
    ds_read_b128 v[108:111], v10 offset:6144
    v_mfma_f32_16x16x32_bf16 v[192:195], v[64:67], v[112:115], v[192:195]
    ds_read_b64_tr_b16 v[90:91], v5 offset:25600
    s_add_u32 s18, s18, s19
    v_mfma_f32_16x16x32_bf16 v[196:199], v[68:71], v[112:115], v[196:199]
    v_mfma_f32_16x16x32_bf16 v[200:203], v[72:75], v[112:115], v[200:203]
    ds_read_b64_tr_b16 v[92:93], v6 offset:24576
    s_lshr_b32 s19, s3, 2
    v_mfma_f32_16x16x32_bf16 v[204:207], v[76:79], v[112:115], v[204:207]
    s_mul_i32 s19, s19, 14336
    ds_read_b128 v[112:115], v10 offset:8192
    v_mfma_f32_16x16x32_bf16 v[220:223], v[76:79], v[116:119], v[220:223]
    ds_read_b64_tr_b16 v[94:95], v6 offset:25600
    s_add_u32 s18, s18, s19
    v_mfma_f32_16x16x32_bf16 v[216:219], v[72:75], v[116:119], v[216:219]
    s_add_u32 s18, s18, 4456448
    v_mfma_f32_16x16x32_bf16 v[212:215], v[68:71], v[116:119], v[212:215]
    s_add_u32 s19, s18, 229376
    v_mfma_f32_16x16x32_bf16 v[208:211], v[64:67], v[116:119], v[208:211]
    v_lshrrev_b32 v20, 3, v2
    ds_read_b128 v[116:119], v10 offset:10240
    v_mfma_f32_16x16x32_bf16 v[224:227], v[64:67], v[120:123], v[224:227]
    v_mfma_f32_16x16x32_bf16 v[228:231], v[68:71], v[120:123], v[228:231]
    v_mul_u32_u24 v20, 28672, v20
    v_mfma_f32_16x16x32_bf16 v[232:235], v[72:75], v[120:123], v[232:235]
    v_and_b32 v21, 7, v2
    v_mfma_f32_16x16x32_bf16 v[236:239], v[76:79], v[120:123], v[236:239]
    v_lshl_add_u32 v20, v21, 4, v20
    ds_read_b128 v[120:123], v10 offset:12288
    v_mfma_f32_16x16x32_bf16 v[252:255], v[76:79], v[124:127], v[252:255]
    buffer_load_dwordx4 v[24:27], v20, s[32:35], s18 offen sc1
    v_mfma_f32_16x16x32_bf16 v[248:251], v[72:75], v[124:127], v[248:251]
    buffer_load_dwordx4 v[28:31], v20, s[32:35], s19 offen sc1
    v_mfma_f32_16x16x32_bf16 v[244:247], v[68:71], v[124:127], v[244:247]
    v_mfma_f32_16x16x32_bf16 v[240:243], v[64:67], v[124:127], v[240:243]
    ds_read_b128 v[124:127], v10 offset:14336
    s_waitcnt lgkmcnt(3)
    v_mfma_f32_16x16x32_bf16 v[128:131], v[80:83], v[96:99], v[128:131]
    v_mfma_f32_16x16x32_bf16 v[132:135], v[84:87], v[96:99], v[132:135]
    v_mfma_f32_16x16x32_bf16 v[136:139], v[88:91], v[96:99], v[136:139]
    v_mfma_f32_16x16x32_bf16 v[140:143], v[92:95], v[96:99], v[140:143]
    s_waitcnt vmcnt(5) lgkmcnt(0)
    s_barrier
    v_mfma_f32_16x16x32_bf16 v[156:159], v[92:95], v[100:103], v[156:159]
    ds_read_b128 v[96:99], v7 offset:0
    s_and_b32 s71, s3, 3
    s_lshl_b32 s18, s2, 2
    v_mfma_f32_16x16x32_bf16 v[152:155], v[88:91], v[100:103], v[152:155]
    s_add_u32 s18, s18, s71
    v_mfma_f32_16x16x32_bf16 v[148:151], v[84:87], v[100:103], v[148:151]
    ds_read_b64_tr_b16 v[64:65], v5 offset:32768
    s_mul_i32 s17, s71, 21248
    v_mfma_f32_16x16x32_bf16 v[144:147], v[80:83], v[100:103], v[144:147]
    s_add_u32 s17, s17, 98304
    ds_read_b128 v[100:103], v7 offset:2048
    v_mfma_f32_16x16x32_bf16 v[160:163], v[80:83], v[104:107], v[160:163]
    ds_read_b64_tr_b16 v[66:67], v5 offset:33792
    s_cmp_eq_u32 s71, 3
    v_mfma_f32_16x16x32_bf16 v[164:167], v[84:87], v[104:107], v[164:167]
    s_cselect_b32 s71, 5120, s17
    v_mfma_f32_16x16x32_bf16 v[168:171], v[88:91], v[104:107], v[168:171]
    ds_read_b64_tr_b16 v[68:69], v6 offset:32768
    s_lshl_b32 s73, s18, 12
    v_mfma_f32_16x16x32_bf16 v[172:175], v[92:95], v[104:107], v[172:175]
    v_add_u32 v0, v3, v4
    ds_read_b128 v[104:107], v7 offset:4096
    v_mfma_f32_16x16x32_bf16 v[188:191], v[92:95], v[108:111], v[188:191]
    ds_read_b64_tr_b16 v[70:71], v6 offset:33792
    v_subrev_u32 v0, 15, v0
    v_mfma_f32_16x16x32_bf16 v[184:187], v[88:91], v[108:111], v[184:187]
    v_lshlrev_b32 v0, 1, v0
    v_mfma_f32_16x16x32_bf16 v[180:183], v[84:87], v[108:111], v[180:183]
    ds_read_b64_tr_b16 v[72:73], v5 offset:40960
    v_cmp_gt_i32 vcc, 0, v0
    v_mfma_f32_16x16x32_bf16 v[176:179], v[80:83], v[108:111], v[176:179]
    v_add_u32 v0, s73, v0
    ds_read_b128 v[108:111], v7 offset:6144
    v_mfma_f32_16x16x32_bf16 v[192:195], v[80:83], v[112:115], v[192:195]
    ds_read_b64_tr_b16 v[74:75], v5 offset:41984
    s_lshl_b32 s17, s18, 1
    v_mfma_f32_16x16x32_bf16 v[196:199], v[84:87], v[112:115], v[196:199]
    v_cndmask_b32 v0, v0, -1, vcc
    v_mov_b32 v1, s17
    v_mfma_f32_16x16x32_bf16 v[200:203], v[88:91], v[112:115], v[200:203]
    ds_read_b64_tr_b16 v[76:77], v6 offset:40960
    buffer_load_ushort v0, v0, s[56:59], 0 offen
    v_mfma_f32_16x16x32_bf16 v[204:207], v[92:95], v[112:115], v[204:207]
    buffer_load_ushort v1, v1, s[60:63], 0 offen
    ds_read_b128 v[112:115], v7 offset:8192
    v_mfma_f32_16x16x32_bf16 v[220:223], v[92:95], v[116:119], v[220:223]
    ds_read_b64_tr_b16 v[78:79], v6 offset:41984
    s_lshr_b32 s17, s3, 2
    v_mfma_f32_16x16x32_bf16 v[216:219], v[88:91], v[116:119], v[216:219]
    s_lshl_b32 s17, s17, 11
    v_mfma_f32_16x16x32_bf16 v[212:215], v[84:87], v[116:119], v[212:215]
    s_add_u32 s74, s71, s17
    v_mfma_f32_16x16x32_bf16 v[208:211], v[80:83], v[116:119], v[208:211]
    s_add_u32 s75, s73, s17
    ds_read_b128 v[116:119], v7 offset:10240
    v_mfma_f32_16x16x32_bf16 v[224:227], v[80:83], v[120:123], v[224:227]
    v_lshlrev_b32 v15, 4, v2
    v_mfma_f32_16x16x32_bf16 v[228:231], v[84:87], v[120:123], v[228:231]
    s_add_u32 m0, s74, 32
    v_mfma_f32_16x16x32_bf16 v[232:235], v[88:91], v[120:123], v[232:235]
    s_add_u32 s17, s75, 2
    v_mfma_f32_16x16x32_bf16 v[236:239], v[92:95], v[120:123], v[236:239]
    buffer_load_dwordx4 v15, s[56:59], s17 offen  lds
    ds_read_b128 v[120:123], v7 offset:12288
    v_mfma_f32_16x16x32_bf16 v[252:255], v[92:95], v[124:127], v[252:255]
    s_add_u32 m0, s74, 4188
    v_mfma_f32_16x16x32_bf16 v[248:251], v[88:91], v[124:127], v[248:251]
    s_add_u32 s17, s75, 0
    v_mfma_f32_16x16x32_bf16 v[244:247], v[84:87], v[124:127], v[244:247]
    buffer_load_dwordx4 v15, s[56:59], s17 offen  lds
    v_mfma_f32_16x16x32_bf16 v[240:243], v[80:83], v[124:127], v[240:243]
    ds_read_b128 v[124:127], v7 offset:14336
    s_waitcnt lgkmcnt(3)
    v_mfma_f32_16x16x32_bf16 v[128:131], v[64:67], v[96:99], v[128:131]
    v_mfma_f32_16x16x32_bf16 v[132:135], v[68:71], v[96:99], v[132:135]
    v_mfma_f32_16x16x32_bf16 v[136:139], v[72:75], v[96:99], v[136:139]
    v_mfma_f32_16x16x32_bf16 v[140:143], v[76:79], v[96:99], v[140:143]
    s_waitcnt vmcnt(7) lgkmcnt(0)
    s_barrier
    s_waitcnt vmcnt(4)
    v_mfma_f32_16x16x32_bf16 v[156:159], v[76:79], v[100:103], v[156:159]
    v_add_f32 v24, v24, v28
    v_add_f32 v25, v25, v29
    ds_read_b128 v[96:99], v8 offset:0
    v_and_b32 v14, 31, v2
    v_mfma_f32_16x16x32_bf16 v[152:155], v[72:75], v[100:103], v[152:155]
    v_add_f32 v26, v26, v30
    v_add_f32 v27, v27, v31
    v_lshlrev_b32 v14, 7, v14
    v_mfma_f32_16x16x32_bf16 v[148:151], v[68:71], v[100:103], v[148:151]
    v_add_f32_dpp v24, v24, v24 row_ror:8 row_mask:0xf bank_mask:0xf
    v_add_f32_dpp v25, v25, v25 row_ror:8 row_mask:0xf bank_mask:0xf
    ds_read_b64_tr_b16 v[80:81], v5 offset:49152
    v_mfma_f32_16x16x32_bf16 v[144:147], v[64:67], v[100:103], v[144:147]
    v_add_f32_dpp v26, v26, v26 row_ror:8 row_mask:0xf bank_mask:0xf
    v_add_f32_dpp v27, v27, v27 row_ror:8 row_mask:0xf bank_mask:0xf
    s_mov_b32 s72, 32702464
    ds_read_b128 v[100:103], v8 offset:2048
    v_mfma_f32_16x16x32_bf16 v[160:163], v[64:67], v[104:107], v[160:163]
    v_mov_b32 v28, v24
    v_mov_b32 v29, v25
    ds_read_b64_tr_b16 v[82:83], v5 offset:50176
    v_mfma_f32_16x16x32_bf16 v[164:167], v[68:71], v[104:107], v[164:167]
    v_mov_b32 v30, v26
    v_mov_b32 v31, v27
    s_cmp_eq_u32 s3, 0
    v_mfma_f32_16x16x32_bf16 v[168:171], v[72:75], v[104:107], v[168:171]
    v_permlane16_swap_b32 v24, v28
    v_permlane16_swap_b32 v25, v29
    ds_read_b64_tr_b16 v[84:85], v6 offset:49152
    v_mfma_f32_16x16x32_bf16 v[172:175], v[76:79], v[104:107], v[172:175]
    v_permlane16_swap_b32 v26, v30
    v_permlane16_swap_b32 v27, v31
    s_cselect_b32 s72, s72, 0x20000000
    ds_read_b128 v[104:107], v8 offset:4096
    v_mfma_f32_16x16x32_bf16 v[188:191], v[76:79], v[108:111], v[188:191]
    v_add_f32 v24, v24, v28
    v_add_f32 v25, v25, v29
    ds_read_b64_tr_b16 v[86:87], v6 offset:50176
    v_mfma_f32_16x16x32_bf16 v[184:187], v[72:75], v[108:111], v[184:187]
    v_add_f32 v26, v26, v30
    v_add_f32 v27, v27, v31
    buffer_load_dword v11, v14, s[32:35], s72 offen sc1
    v_mfma_f32_16x16x32_bf16 v[180:183], v[68:71], v[108:111], v[180:183]
    v_mov_b32 v28, v24
    v_mov_b32 v29, v25
    ds_read_b64_tr_b16 v[88:89], v5 offset:57344
    s_add_u32 m0, s74, 8348
    v_mfma_f32_16x16x32_bf16 v[176:179], v[64:67], v[108:111], v[176:179]
    v_mov_b32 v30, v26
    v_mov_b32 v31, v27
    ds_read_b128 v[108:111], v8 offset:6144
    v_mfma_f32_16x16x32_bf16 v[192:195], v[64:67], v[112:115], v[192:195]
    v_permlane32_swap_b32 v24, v28
    v_permlane32_swap_b32 v25, v29
    ds_read_b64_tr_b16 v[90:91], v5 offset:58368
    s_add_u32 s17, s75, 2
    v_mfma_f32_16x16x32_bf16 v[196:199], v[68:71], v[112:115], v[196:199]
    v_permlane32_swap_b32 v26, v30
    v_permlane32_swap_b32 v27, v31
    v_mfma_f32_16x16x32_bf16 v[200:203], v[72:75], v[112:115], v[200:203]
    v_add_f32 v24, v24, v28
    v_add_f32 v25, v25, v29
    ds_read_b64_tr_b16 v[92:93], v6 offset:57344
    buffer_load_dwordx4 v15, s[56:59], s17 offen  lds
    v_mfma_f32_16x16x32_bf16 v[204:207], v[76:79], v[112:115], v[204:207]
    v_add_f32 v26, v26, v30
    v_add_f32 v27, v27, v31
    ds_read_b128 v[112:115], v8 offset:8192
    v_mfma_f32_16x16x32_bf16 v[220:223], v[76:79], v[116:119], v[220:223]
    s_lshl_b32 s17, s3, 7
    v_lshl_add_u32 v20, v21, 4, s17
    ds_write_b128 v20, v[24:27] offset:4096
    ds_read_b64_tr_b16 v[94:95], v6 offset:58368
    s_add_u32 m0, s74, 12504
    v_mfma_f32_16x16x32_bf16 v[216:219], v[72:75], v[116:119], v[216:219]
    v_mfma_f32_16x16x32_bf16 v[212:215], v[68:71], v[116:119], v[212:215]
    s_add_u32 s17, s75, 0
    v_mfma_f32_16x16x32_bf16 v[208:211], v[64:67], v[116:119], v[208:211]
    buffer_load_dwordx4 v15, s[56:59], s17 offen  lds
    ds_read_b128 v[116:119], v8 offset:10240
    v_mfma_f32_16x16x32_bf16 v[224:227], v[64:67], v[120:123], v[224:227]
    v_mfma_f32_16x16x32_bf16 v[228:231], v[68:71], v[120:123], v[228:231]
    s_add_u32 m0, s74, 1056
    v_mfma_f32_16x16x32_bf16 v[232:235], v[72:75], v[120:123], v[232:235]
    v_mfma_f32_16x16x32_bf16 v[236:239], v[76:79], v[120:123], v[236:239]
    s_add_u32 s17, s75, 1026
    ds_read_b128 v[120:123], v8 offset:12288
    v_mfma_f32_16x16x32_bf16 v[252:255], v[76:79], v[124:127], v[252:255]
    v_mfma_f32_16x16x32_bf16 v[248:251], v[72:75], v[124:127], v[248:251]
    buffer_load_dwordx4 v15, s[56:59], s17 offen  lds
    v_mfma_f32_16x16x32_bf16 v[244:247], v[68:71], v[124:127], v[244:247]
    v_mfma_f32_16x16x32_bf16 v[240:243], v[64:67], v[124:127], v[240:243]
    ds_read_b128 v[124:127], v8 offset:14336
    s_waitcnt lgkmcnt(3)
    v_mfma_f32_16x16x32_bf16 v[128:131], v[80:83], v[96:99], v[128:131]
    v_mfma_f32_16x16x32_bf16 v[132:135], v[84:87], v[96:99], v[132:135]
    v_mfma_f32_16x16x32_bf16 v[136:139], v[88:91], v[96:99], v[136:139]
    v_mfma_f32_16x16x32_bf16 v[140:143], v[92:95], v[96:99], v[140:143]
    s_waitcnt lgkmcnt(0)
    s_barrier
    v_mfma_f32_16x16x32_bf16 v[156:159], v[92:95], v[100:103], v[156:159]
    v_lshlrev_b32 v13, 4, v4
    s_lshr_b32 s17, s3, 2
    v_mfma_f32_16x16x32_bf16 v[152:155], v[88:91], v[100:103], v[152:155]
    s_lshl_b32 s17, s17, 11
    v_add_u32 v13, s17, v13
    v_mfma_f32_16x16x32_bf16 v[148:151], v[84:87], v[100:103], v[148:151]
    v_lshlrev_b32 v12, 4, v3
    v_mfma_f32_16x16x32_bf16 v[144:147], v[80:83], v[100:103], v[144:147]
    s_and_b32 s17, s3, 3
    s_lshl_b32 s17, s17, 7
    v_mfma_f32_16x16x32_bf16 v[160:163], v[80:83], v[104:107], v[160:163]
    v_add_u32 v12, s17, v12
    ds_read_b128 v[48:51], v12 offset:4096
    v_mfma_f32_16x16x32_bf16 v[164:167], v[84:87], v[104:107], v[164:167]
    ds_read_b128 v[52:55], v12 offset:4160
    v_mfma_f32_16x16x32_bf16 v[168:171], v[88:91], v[104:107], v[168:171]
    ds_read_b128 v[56:59], v12 offset:4608
    ds_read_b128 v[60:63], v12 offset:4672
    v_mfma_f32_16x16x32_bf16 v[172:175], v[92:95], v[104:107], v[172:175]
    ds_read_b128 v[16:19], v13 offset:0
    ds_read_b128 v[20:23], v13 offset:256
    v_mfma_f32_16x16x32_bf16 v[188:191], v[92:95], v[108:111], v[188:191]
    ds_read_b128 v[24:27], v13 offset:512
    v_mfma_f32_16x16x32_bf16 v[184:187], v[88:91], v[108:111], v[184:187]
    ds_read_b128 v[28:31], v13 offset:768
    ds_read_b128 v[32:35], v13 offset:1024
    v_mfma_f32_16x16x32_bf16 v[180:183], v[84:87], v[108:111], v[180:183]
    ds_read_b128 v[36:39], v13 offset:1280
    v_mfma_f32_16x16x32_bf16 v[176:179], v[80:83], v[108:111], v[176:179]
    ds_read_b128 v[40:43], v13 offset:1536
    ds_read_b128 v[44:47], v13 offset:1792
    v_mfma_f32_16x16x32_bf16 v[192:195], v[80:83], v[112:115], v[192:195]
    s_add_u32 m0, s74, 5212
    s_add_u32 s17, s75, 1024
    v_mfma_f32_16x16x32_bf16 v[196:199], v[84:87], v[112:115], v[196:199]
    buffer_load_dwordx4 v15, s[56:59], s17 offen  lds
    v_mfma_f32_16x16x32_bf16 v[200:203], v[88:91], v[112:115], v[200:203]
    s_add_u32 m0, s74, 9372
    s_add_u32 s17, s75, 1026
    v_mfma_f32_16x16x32_bf16 v[204:207], v[92:95], v[112:115], v[204:207]
    buffer_load_dwordx4 v15, s[56:59], s17 offen  lds
    s_add_u32 m0, s74, 13528
    v_mfma_f32_16x16x32_bf16 v[220:223], v[92:95], v[116:119], v[220:223]
    s_add_u32 s17, s75, 1024
    v_mfma_f32_16x16x32_bf16 v[216:219], v[88:91], v[116:119], v[216:219]
    buffer_load_dwordx4 v15, s[56:59], s17 offen  lds
    s_and_b32 s17, s3, 3
    v_mfma_f32_16x16x32_bf16 v[212:215], v[84:87], v[116:119], v[212:215]
    s_lshl_b32 s18, s15, 2
    v_mfma_f32_16x16x32_bf16 v[208:211], v[80:83], v[116:119], v[208:211]
    s_add_u32 s18, s18, s17
    s_lshl_b32 s18, s18, 7
    v_mfma_f32_16x16x32_bf16 v[224:227], v[80:83], v[120:123], v[224:227]
    s_lshl_b32 s17, s14, 4
    s_add_u32 s18, s18, s17
    v_mfma_f32_16x16x32_bf16 v[228:231], v[84:87], v[120:123], v[228:231]
    s_lshr_b32 s17, s3, 2
    v_mfma_f32_16x16x32_bf16 v[232:235], v[88:91], v[120:123], v[232:235]
    s_lshl_b32 s17, s17, 3
    s_add_u32 s18, s18, s17
    v_mfma_f32_16x16x32_bf16 v[236:239], v[92:95], v[120:123], v[236:239]
    s_lshl_b32 s18, s18, 10
    s_add_u32 s64, s18, 10485760
    v_mfma_f32_16x16x32_bf16 v[252:255], v[92:95], v[124:127], v[252:255]
    s_add_u32 s65, s64, 4096
    v_mfma_f32_16x16x32_bf16 v[248:251], v[88:91], v[124:127], v[248:251]
    s_lshl_b32 s100, s15, 3
    s_add_u32 s100, s100, s14
    v_mfma_f32_16x16x32_bf16 v[244:247], v[84:87], v[124:127], v[244:247]
    v_lshlrev_b32 v15, 4, v2
    v_mfma_f32_16x16x32_bf16 v[240:243], v[80:83], v[124:127], v[240:243]
    s_waitcnt vmcnt(6)
    v_cmp_ne_u32 vcc, 1, v11
    s_cmp_eq_u32 s3, 0
    s_cselect_b64 s[18:19], vcc, 0
    s_cmp_lg_u64 s[18:19], 0
    s_cbranch_scc1 L_usl
L_uok:
    s_waitcnt lgkmcnt(0)
    s_barrier
    v_pk_fma_f32 v[128:129], v[48:49], v[16:17], v[128:129] op_sel_hi:[1,0,1]
    v_pk_fma_f32 v[130:131], v[50:51], v[16:17], v[130:131] op_sel_hi:[1,0,1]
    v_pk_fma_f32 v[136:137], v[56:57], v[16:17], v[136:137] op_sel_hi:[1,0,1]
    v_pk_mul_f32 v[64:65], v[128:129], v[128:129]
    v_pk_mul_f32 v[66:67], v[130:131], v[130:131]
    v_pk_fma_f32 v[138:139], v[58:59], v[16:17], v[138:139] op_sel_hi:[1,0,1]
    v_pk_fma_f32 v[64:65], v[64:65], v[18:19], v[16:17] op_sel:[0,0,1] op_sel_hi:[1,0,1]
    v_pk_fma_f32 v[66:67], v[66:67], v[18:19], v[16:17] op_sel:[0,0,1] op_sel_hi:[1,0,1]
    v_pk_mul_f32 v[136:137], v[136:137], v[128:129]
    v_pk_mul_f32 v[64:65], v[64:65], v[128:129]
    v_pk_mul_f32 v[66:67], v[66:67], v[130:131]
    v_pk_mul_f32 v[138:139], v[138:139], v[130:131]
    v_exp_f32 v64, v64
    v_exp_f32 v65, v65
    v_exp_f32 v66, v66
    v_exp_f32 v67, v67
    s_nop 0
    s_add_u32 m0, s74, 16640
    s_add_u32 s17, s75, 5242880
    buffer_load_dwordx4 v15, s[32:35], s17 offen sc1 lds
    v_pk_fma_f32 v[64:65], v[64:65], v[18:19], v[18:19] op_sel:[0,1,1] op_sel_hi:[1,1,1]
    v_pk_fma_f32 v[66:67], v[66:67], v[18:19], v[18:19] op_sel:[0,1,1] op_sel_hi:[1,1,1]
    v_rcp_f32 v64, v64
    v_rcp_f32 v65, v65
    v_rcp_f32 v66, v66
    v_rcp_f32 v67, v67
    v_pk_fma_f32 v[132:133], v[52:53], v[16:17], v[132:133] op_sel_hi:[1,0,1]
    v_pk_fma_f32 v[134:135], v[54:55], v[16:17], v[134:135] op_sel_hi:[1,0,1]
    v_pk_fma_f32 v[140:141], v[60:61], v[16:17], v[140:141] op_sel_hi:[1,0,1]
    v_pk_mul_f32 v[72:73], v[132:133], v[132:133]
    v_pk_mul_f32 v[74:75], v[134:135], v[134:135]
    v_pk_fma_f32 v[142:143], v[62:63], v[16:17], v[142:143] op_sel_hi:[1,0,1]
    v_pk_fma_f32 v[72:73], v[72:73], v[18:19], v[16:17] op_sel:[0,0,1] op_sel_hi:[1,0,1]
    v_pk_fma_f32 v[74:75], v[74:75], v[18:19], v[16:17] op_sel:[0,0,1] op_sel_hi:[1,0,1]
    v_pk_mul_f32 v[140:141], v[140:141], v[132:133]
    v_pk_mul_f32 v[72:73], v[72:73], v[132:133]
    v_pk_mul_f32 v[74:75], v[74:75], v[134:135]
    v_pk_mul_f32 v[142:143], v[142:143], v[134:135]
    v_exp_f32 v72, v72
    v_exp_f32 v73, v73
    v_exp_f32 v74, v74
    v_exp_f32 v75, v75
    v_pk_mul_f32 v[64:65], v[64:65], v[136:137]
    v_pk_mul_f32 v[66:67], v[66:67], v[138:139]
    v_cvt_pk_bf16_f32 v128, v64, v65
    v_cvt_pk_bf16_f32 v129, v66, v67
    s_add_u32 m0, s74, 17664
    s_add_u32 s17, s75, 5243904
    buffer_load_dwordx4 v15, s[32:35], s17 offen sc1 lds
    v_pk_fma_f32 v[72:73], v[72:73], v[18:19], v[18:19] op_sel:[0,1,1] op_sel_hi:[1,1,1]
    v_pk_fma_f32 v[74:75], v[74:75], v[18:19], v[18:19] op_sel:[0,1,1] op_sel_hi:[1,1,1]
    v_rcp_f32 v72, v72
    v_rcp_f32 v73, v73
    v_rcp_f32 v74, v74
    v_rcp_f32 v75, v75
    v_pk_fma_f32 v[144:145], v[48:49], v[20:21], v[144:145] op_sel_hi:[1,0,1]
    v_pk_fma_f32 v[146:147], v[50:51], v[20:21], v[146:147] op_sel_hi:[1,0,1]
    v_pk_fma_f32 v[152:153], v[56:57], v[20:21], v[152:153] op_sel_hi:[1,0,1]
    v_pk_mul_f32 v[80:81], v[144:145], v[144:145]
    v_pk_mul_f32 v[82:83], v[146:147], v[146:147]
    v_pk_fma_f32 v[154:155], v[58:59], v[20:21], v[154:155] op_sel_hi:[1,0,1]
    v_pk_fma_f32 v[80:81], v[80:81], v[22:23], v[20:21] op_sel:[0,0,1] op_sel_hi:[1,0,1]
    v_pk_fma_f32 v[82:83], v[82:83], v[22:23], v[20:21] op_sel:[0,0,1] op_sel_hi:[1,0,1]
    v_pk_mul_f32 v[152:153], v[152:153], v[144:145]
    v_pk_mul_f32 v[80:81], v[80:81], v[144:145]
    v_pk_mul_f32 v[82:83], v[82:83], v[146:147]
    v_pk_mul_f32 v[154:155], v[154:155], v[146:147]
    v_exp_f32 v80, v80
    v_exp_f32 v81, v81
    v_exp_f32 v82, v82
    v_exp_f32 v83, v83
    v_pk_mul_f32 v[72:73], v[72:73], v[140:141]
    v_pk_mul_f32 v[74:75], v[74:75], v[142:143]
    v_cvt_pk_bf16_f32 v130, v72, v73
    v_cvt_pk_bf16_f32 v131, v74, v75
    buffer_store_dwordx4 v[128:131], v15, s[32:35], s64 offen offset:0 sc1
    v_pk_fma_f32 v[80:81], v[80:81], v[22:23], v[22:23] op_sel:[0,1,1] op_sel_hi:[1,1,1]
    v_pk_fma_f32 v[82:83], v[82:83], v[22:23], v[22:23] op_sel:[0,1,1] op_sel_hi:[1,1,1]
    v_rcp_f32 v80, v80
    v_rcp_f32 v81, v81
    v_rcp_f32 v82, v82
    v_rcp_f32 v83, v83
    v_pk_fma_f32 v[148:149], v[52:53], v[20:21], v[148:149] op_sel_hi:[1,0,1]
    v_pk_fma_f32 v[150:151], v[54:55], v[20:21], v[150:151] op_sel_hi:[1,0,1]
    v_pk_fma_f32 v[156:157], v[60:61], v[20:21], v[156:157] op_sel_hi:[1,0,1]
    v_pk_mul_f32 v[88:89], v[148:149], v[148:149]
    v_pk_mul_f32 v[90:91], v[150:151], v[150:151]
    v_pk_fma_f32 v[158:159], v[62:63], v[20:21], v[158:159] op_sel_hi:[1,0,1]
    v_pk_fma_f32 v[88:89], v[88:89], v[22:23], v[20:21] op_sel:[0,0,1] op_sel_hi:[1,0,1]
    v_pk_fma_f32 v[90:91], v[90:91], v[22:23], v[20:21] op_sel:[0,0,1] op_sel_hi:[1,0,1]
    v_pk_mul_f32 v[156:157], v[156:157], v[148:149]
    v_pk_mul_f32 v[88:89], v[88:89], v[148:149]
    v_pk_mul_f32 v[90:91], v[90:91], v[150:151]
    v_pk_mul_f32 v[158:159], v[158:159], v[150:151]
    v_exp_f32 v88, v88
    v_exp_f32 v89, v89
    v_exp_f32 v90, v90
    v_exp_f32 v91, v91
    v_pk_mul_f32 v[80:81], v[80:81], v[152:153]
    v_pk_mul_f32 v[82:83], v[82:83], v[154:155]
    v_cvt_pk_bf16_f32 v144, v80, v81
    v_cvt_pk_bf16_f32 v145, v82, v83
    v_pk_fma_f32 v[88:89], v[88:89], v[22:23], v[22:23] op_sel:[0,1,1] op_sel_hi:[1,1,1]
    v_pk_fma_f32 v[90:91], v[90:91], v[22:23], v[22:23] op_sel:[0,1,1] op_sel_hi:[1,1,1]
    v_rcp_f32 v88, v88
    v_rcp_f32 v89, v89
    v_rcp_f32 v90, v90
    v_rcp_f32 v91, v91
    v_pk_fma_f32 v[160:161], v[48:49], v[24:25], v[160:161] op_sel_hi:[1,0,1]
    v_pk_fma_f32 v[162:163], v[50:51], v[24:25], v[162:163] op_sel_hi:[1,0,1]
    v_pk_fma_f32 v[168:169], v[56:57], v[24:25], v[168:169] op_sel_hi:[1,0,1]
    v_pk_mul_f32 v[64:65], v[160:161], v[160:161]
    v_pk_mul_f32 v[66:67], v[162:163], v[162:163]
    v_pk_fma_f32 v[170:171], v[58:59], v[24:25], v[170:171] op_sel_hi:[1,0,1]
    v_pk_fma_f32 v[64:65], v[64:65], v[26:27], v[24:25] op_sel:[0,0,1] op_sel_hi:[1,0,1]
    v_pk_fma_f32 v[66:67], v[66:67], v[26:27], v[24:25] op_sel:[0,0,1] op_sel_hi:[1,0,1]
    v_pk_mul_f32 v[168:169], v[168:169], v[160:161]
    v_pk_mul_f32 v[64:65], v[64:65], v[160:161]
    v_pk_mul_f32 v[66:67], v[66:67], v[162:163]
    v_pk_mul_f32 v[170:171], v[170:171], v[162:163]
    v_exp_f32 v64, v64
    v_exp_f32 v65, v65
    v_exp_f32 v66, v66
    v_exp_f32 v67, v67
    v_pk_mul_f32 v[88:89], v[88:89], v[156:157]
    v_pk_mul_f32 v[90:91], v[90:91], v[158:159]
    v_cvt_pk_bf16_f32 v146, v88, v89
    v_cvt_pk_bf16_f32 v147, v90, v91
    buffer_store_dwordx4 v[144:147], v15, s[32:35], s64 offen offset:1024 sc1
    v_pk_fma_f32 v[64:65], v[64:65], v[26:27], v[26:27] op_sel:[0,1,1] op_sel_hi:[1,1,1]
    v_pk_fma_f32 v[66:67], v[66:67], v[26:27], v[26:27] op_sel:[0,1,1] op_sel_hi:[1,1,1]
    v_rcp_f32 v64, v64
    v_rcp_f32 v65, v65
    v_rcp_f32 v66, v66
    v_rcp_f32 v67, v67
    v_pk_fma_f32 v[164:165], v[52:53], v[24:25], v[164:165] op_sel_hi:[1,0,1]
    v_pk_fma_f32 v[166:167], v[54:55], v[24:25], v[166:167] op_sel_hi:[1,0,1]
    v_pk_fma_f32 v[172:173], v[60:61], v[24:25], v[172:173] op_sel_hi:[1,0,1]
    v_pk_mul_f32 v[72:73], v[164:165], v[164:165]
    v_pk_mul_f32 v[74:75], v[166:167], v[166:167]
    v_pk_fma_f32 v[174:175], v[62:63], v[24:25], v[174:175] op_sel_hi:[1,0,1]
    v_pk_fma_f32 v[72:73], v[72:73], v[26:27], v[24:25] op_sel:[0,0,1] op_sel_hi:[1,0,1]
    v_pk_fma_f32 v[74:75], v[74:75], v[26:27], v[24:25] op_sel:[0,0,1] op_sel_hi:[1,0,1]
    v_pk_mul_f32 v[172:173], v[172:173], v[164:165]
    v_pk_mul_f32 v[72:73], v[72:73], v[164:165]
    v_pk_mul_f32 v[74:75], v[74:75], v[166:167]
    v_pk_mul_f32 v[174:175], v[174:175], v[166:167]
    v_exp_f32 v72, v72
    v_exp_f32 v73, v73
    v_exp_f32 v74, v74
    v_exp_f32 v75, v75
    v_pk_mul_f32 v[64:65], v[64:65], v[168:169]
    v_pk_mul_f32 v[66:67], v[66:67], v[170:171]
    v_cvt_pk_bf16_f32 v160, v64, v65
    v_cvt_pk_bf16_f32 v161, v66, v67
    v_pk_fma_f32 v[72:73], v[72:73], v[26:27], v[26:27] op_sel:[0,1,1] op_sel_hi:[1,1,1]
    v_pk_fma_f32 v[74:75], v[74:75], v[26:27], v[26:27] op_sel:[0,1,1] op_sel_hi:[1,1,1]
    v_rcp_f32 v72, v72
    v_rcp_f32 v73, v73
    v_rcp_f32 v74, v74
    v_rcp_f32 v75, v75
    v_pk_fma_f32 v[176:177], v[48:49], v[28:29], v[176:177] op_sel_hi:[1,0,1]
    v_pk_fma_f32 v[178:179], v[50:51], v[28:29], v[178:179] op_sel_hi:[1,0,1]
    v_pk_fma_f32 v[184:185], v[56:57], v[28:29], v[184:185] op_sel_hi:[1,0,1]
    v_pk_mul_f32 v[80:81], v[176:177], v[176:177]
    v_pk_mul_f32 v[82:83], v[178:179], v[178:179]
    v_pk_fma_f32 v[186:187], v[58:59], v[28:29], v[186:187] op_sel_hi:[1,0,1]
    v_pk_fma_f32 v[80:81], v[80:81], v[30:31], v[28:29] op_sel:[0,0,1] op_sel_hi:[1,0,1]
    v_pk_fma_f32 v[82:83], v[82:83], v[30:31], v[28:29] op_sel:[0,0,1] op_sel_hi:[1,0,1]
    v_pk_mul_f32 v[184:185], v[184:185], v[176:177]
    v_pk_mul_f32 v[80:81], v[80:81], v[176:177]
    v_pk_mul_f32 v[82:83], v[82:83], v[178:179]
    v_pk_mul_f32 v[186:187], v[186:187], v[178:179]
    v_exp_f32 v80, v80
    v_exp_f32 v81, v81
    v_exp_f32 v82, v82
    v_exp_f32 v83, v83
    v_pk_mul_f32 v[72:73], v[72:73], v[172:173]
    v_pk_mul_f32 v[74:75], v[74:75], v[174:175]
    v_cvt_pk_bf16_f32 v162, v72, v73
    v_cvt_pk_bf16_f32 v163, v74, v75
    buffer_store_dwordx4 v[160:163], v15, s[32:35], s64 offen offset:2048 sc1
    v_pk_fma_f32 v[80:81], v[80:81], v[30:31], v[30:31] op_sel:[0,1,1] op_sel_hi:[1,1,1]
    v_pk_fma_f32 v[82:83], v[82:83], v[30:31], v[30:31] op_sel:[0,1,1] op_sel_hi:[1,1,1]
    v_rcp_f32 v80, v80
    v_rcp_f32 v81, v81
    v_rcp_f32 v82, v82
    v_rcp_f32 v83, v83
    v_pk_fma_f32 v[180:181], v[52:53], v[28:29], v[180:181] op_sel_hi:[1,0,1]
    v_pk_fma_f32 v[182:183], v[54:55], v[28:29], v[182:183] op_sel_hi:[1,0,1]
    v_pk_fma_f32 v[188:189], v[60:61], v[28:29], v[188:189] op_sel_hi:[1,0,1]
    v_pk_mul_f32 v[88:89], v[180:181], v[180:181]
    v_pk_mul_f32 v[90:91], v[182:183], v[182:183]
    v_pk_fma_f32 v[190:191], v[62:63], v[28:29], v[190:191] op_sel_hi:[1,0,1]
    v_pk_fma_f32 v[88:89], v[88:89], v[30:31], v[28:29] op_sel:[0,0,1] op_sel_hi:[1,0,1]
    v_pk_fma_f32 v[90:91], v[90:91], v[30:31], v[28:29] op_sel:[0,0,1] op_sel_hi:[1,0,1]
    v_pk_mul_f32 v[188:189], v[188:189], v[180:181]
    v_pk_mul_f32 v[88:89], v[88:89], v[180:181]
    v_pk_mul_f32 v[90:91], v[90:91], v[182:183]
    v_pk_mul_f32 v[190:191], v[190:191], v[182:183]
    v_exp_f32 v88, v88
    v_exp_f32 v89, v89
    v_exp_f32 v90, v90
    v_exp_f32 v91, v91
    v_pk_mul_f32 v[80:81], v[80:81], v[184:185]
    v_pk_mul_f32 v[82:83], v[82:83], v[186:187]
    v_cvt_pk_bf16_f32 v176, v80, v81
    v_cvt_pk_bf16_f32 v177, v82, v83
    v_pk_fma_f32 v[88:89], v[88:89], v[30:31], v[30:31] op_sel:[0,1,1] op_sel_hi:[1,1,1]
    v_pk_fma_f32 v[90:91], v[90:91], v[30:31], v[30:31] op_sel:[0,1,1] op_sel_hi:[1,1,1]
    v_rcp_f32 v88, v88
    v_rcp_f32 v89, v89
    v_rcp_f32 v90, v90
    v_rcp_f32 v91, v91
    v_pk_fma_f32 v[192:193], v[48:49], v[32:33], v[192:193] op_sel_hi:[1,0,1]
    v_pk_fma_f32 v[194:195], v[50:51], v[32:33], v[194:195] op_sel_hi:[1,0,1]
    v_pk_fma_f32 v[200:201], v[56:57], v[32:33], v[200:201] op_sel_hi:[1,0,1]
    v_pk_mul_f32 v[64:65], v[192:193], v[192:193]
    v_pk_mul_f32 v[66:67], v[194:195], v[194:195]
    v_pk_fma_f32 v[202:203], v[58:59], v[32:33], v[202:203] op_sel_hi:[1,0,1]
    v_pk_fma_f32 v[64:65], v[64:65], v[34:35], v[32:33] op_sel:[0,0,1] op_sel_hi:[1,0,1]
    v_pk_fma_f32 v[66:67], v[66:67], v[34:35], v[32:33] op_sel:[0,0,1] op_sel_hi:[1,0,1]
    v_pk_mul_f32 v[200:201], v[200:201], v[192:193]
    v_pk_mul_f32 v[64:65], v[64:65], v[192:193]
    v_pk_mul_f32 v[66:67], v[66:67], v[194:195]
    v_pk_mul_f32 v[202:203], v[202:203], v[194:195]
    v_exp_f32 v64, v64
    v_exp_f32 v65, v65
    v_exp_f32 v66, v66
    v_exp_f32 v67, v67
    v_pk_mul_f32 v[88:89], v[88:89], v[188:189]
    v_pk_mul_f32 v[90:91], v[90:91], v[190:191]
    v_cvt_pk_bf16_f32 v178, v88, v89
    v_cvt_pk_bf16_f32 v179, v90, v91
    buffer_store_dwordx4 v[176:179], v15, s[32:35], s64 offen offset:3072 sc1
    v_pk_fma_f32 v[64:65], v[64:65], v[34:35], v[34:35] op_sel:[0,1,1] op_sel_hi:[1,1,1]
    v_pk_fma_f32 v[66:67], v[66:67], v[34:35], v[34:35] op_sel:[0,1,1] op_sel_hi:[1,1,1]
    v_rcp_f32 v64, v64
    v_rcp_f32 v65, v65
    v_rcp_f32 v66, v66
    v_rcp_f32 v67, v67
    v_pk_fma_f32 v[196:197], v[52:53], v[32:33], v[196:197] op_sel_hi:[1,0,1]
    v_pk_fma_f32 v[198:199], v[54:55], v[32:33], v[198:199] op_sel_hi:[1,0,1]
    v_pk_fma_f32 v[204:205], v[60:61], v[32:33], v[204:205] op_sel_hi:[1,0,1]
    v_pk_mul_f32 v[72:73], v[196:197], v[196:197]
    v_pk_mul_f32 v[74:75], v[198:199], v[198:199]
    v_pk_fma_f32 v[206:207], v[62:63], v[32:33], v[206:207] op_sel_hi:[1,0,1]
    v_pk_fma_f32 v[72:73], v[72:73], v[34:35], v[32:33] op_sel:[0,0,1] op_sel_hi:[1,0,1]
    v_pk_fma_f32 v[74:75], v[74:75], v[34:35], v[32:33] op_sel:[0,0,1] op_sel_hi:[1,0,1]
    v_pk_mul_f32 v[204:205], v[204:205], v[196:197]
    v_pk_mul_f32 v[72:73], v[72:73], v[196:197]
    v_pk_mul_f32 v[74:75], v[74:75], v[198:199]
    v_pk_mul_f32 v[206:207], v[206:207], v[198:199]
    v_exp_f32 v72, v72
    v_exp_f32 v73, v73
    v_exp_f32 v74, v74
    v_exp_f32 v75, v75
    v_pk_mul_f32 v[64:65], v[64:65], v[200:201]
    v_pk_mul_f32 v[66:67], v[66:67], v[202:203]
    v_cvt_pk_bf16_f32 v192, v64, v65
    v_cvt_pk_bf16_f32 v193, v66, v67
    v_pk_fma_f32 v[72:73], v[72:73], v[34:35], v[34:35] op_sel:[0,1,1] op_sel_hi:[1,1,1]
    v_pk_fma_f32 v[74:75], v[74:75], v[34:35], v[34:35] op_sel:[0,1,1] op_sel_hi:[1,1,1]
    v_rcp_f32 v72, v72
    v_rcp_f32 v73, v73
    v_rcp_f32 v74, v74
    v_rcp_f32 v75, v75
    v_pk_fma_f32 v[208:209], v[48:49], v[36:37], v[208:209] op_sel_hi:[1,0,1]
    v_pk_fma_f32 v[210:211], v[50:51], v[36:37], v[210:211] op_sel_hi:[1,0,1]
    v_pk_fma_f32 v[216:217], v[56:57], v[36:37], v[216:217] op_sel_hi:[1,0,1]
    v_pk_mul_f32 v[80:81], v[208:209], v[208:209]
    v_pk_mul_f32 v[82:83], v[210:211], v[210:211]
    v_pk_fma_f32 v[218:219], v[58:59], v[36:37], v[218:219] op_sel_hi:[1,0,1]
    v_pk_fma_f32 v[80:81], v[80:81], v[38:39], v[36:37] op_sel:[0,0,1] op_sel_hi:[1,0,1]
    v_pk_fma_f32 v[82:83], v[82:83], v[38:39], v[36:37] op_sel:[0,0,1] op_sel_hi:[1,0,1]
    v_pk_mul_f32 v[216:217], v[216:217], v[208:209]
    v_pk_mul_f32 v[80:81], v[80:81], v[208:209]
    v_pk_mul_f32 v[82:83], v[82:83], v[210:211]
    v_pk_mul_f32 v[218:219], v[218:219], v[210:211]
    v_exp_f32 v80, v80
    v_exp_f32 v81, v81
    v_exp_f32 v82, v82
    v_exp_f32 v83, v83
    v_pk_mul_f32 v[72:73], v[72:73], v[204:205]
    v_pk_mul_f32 v[74:75], v[74:75], v[206:207]
    v_cvt_pk_bf16_f32 v194, v72, v73
    v_cvt_pk_bf16_f32 v195, v74, v75
    buffer_store_dwordx4 v[192:195], v15, s[32:35], s65 offen offset:0 sc1
    v_pk_fma_f32 v[80:81], v[80:81], v[38:39], v[38:39] op_sel:[0,1,1] op_sel_hi:[1,1,1]
    v_pk_fma_f32 v[82:83], v[82:83], v[38:39], v[38:39] op_sel:[0,1,1] op_sel_hi:[1,1,1]
    v_rcp_f32 v80, v80
    v_rcp_f32 v81, v81
    v_rcp_f32 v82, v82
    v_rcp_f32 v83, v83
    v_pk_fma_f32 v[212:213], v[52:53], v[36:37], v[212:213] op_sel_hi:[1,0,1]
    v_pk_fma_f32 v[214:215], v[54:55], v[36:37], v[214:215] op_sel_hi:[1,0,1]
    v_pk_fma_f32 v[220:221], v[60:61], v[36:37], v[220:221] op_sel_hi:[1,0,1]
    v_pk_mul_f32 v[88:89], v[212:213], v[212:213]
    v_pk_mul_f32 v[90:91], v[214:215], v[214:215]
    v_pk_fma_f32 v[222:223], v[62:63], v[36:37], v[222:223] op_sel_hi:[1,0,1]
    v_pk_fma_f32 v[88:89], v[88:89], v[38:39], v[36:37] op_sel:[0,0,1] op_sel_hi:[1,0,1]
    v_pk_fma_f32 v[90:91], v[90:91], v[38:39], v[36:37] op_sel:[0,0,1] op_sel_hi:[1,0,1]
    v_pk_mul_f32 v[220:221], v[220:221], v[212:213]
    v_pk_mul_f32 v[88:89], v[88:89], v[212:213]
    v_pk_mul_f32 v[90:91], v[90:91], v[214:215]
    v_pk_mul_f32 v[222:223], v[222:223], v[214:215]
    v_exp_f32 v88, v88
    v_exp_f32 v89, v89
    v_exp_f32 v90, v90
    v_exp_f32 v91, v91
    v_pk_mul_f32 v[80:81], v[80:81], v[216:217]
    v_pk_mul_f32 v[82:83], v[82:83], v[218:219]
    v_cvt_pk_bf16_f32 v208, v80, v81
    v_cvt_pk_bf16_f32 v209, v82, v83
    v_pk_fma_f32 v[88:89], v[88:89], v[38:39], v[38:39] op_sel:[0,1,1] op_sel_hi:[1,1,1]
    v_pk_fma_f32 v[90:91], v[90:91], v[38:39], v[38:39] op_sel:[0,1,1] op_sel_hi:[1,1,1]
    v_rcp_f32 v88, v88
    v_rcp_f32 v89, v89
    v_rcp_f32 v90, v90
    v_rcp_f32 v91, v91
    v_pk_fma_f32 v[224:225], v[48:49], v[40:41], v[224:225] op_sel_hi:[1,0,1]
    v_pk_fma_f32 v[226:227], v[50:51], v[40:41], v[226:227] op_sel_hi:[1,0,1]
    v_pk_fma_f32 v[232:233], v[56:57], v[40:41], v[232:233] op_sel_hi:[1,0,1]
    v_pk_mul_f32 v[64:65], v[224:225], v[224:225]
    v_pk_mul_f32 v[66:67], v[226:227], v[226:227]
    v_pk_fma_f32 v[234:235], v[58:59], v[40:41], v[234:235] op_sel_hi:[1,0,1]
    v_pk_fma_f32 v[64:65], v[64:65], v[42:43], v[40:41] op_sel:[0,0,1] op_sel_hi:[1,0,1]
    v_pk_fma_f32 v[66:67], v[66:67], v[42:43], v[40:41] op_sel:[0,0,1] op_sel_hi:[1,0,1]
    v_pk_mul_f32 v[232:233], v[232:233], v[224:225]
    v_pk_mul_f32 v[64:65], v[64:65], v[224:225]
    v_pk_mul_f32 v[66:67], v[66:67], v[226:227]
    v_pk_mul_f32 v[234:235], v[234:235], v[226:227]
    v_exp_f32 v64, v64
    v_exp_f32 v65, v65
    v_exp_f32 v66, v66
    v_exp_f32 v67, v67
    v_pk_mul_f32 v[88:89], v[88:89], v[220:221]
    v_pk_mul_f32 v[90:91], v[90:91], v[222:223]
    v_cvt_pk_bf16_f32 v210, v88, v89
    v_cvt_pk_bf16_f32 v211, v90, v91
    buffer_store_dwordx4 v[208:211], v15, s[32:35], s65 offen offset:1024 sc1
    v_pk_fma_f32 v[64:65], v[64:65], v[42:43], v[42:43] op_sel:[0,1,1] op_sel_hi:[1,1,1]
    v_pk_fma_f32 v[66:67], v[66:67], v[42:43], v[42:43] op_sel:[0,1,1] op_sel_hi:[1,1,1]
    v_rcp_f32 v64, v64
    v_rcp_f32 v65, v65
    v_rcp_f32 v66, v66
    v_rcp_f32 v67, v67
    v_pk_fma_f32 v[228:229], v[52:53], v[40:41], v[228:229] op_sel_hi:[1,0,1]
    v_pk_fma_f32 v[230:231], v[54:55], v[40:41], v[230:231] op_sel_hi:[1,0,1]
    v_pk_fma_f32 v[236:237], v[60:61], v[40:41], v[236:237] op_sel_hi:[1,0,1]
    v_pk_mul_f32 v[72:73], v[228:229], v[228:229]
    v_pk_mul_f32 v[74:75], v[230:231], v[230:231]
    v_pk_fma_f32 v[238:239], v[62:63], v[40:41], v[238:239] op_sel_hi:[1,0,1]
    v_pk_fma_f32 v[72:73], v[72:73], v[42:43], v[40:41] op_sel:[0,0,1] op_sel_hi:[1,0,1]
    v_pk_fma_f32 v[74:75], v[74:75], v[42:43], v[40:41] op_sel:[0,0,1] op_sel_hi:[1,0,1]
    v_pk_mul_f32 v[236:237], v[236:237], v[228:229]
    v_pk_mul_f32 v[72:73], v[72:73], v[228:229]
    v_pk_mul_f32 v[74:75], v[74:75], v[230:231]
    v_pk_mul_f32 v[238:239], v[238:239], v[230:231]
    v_exp_f32 v72, v72
    v_exp_f32 v73, v73
    v_exp_f32 v74, v74
    v_exp_f32 v75, v75
    v_pk_mul_f32 v[64:65], v[64:65], v[232:233]
    v_pk_mul_f32 v[66:67], v[66:67], v[234:235]
    v_cvt_pk_bf16_f32 v224, v64, v65
    v_cvt_pk_bf16_f32 v225, v66, v67
    v_pk_fma_f32 v[72:73], v[72:73], v[42:43], v[42:43] op_sel:[0,1,1] op_sel_hi:[1,1,1]
    v_pk_fma_f32 v[74:75], v[74:75], v[42:43], v[42:43] op_sel:[0,1,1] op_sel_hi:[1,1,1]
    v_rcp_f32 v72, v72
    v_rcp_f32 v73, v73
    v_rcp_f32 v74, v74
    v_rcp_f32 v75, v75
    v_pk_fma_f32 v[240:241], v[48:49], v[44:45], v[240:241] op_sel_hi:[1,0,1]
    v_pk_fma_f32 v[242:243], v[50:51], v[44:45], v[242:243] op_sel_hi:[1,0,1]
    v_pk_fma_f32 v[248:249], v[56:57], v[44:45], v[248:249] op_sel_hi:[1,0,1]
    v_pk_mul_f32 v[80:81], v[240:241], v[240:241]
    v_pk_mul_f32 v[82:83], v[242:243], v[242:243]
    v_pk_fma_f32 v[250:251], v[58:59], v[44:45], v[250:251] op_sel_hi:[1,0,1]
    v_pk_fma_f32 v[80:81], v[80:81], v[46:47], v[44:45] op_sel:[0,0,1] op_sel_hi:[1,0,1]
    v_pk_fma_f32 v[82:83], v[82:83], v[46:47], v[44:45] op_sel:[0,0,1] op_sel_hi:[1,0,1]
    v_pk_mul_f32 v[248:249], v[248:249], v[240:241]
    v_pk_mul_f32 v[80:81], v[80:81], v[240:241]
    v_pk_mul_f32 v[82:83], v[82:83], v[242:243]
    v_pk_mul_f32 v[250:251], v[250:251], v[242:243]
    v_exp_f32 v80, v80
    v_exp_f32 v81, v81
    v_exp_f32 v82, v82
    v_exp_f32 v83, v83
    v_pk_mul_f32 v[72:73], v[72:73], v[236:237]
    v_pk_mul_f32 v[74:75], v[74:75], v[238:239]
    v_cvt_pk_bf16_f32 v226, v72, v73
    v_cvt_pk_bf16_f32 v227, v74, v75
    buffer_store_dwordx4 v[224:227], v15, s[32:35], s65 offen offset:2048 sc1
    v_pk_fma_f32 v[80:81], v[80:81], v[46:47], v[46:47] op_sel:[0,1,1] op_sel_hi:[1,1,1]
    v_pk_fma_f32 v[82:83], v[82:83], v[46:47], v[46:47] op_sel:[0,1,1] op_sel_hi:[1,1,1]
    v_rcp_f32 v80, v80
    v_rcp_f32 v81, v81
    v_rcp_f32 v82, v82
    v_rcp_f32 v83, v83
    v_pk_fma_f32 v[244:245], v[52:53], v[44:45], v[244:245] op_sel_hi:[1,0,1]
    v_pk_fma_f32 v[246:247], v[54:55], v[44:45], v[246:247] op_sel_hi:[1,0,1]
    v_pk_fma_f32 v[252:253], v[60:61], v[44:45], v[252:253] op_sel_hi:[1,0,1]
    v_pk_mul_f32 v[88:89], v[244:245], v[244:245]
    v_pk_mul_f32 v[90:91], v[246:247], v[246:247]
    v_pk_fma_f32 v[254:255], v[62:63], v[44:45], v[254:255] op_sel_hi:[1,0,1]
    v_pk_fma_f32 v[88:89], v[88:89], v[46:47], v[44:45] op_sel:[0,0,1] op_sel_hi:[1,0,1]
    v_pk_fma_f32 v[90:91], v[90:91], v[46:47], v[44:45] op_sel:[0,0,1] op_sel_hi:[1,0,1]
    v_pk_mul_f32 v[252:253], v[252:253], v[244:245]
    v_pk_mul_f32 v[88:89], v[88:89], v[244:245]
    v_pk_mul_f32 v[90:91], v[90:91], v[246:247]
    v_pk_mul_f32 v[254:255], v[254:255], v[246:247]
    v_exp_f32 v88, v88
    v_exp_f32 v89, v89
    v_exp_f32 v90, v90
    v_exp_f32 v91, v91
    v_pk_mul_f32 v[80:81], v[80:81], v[248:249]
    v_pk_mul_f32 v[82:83], v[82:83], v[250:251]
    v_cvt_pk_bf16_f32 v240, v80, v81
    v_cvt_pk_bf16_f32 v241, v82, v83
    v_pk_fma_f32 v[88:89], v[88:89], v[46:47], v[46:47] op_sel:[0,1,1] op_sel_hi:[1,1,1]
    v_pk_fma_f32 v[90:91], v[90:91], v[46:47], v[46:47] op_sel:[0,1,1] op_sel_hi:[1,1,1]
    v_rcp_f32 v88, v88
    v_rcp_f32 v89, v89
    v_rcp_f32 v90, v90
    v_rcp_f32 v91, v91
    s_nop 0
    v_pk_mul_f32 v[88:89], v[88:89], v[252:253]
    v_pk_mul_f32 v[90:91], v[90:91], v[254:255]
    v_cvt_pk_bf16_f32 v242, v88, v89
    v_cvt_pk_bf16_f32 v243, v90, v91
    buffer_store_dwordx4 v[240:243], v15, s[32:35], s65 offen offset:3072 sc1
    s_waitcnt vmcnt(8)
    s_branch L_conv
L_y0:
    v_mfma_f32_16x16x32_bf16 v[48:51], v[64:67], v[16:19], v[48:51]
    v_mfma_f32_16x16x32_bf16 v[52:55], v[68:71], v[16:19], v[52:55]
    v_mfma_f32_16x16x32_bf16 v[56:59], v[72:75], v[16:19], v[56:59]
    v_mfma_f32_16x16x32_bf16 v[60:63], v[76:79], v[16:19], v[60:63]
    s_branch L_x0
L_y1:
    v_mfma_f32_16x16x32_bf16 v[48:51], v[80:83], v[16:19], v[48:51]
    v_mfma_f32_16x16x32_bf16 v[52:55], v[84:87], v[16:19], v[52:55]
    v_mfma_f32_16x16x32_bf16 v[56:59], v[88:91], v[16:19], v[56:59]
    v_mfma_f32_16x16x32_bf16 v[60:63], v[92:95], v[16:19], v[60:63]
    s_branch L_x1
L_y2:
    v_mfma_f32_16x16x32_bf16 v[48:51], v[64:67], v[16:19], v[48:51]
    v_mfma_f32_16x16x32_bf16 v[52:55], v[68:71], v[16:19], v[52:55]
    v_mfma_f32_16x16x32_bf16 v[56:59], v[72:75], v[16:19], v[56:59]
    v_mfma_f32_16x16x32_bf16 v[60:63], v[76:79], v[16:19], v[60:63]
    s_branch L_x2
L_y3:
    v_mfma_f32_16x16x32_bf16 v[48:51], v[80:83], v[16:19], v[48:51]
    v_mfma_f32_16x16x32_bf16 v[52:55], v[84:87], v[16:19], v[52:55]
    v_mfma_f32_16x16x32_bf16 v[56:59], v[88:91], v[16:19], v[56:59]
    v_mfma_f32_16x16x32_bf16 v[60:63], v[92:95], v[16:19], v[60:63]
    s_branch L_x3
L_y4:
    v_mfma_f32_16x16x32_bf16 v[48:51], v[64:67], v[16:19], v[48:51]
    v_mfma_f32_16x16x32_bf16 v[52:55], v[68:71], v[16:19], v[52:55]
    v_mfma_f32_16x16x32_bf16 v[56:59], v[72:75], v[16:19], v[56:59]
    v_mfma_f32_16x16x32_bf16 v[60:63], v[76:79], v[16:19], v[60:63]
    s_branch L_x4
L_y5:
    v_mfma_f32_16x16x32_bf16 v[48:51], v[80:83], v[16:19], v[48:51]
    v_mfma_f32_16x16x32_bf16 v[52:55], v[84:87], v[16:19], v[52:55]
    v_mfma_f32_16x16x32_bf16 v[56:59], v[88:91], v[16:19], v[56:59]
    v_mfma_f32_16x16x32_bf16 v[60:63], v[92:95], v[16:19], v[60:63]
    s_branch L_x5
L_y6:
    v_mfma_f32_16x16x32_bf16 v[48:51], v[64:67], v[16:19], v[48:51]
    v_mfma_f32_16x16x32_bf16 v[52:55], v[68:71], v[16:19], v[52:55]
    v_mfma_f32_16x16x32_bf16 v[56:59], v[72:75], v[16:19], v[56:59]
    v_mfma_f32_16x16x32_bf16 v[60:63], v[76:79], v[16:19], v[60:63]
    s_branch L_x6
L_y7:
    v_mfma_f32_16x16x32_bf16 v[48:51], v[80:83], v[16:19], v[48:51]
    v_mfma_f32_16x16x32_bf16 v[52:55], v[84:87], v[16:19], v[52:55]
    v_mfma_f32_16x16x32_bf16 v[56:59], v[88:91], v[16:19], v[56:59]
    v_mfma_f32_16x16x32_bf16 v[60:63], v[92:95], v[16:19], v[60:63]
    s_branch L_x7
L_y8:
    v_mfma_f32_16x16x32_bf16 v[48:51], v[64:67], v[16:19], v[48:51]
    v_mfma_f32_16x16x32_bf16 v[52:55], v[68:71], v[16:19], v[52:55]
    v_mfma_f32_16x16x32_bf16 v[56:59], v[72:75], v[16:19], v[56:59]
    v_mfma_f32_16x16x32_bf16 v[60:63], v[76:79], v[16:19], v[60:63]
    s_branch L_x8
L_y9:
    v_mfma_f32_16x16x32_bf16 v[48:51], v[80:83], v[16:19], v[48:51]
    v_mfma_f32_16x16x32_bf16 v[52:55], v[84:87], v[16:19], v[52:55]
    v_mfma_f32_16x16x32_bf16 v[56:59], v[88:91], v[16:19], v[56:59]
    v_mfma_f32_16x16x32_bf16 v[60:63], v[92:95], v[16:19], v[60:63]
    s_branch L_x9
L_y10:
    v_mfma_f32_16x16x32_bf16 v[48:51], v[64:67], v[16:19], v[48:51]
    v_mfma_f32_16x16x32_bf16 v[52:55], v[68:71], v[16:19], v[52:55]
    v_mfma_f32_16x16x32_bf16 v[56:59], v[72:75], v[16:19], v[56:59]
    v_mfma_f32_16x16x32_bf16 v[60:63], v[76:79], v[16:19], v[60:63]
    s_branch L_x10
L_y11:
    v_mfma_f32_16x16x32_bf16 v[48:51], v[80:83], v[16:19], v[48:51]
    v_mfma_f32_16x16x32_bf16 v[52:55], v[84:87], v[16:19], v[52:55]
    v_mfma_f32_16x16x32_bf16 v[56:59], v[88:91], v[16:19], v[56:59]
    v_mfma_f32_16x16x32_bf16 v[60:63], v[92:95], v[16:19], v[60:63]
    s_branch L_x11
L_y12:
    v_mfma_f32_16x16x32_bf16 v[48:51], v[64:67], v[16:19], v[48:51]
    v_mfma_f32_16x16x32_bf16 v[52:55], v[68:71], v[16:19], v[52:55]
    v_mfma_f32_16x16x32_bf16 v[56:59], v[72:75], v[16:19], v[56:59]
    v_mfma_f32_16x16x32_bf16 v[60:63], v[76:79], v[16:19], v[60:63]
    s_branch L_x12
L_y13:
    v_mfma_f32_16x16x32_bf16 v[48:51], v[80:83], v[16:19], v[48:51]
    v_mfma_f32_16x16x32_bf16 v[52:55], v[84:87], v[16:19], v[52:55]
    v_mfma_f32_16x16x32_bf16 v[56:59], v[88:91], v[16:19], v[56:59]
    v_mfma_f32_16x16x32_bf16 v[60:63], v[92:95], v[16:19], v[60:63]
    s_branch L_x13
L_y14:
    v_mfma_f32_16x16x32_bf16 v[48:51], v[64:67], v[16:19], v[48:51]
    v_mfma_f32_16x16x32_bf16 v[52:55], v[68:71], v[16:19], v[52:55]
    v_mfma_f32_16x16x32_bf16 v[56:59], v[72:75], v[16:19], v[56:59]
    v_mfma_f32_16x16x32_bf16 v[60:63], v[76:79], v[16:19], v[60:63]
    s_branch L_x14
L_y15:
    v_mfma_f32_16x16x32_bf16 v[48:51], v[80:83], v[16:19], v[48:51]
    v_mfma_f32_16x16x32_bf16 v[52:55], v[84:87], v[16:19], v[52:55]
    v_mfma_f32_16x16x32_bf16 v[56:59], v[88:91], v[16:19], v[56:59]
    v_mfma_f32_16x16x32_bf16 v[60:63], v[92:95], v[16:19], v[60:63]
    s_branch L_x15
L_y16:
    v_mfma_f32_16x16x32_bf16 v[48:51], v[64:67], v[16:19], v[48:51]
    v_mfma_f32_16x16x32_bf16 v[52:55], v[68:71], v[16:19], v[52:55]
    v_mfma_f32_16x16x32_bf16 v[56:59], v[72:75], v[16:19], v[56:59]
    v_mfma_f32_16x16x32_bf16 v[60:63], v[76:79], v[16:19], v[60:63]
    s_branch L_x16
L_y17:
    v_mfma_f32_16x16x32_bf16 v[48:51], v[80:83], v[16:19], v[48:51]
    v_mfma_f32_16x16x32_bf16 v[52:55], v[84:87], v[16:19], v[52:55]
    v_mfma_f32_16x16x32_bf16 v[56:59], v[88:91], v[16:19], v[56:59]
    v_mfma_f32_16x16x32_bf16 v[60:63], v[92:95], v[16:19], v[60:63]
    s_branch L_x17
L_y18:
    v_mfma_f32_16x16x32_bf16 v[48:51], v[64:67], v[16:19], v[48:51]
    v_mfma_f32_16x16x32_bf16 v[52:55], v[68:71], v[16:19], v[52:55]
    v_mfma_f32_16x16x32_bf16 v[56:59], v[72:75], v[16:19], v[56:59]
    v_mfma_f32_16x16x32_bf16 v[60:63], v[76:79], v[16:19], v[60:63]
    s_branch L_x18
L_y19:
    v_mfma_f32_16x16x32_bf16 v[48:51], v[80:83], v[16:19], v[48:51]
    v_mfma_f32_16x16x32_bf16 v[52:55], v[84:87], v[16:19], v[52:55]
    v_mfma_f32_16x16x32_bf16 v[56:59], v[88:91], v[16:19], v[56:59]
    v_mfma_f32_16x16x32_bf16 v[60:63], v[92:95], v[16:19], v[60:63]
    s_branch L_x19
L_y20:
    v_mfma_f32_16x16x32_bf16 v[48:51], v[64:67], v[16:19], v[48:51]
    v_mfma_f32_16x16x32_bf16 v[52:55], v[68:71], v[16:19], v[52:55]
    v_mfma_f32_16x16x32_bf16 v[56:59], v[72:75], v[16:19], v[56:59]
    v_mfma_f32_16x16x32_bf16 v[60:63], v[76:79], v[16:19], v[60:63]
    s_branch L_x20
L_y21:
    v_mfma_f32_16x16x32_bf16 v[48:51], v[80:83], v[16:19], v[48:51]
    v_mfma_f32_16x16x32_bf16 v[52:55], v[84:87], v[16:19], v[52:55]
    v_mfma_f32_16x16x32_bf16 v[56:59], v[88:91], v[16:19], v[56:59]
    v_mfma_f32_16x16x32_bf16 v[60:63], v[92:95], v[16:19], v[60:63]
    s_branch L_x21
L_zsl:
    s_mov_b32 s19, 0
L_zsp:
    s_add_u32 s19, s19, 1
    s_cmp_ge_u32 s19, 0x20000
    s_cbranch_scc1 L_zok
    s_sleep 32
    buffer_load_dword v31, v30, s[36:39], 0 offen sc1
    s_waitcnt vmcnt(0)
    v_cmp_gt_u32 vcc, 32, v31
    s_nop 1
    s_cmp_eq_u64 vcc, 0
    s_cbranch_scc0 L_zsp
    s_branch L_zok
L_csl:
    s_mov_b32 s19, 0
L_csp:
    s_add_u32 s19, s19, 1
    s_cmp_ge_u32 s19, 0x20000
    s_cbranch_scc1 L_cok
    s_sleep 8
    buffer_load_dword v35, v14, s[32:35], s72 offen sc1
    s_waitcnt vmcnt(0)
    v_cmp_ne_u32 vcc, 1, v35
    s_nop 1
    s_cmp_eq_u64 vcc, 0
    s_cbranch_scc0 L_csp
    s_branch L_cok
L_usl:
    s_mov_b32 s19, 0
L_usp:
    s_add_u32 s19, s19, 1
    s_cmp_ge_u32 s19, 0x20000
    s_cbranch_scc1 L_uok
    s_sleep 8
    buffer_load_dword v11, v14, s[32:35], s72 offen sc1
    s_waitcnt vmcnt(0)
    v_cmp_ne_u32 vcc, 1, v11
    s_nop 1
    s_cmp_eq_u64 vcc, 0
    s_cbranch_scc0 L_usp
    s_branch L_uok
L_helper:
    s_lshl_b32 s14, s2, 3
    s_add_u32 s14, s14, s3
    s_lshl_b32 s15, s14, 14
    v_lshrrev_b32 v5, 3, v2
    v_and_b32 v6, 7, v2
    v_lshlrev_b32 v7, 11, v5
    v_lshl_add_u32 v7, v6, 4, v7
    s_waitcnt lgkmcnt(0)
    s_and_b32 s29, s29, 0xffff
    s_mov_b32 s30, 0x400000
    s_mov_b32 s31, 0x20000
    s_and_b32 s33, s33, 0xffff
    s_mov_b32 s34, 0x10000000
    s_mov_b32 s35, 0x20000
    s_and_b32 s37, s37, 0xffff
    s_mov_b32 s38, 0x100
    s_mov_b32 s39, 0x20000
    s_cmp_lg_u32 s3, 0
    s_cbranch_scc1 L_noclr
    s_mul_i32 s16, s2, 5120
    s_add_u32 s16, s16, 32571392
    s_add_u32 s17, s16, 4096
    v_lshlrev_b32 v12, 4, v2
    v_mov_b32 v8, 0
    v_mov_b32 v9, 0
    v_mov_b32 v10, 0
    v_mov_b32 v11, 0
    buffer_store_dwordx4 v[8:11], v12, s[32:35], s16 offen sc1
    buffer_store_dwordx4 v[8:11], v12, s[32:35], s16 offen offset:1024 sc1
    buffer_store_dwordx4 v[8:11], v12, s[32:35], s16 offen offset:2048 sc1
    buffer_store_dwordx4 v[8:11], v12, s[32:35], s16 offen offset:3072 sc1
    buffer_store_dwordx4 v[8:11], v12, s[32:35], s17 offen sc1
    s_waitcnt vmcnt(0)
L_noclr:
    s_cmp_lg_u32 s3, 0
    s_cselect_b64 exec, 0, 1
    s_cbranch_execz L_sigZ
    v_mov_b32 v16, 1
    v_mov_b32 v17, 0
    buffer_atomic_add v16, v17, s[36:39], 16 offen sc1
L_sigZ:
    s_mov_b64 exec, -1
    buffer_load_dwordx4 v[128:131], v7, s[28:31], s15 offen offset:0
    buffer_load_dwordx4 v[132:135], v7, s[28:31], s15 offen offset:128
    buffer_load_dwordx4 v[136:139], v7, s[28:31], s15 offen offset:256
    buffer_load_dwordx4 v[140:143], v7, s[28:31], s15 offen offset:384
    buffer_load_dwordx4 v[144:147], v7, s[28:31], s15 offen offset:512
    buffer_load_dwordx4 v[148:151], v7, s[28:31], s15 offen offset:640
    buffer_load_dwordx4 v[152:155], v7, s[28:31], s15 offen offset:768
    buffer_load_dwordx4 v[156:159], v7, s[28:31], s15 offen offset:896
    buffer_load_dwordx4 v[160:163], v7, s[28:31], s15 offen offset:1024
    buffer_load_dwordx4 v[164:167], v7, s[28:31], s15 offen offset:1152
    buffer_load_dwordx4 v[168:171], v7, s[28:31], s15 offen offset:1280
    buffer_load_dwordx4 v[172:175], v7, s[28:31], s15 offen offset:1408
    buffer_load_dwordx4 v[176:179], v7, s[28:31], s15 offen offset:1536
    buffer_load_dwordx4 v[180:183], v7, s[28:31], s15 offen offset:1664
    buffer_load_dwordx4 v[184:187], v7, s[28:31], s15 offen offset:1792
    buffer_load_dwordx4 v[188:191], v7, s[28:31], s15 offen offset:1920
    s_and_b32 s21, s21, 0xffff
    s_mov_b32 s22, 0x700000
    s_mov_b32 s23, 0x20000
    s_and_b32 s25, s25, 0xffff
    s_mov_b32 s26, 0x700000
    s_mov_b32 s27, 0x20000
    s_and_b32 s41, s41, 0xffff
    s_mov_b32 s42, 0x400000
    s_mov_b32 s43, 0x20000
    s_and_b32 s45, s45, 0xffff
    s_mov_b32 s46, 0x400000
    s_mov_b32 s47, 0x20000
    s_and_b32 s49, s49, 0xffff
    s_mov_b32 s50, 0x2000
    s_mov_b32 s51, 0x20000
    s_and_b32 s53, s53, 0xffff
    s_mov_b32 s54, 0x700000
    s_mov_b32 s55, 0x20000
    s_and_b32 s57, s57, 0xffff
    s_mov_b32 s58, 0x400000
    s_mov_b32 s59, 0x20000
    s_and_b32 s61, s61, 0xffff
    s_mov_b32 s62, 0x800
    s_mov_b32 s63, 0x20000
    s_and_b32 s5, s5, 0xffff
    s_mov_b32 s6, 0x400000
    s_mov_b32 s7, 0x20000
    s_cmp_lt_u32 s2, 14
    s_cselect_b32 s96, s20, s24
    s_cselect_b32 s97, s21, s25
    s_mov_b32 s98, 0x700000
    s_mov_b32 s99, 0x20000
    s_cselect_b32 s16, 0, 14
    s_sub_u32 s16, s2, s16
    s_lshl_b32 s15, s16, 9
    s_mul_i32 s16, s3, 14336
    s_add_u32 s15, s15, s16
    s_cmp_ge_u32 s2, 28
    s_cselect_b32 s15, 0x700000, s15
    v_lshrrev_b32 v196, 5, v2
    v_mul_u32_u24 v196, 7168, v196
    v_and_b32 v197, 31, v2
    v_lshl_add_u32 v196, v197, 4, v196
    s_add_u32 s18, s15, 5046272
    buffer_load_dwordx4 v[32:35], v196, s[96:99], s18 offen
    s_add_u32 s18, s15, 5160960
    buffer_load_dwordx4 v[36:39], v196, s[96:99], s18 offen
    s_add_u32 s18, s15, 5275648
    buffer_load_dwordx4 v[40:43], v196, s[96:99], s18 offen
    s_add_u32 s18, s15, 5390336
    buffer_load_dwordx4 v[44:47], v196, s[96:99], s18 offen
    s_add_u32 s18, s15, 5505024
    buffer_load_dwordx4 v[48:51], v196, s[96:99], s18 offen
    s_add_u32 s18, s15, 5619712
    buffer_load_dwordx4 v[52:55], v196, s[96:99], s18 offen
    s_add_u32 s18, s15, 5734400
    buffer_load_dwordx4 v[56:59], v196, s[96:99], s18 offen
    s_add_u32 s18, s15, 5849088
    buffer_load_dwordx4 v[60:63], v196, s[96:99], s18 offen
    s_add_u32 s18, s15, 5963776
    buffer_load_dwordx4 v[64:67], v196, s[96:99], s18 offen
    s_add_u32 s18, s15, 6078464
    buffer_load_dwordx4 v[68:71], v196, s[96:99], s18 offen
    s_add_u32 s18, s15, 6193152
    buffer_load_dwordx4 v[72:75], v196, s[96:99], s18 offen
    s_add_u32 s18, s15, 6307840
    buffer_load_dwordx4 v[76:79], v196, s[96:99], s18 offen
    s_add_u32 s18, s15, 6422528
    buffer_load_dwordx4 v[80:83], v196, s[96:99], s18 offen
    s_add_u32 s18, s15, 6537216
    buffer_load_dwordx4 v[84:87], v196, s[96:99], s18 offen
    s_add_u32 s18, s15, 6651904
    buffer_load_dwordx4 v[88:91], v196, s[96:99], s18 offen
    s_add_u32 s18, s15, 6766592
    buffer_load_dwordx4 v[92:95], v196, s[96:99], s18 offen
    s_add_u32 s18, s15, 6881280
    buffer_load_dwordx4 v[96:99], v196, s[96:99], s18 offen
    s_add_u32 s18, s15, 6995968
    buffer_load_dwordx4 v[100:103], v196, s[96:99], s18 offen
    s_add_u32 s18, s15, 7110656
    buffer_load_dwordx4 v[104:107], v196, s[96:99], s18 offen
    s_add_u32 s18, s15, 7225344
    buffer_load_dwordx4 v[108:111], v196, s[96:99], s18 offen
    s_lshl_b32 s16, s3, 7
    v_lshl_add_u32 v197, v6, 4, s16
    v_lshlrev_b32 v198, 2, v197
    s_lshl_b32 s17, s2, 6
    v_lshl_add_u32 v196, v5, 3, s17
    v_lshl_add_u32 v197, v196, 11, v197
    v_lshlrev_b32 v196, 1, v196
    v_lshlrev_b32 v199, 15, v6
    v_sub_u32 v196, v199, v196
    v_add_u32 v196, 4080, v196
    s_lshl_b32 s68, s3, 18
    s_add_u32 s68, s68, 5242880
    v_subrev_u32 v199, 6144, v197
    v_cmp_gt_u32 vcc, 8, v2
    v_mov_b32 v255, 0x20000000
    s_nop 0
    v_cndmask_b32 v199, v255, v199, vcc
    v_subrev_u32 v255, 8, v2
    v_and_b32 v255, 63, v255
    v_lshlrev_b32 v255, 2, v255
    buffer_load_dwordx4 v[16:19], v198, s[48:51], 0 offen offset:0
    buffer_load_dwordx4 v[20:23], v198, s[48:51], 0 offen offset:16
    buffer_load_dwordx4 v[24:27], v198, s[48:51], 0 offen offset:32
    buffer_load_dwordx4 v[28:31], v198, s[48:51], 0 offen offset:48
    s_mov_b32 s16, 0x3f803f80
    v_mov_b32 v8, 0
    v_mov_b32 v9, 0
    s_waitcnt vmcnt(39)
    v_dot2c_f32_bf16 v8, s16, v128
    v_dot2c_f32_bf16 v9, s16, v129
    v_dot2c_f32_bf16 v8, s16, v130
    v_dot2c_f32_bf16 v9, s16, v131
    s_waitcnt vmcnt(38)
    v_dot2c_f32_bf16 v8, s16, v132
    v_dot2c_f32_bf16 v9, s16, v133
    v_dot2c_f32_bf16 v8, s16, v134
    v_dot2c_f32_bf16 v9, s16, v135
    s_waitcnt vmcnt(37)
    v_dot2c_f32_bf16 v8, s16, v136
    v_dot2c_f32_bf16 v9, s16, v137
    v_dot2c_f32_bf16 v8, s16, v138
    v_dot2c_f32_bf16 v9, s16, v139
    s_waitcnt vmcnt(36)
    v_dot2c_f32_bf16 v8, s16, v140
    v_dot2c_f32_bf16 v9, s16, v141
    v_dot2c_f32_bf16 v8, s16, v142
    v_dot2c_f32_bf16 v9, s16, v143
    s_waitcnt vmcnt(35)
    v_dot2c_f32_bf16 v8, s16, v144
    v_dot2c_f32_bf16 v9, s16, v145
    v_dot2c_f32_bf16 v8, s16, v146
    v_dot2c_f32_bf16 v9, s16, v147
    s_waitcnt vmcnt(34)
    v_dot2c_f32_bf16 v8, s16, v148
    v_dot2c_f32_bf16 v9, s16, v149
    v_dot2c_f32_bf16 v8, s16, v150
    v_dot2c_f32_bf16 v9, s16, v151
    s_waitcnt vmcnt(33)
    v_dot2c_f32_bf16 v8, s16, v152
    v_dot2c_f32_bf16 v9, s16, v153
    v_dot2c_f32_bf16 v8, s16, v154
    v_dot2c_f32_bf16 v9, s16, v155
    s_waitcnt vmcnt(32)
    v_dot2c_f32_bf16 v8, s16, v156
    v_dot2c_f32_bf16 v9, s16, v157
    v_dot2c_f32_bf16 v8, s16, v158
    v_dot2c_f32_bf16 v9, s16, v159
    s_waitcnt vmcnt(31)
    v_dot2c_f32_bf16 v8, s16, v160
    v_dot2c_f32_bf16 v9, s16, v161
    v_dot2c_f32_bf16 v8, s16, v162
    v_dot2c_f32_bf16 v9, s16, v163
    s_waitcnt vmcnt(30)
    v_dot2c_f32_bf16 v8, s16, v164
    v_dot2c_f32_bf16 v9, s16, v165
    v_dot2c_f32_bf16 v8, s16, v166
    v_dot2c_f32_bf16 v9, s16, v167
    s_waitcnt vmcnt(29)
    v_dot2c_f32_bf16 v8, s16, v168
    v_dot2c_f32_bf16 v9, s16, v169
    v_dot2c_f32_bf16 v8, s16, v170
    v_dot2c_f32_bf16 v9, s16, v171
    s_waitcnt vmcnt(28)
    v_dot2c_f32_bf16 v8, s16, v172
    v_dot2c_f32_bf16 v9, s16, v173
    v_dot2c_f32_bf16 v8, s16, v174
    v_dot2c_f32_bf16 v9, s16, v175
    s_waitcnt vmcnt(27)
    v_dot2c_f32_bf16 v8, s16, v176
    v_dot2c_f32_bf16 v9, s16, v177
    v_dot2c_f32_bf16 v8, s16, v178
    v_dot2c_f32_bf16 v9, s16, v179
    s_waitcnt vmcnt(26)
    v_dot2c_f32_bf16 v8, s16, v180
    v_dot2c_f32_bf16 v9, s16, v181
    v_dot2c_f32_bf16 v8, s16, v182
    v_dot2c_f32_bf16 v9, s16, v183
    s_waitcnt vmcnt(25)
    v_dot2c_f32_bf16 v8, s16, v184
    v_dot2c_f32_bf16 v9, s16, v185
    v_dot2c_f32_bf16 v8, s16, v186
    v_dot2c_f32_bf16 v9, s16, v187
    s_waitcnt vmcnt(24)
    v_dot2c_f32_bf16 v8, s16, v188
    v_dot2c_f32_bf16 v9, s16, v189
    v_dot2c_f32_bf16 v8, s16, v190
    v_dot2c_f32_bf16 v9, s16, v191
    s_nop 2
    v_add_f32 v8, v8, v9
    s_nop 2
    v_add_f32_dpp v8, v8, v8 quad_perm:[1,0,3,2] row_mask:0xf bank_mask:0xf
    s_nop 1
    v_add_f32_dpp v8, v8, v8 quad_perm:[2,3,0,1] row_mask:0xf bank_mask:0xf
    s_nop 1
    v_add_f32_dpp v8, v8, v8 row_half_mirror row_mask:0xf bank_mask:0xf
    v_mul_f32 v8, 0xba800000, v8
    v_mov_b32 v10, 0
    v_mov_b32 v11, 0
    v_lshlrev_b32 v200, 16, v128
    v_and_b32 v201, 0xffff0000, v128
    v_pk_add_f32 v[200:201], v[200:201], v[8:9] op_sel_hi:[1,0]
    v_pk_fma_f32 v[10:11], v[200:201], v[200:201], v[10:11]
    v_lshlrev_b32 v202, 16, v129
    v_and_b32 v203, 0xffff0000, v129
    v_pk_add_f32 v[202:203], v[202:203], v[8:9] op_sel_hi:[1,0]
    v_pk_fma_f32 v[10:11], v[202:203], v[202:203], v[10:11]
    v_lshlrev_b32 v204, 16, v130
    v_and_b32 v205, 0xffff0000, v130
    v_pk_add_f32 v[204:205], v[204:205], v[8:9] op_sel_hi:[1,0]
    v_pk_fma_f32 v[10:11], v[204:205], v[204:205], v[10:11]
    v_lshlrev_b32 v206, 16, v131
    v_and_b32 v207, 0xffff0000, v131
    v_pk_add_f32 v[206:207], v[206:207], v[8:9] op_sel_hi:[1,0]
    v_pk_fma_f32 v[10:11], v[206:207], v[206:207], v[10:11]
    v_lshlrev_b32 v200, 16, v132
    v_and_b32 v201, 0xffff0000, v132
    v_pk_add_f32 v[200:201], v[200:201], v[8:9] op_sel_hi:[1,0]
    v_pk_fma_f32 v[10:11], v[200:201], v[200:201], v[10:11]
    v_lshlrev_b32 v202, 16, v133
    v_and_b32 v203, 0xffff0000, v133
    v_pk_add_f32 v[202:203], v[202:203], v[8:9] op_sel_hi:[1,0]
    v_pk_fma_f32 v[10:11], v[202:203], v[202:203], v[10:11]
    v_lshlrev_b32 v204, 16, v134
    v_and_b32 v205, 0xffff0000, v134
    v_pk_add_f32 v[204:205], v[204:205], v[8:9] op_sel_hi:[1,0]
    v_pk_fma_f32 v[10:11], v[204:205], v[204:205], v[10:11]
    v_lshlrev_b32 v206, 16, v135
    v_and_b32 v207, 0xffff0000, v135
    v_pk_add_f32 v[206:207], v[206:207], v[8:9] op_sel_hi:[1,0]
    v_pk_fma_f32 v[10:11], v[206:207], v[206:207], v[10:11]
    v_lshlrev_b32 v200, 16, v136
    v_and_b32 v201, 0xffff0000, v136
    v_pk_add_f32 v[200:201], v[200:201], v[8:9] op_sel_hi:[1,0]
    v_pk_fma_f32 v[10:11], v[200:201], v[200:201], v[10:11]
    v_lshlrev_b32 v202, 16, v137
    v_and_b32 v203, 0xffff0000, v137
    v_pk_add_f32 v[202:203], v[202:203], v[8:9] op_sel_hi:[1,0]
    v_pk_fma_f32 v[10:11], v[202:203], v[202:203], v[10:11]
    v_lshlrev_b32 v204, 16, v138
    v_and_b32 v205, 0xffff0000, v138
    v_pk_add_f32 v[204:205], v[204:205], v[8:9] op_sel_hi:[1,0]
    v_pk_fma_f32 v[10:11], v[204:205], v[204:205], v[10:11]
    v_lshlrev_b32 v206, 16, v139
    v_and_b32 v207, 0xffff0000, v139
    v_pk_add_f32 v[206:207], v[206:207], v[8:9] op_sel_hi:[1,0]
    v_pk_fma_f32 v[10:11], v[206:207], v[206:207], v[10:11]
    v_lshlrev_b32 v200, 16, v140
    v_and_b32 v201, 0xffff0000, v140
    v_pk_add_f32 v[200:201], v[200:201], v[8:9] op_sel_hi:[1,0]
    v_pk_fma_f32 v[10:11], v[200:201], v[200:201], v[10:11]
    v_lshlrev_b32 v202, 16, v141
    v_and_b32 v203, 0xffff0000, v141
    v_pk_add_f32 v[202:203], v[202:203], v[8:9] op_sel_hi:[1,0]
    v_pk_fma_f32 v[10:11], v[202:203], v[202:203], v[10:11]
    v_lshlrev_b32 v204, 16, v142
    v_and_b32 v205, 0xffff0000, v142
    v_pk_add_f32 v[204:205], v[204:205], v[8:9] op_sel_hi:[1,0]
    v_pk_fma_f32 v[10:11], v[204:205], v[204:205], v[10:11]
    v_lshlrev_b32 v206, 16, v143
    v_and_b32 v207, 0xffff0000, v143
    v_pk_add_f32 v[206:207], v[206:207], v[8:9] op_sel_hi:[1,0]
    v_pk_fma_f32 v[10:11], v[206:207], v[206:207], v[10:11]
    v_lshlrev_b32 v200, 16, v144
    v_and_b32 v201, 0xffff0000, v144
    v_pk_add_f32 v[200:201], v[200:201], v[8:9] op_sel_hi:[1,0]
    v_pk_fma_f32 v[10:11], v[200:201], v[200:201], v[10:11]
    v_lshlrev_b32 v202, 16, v145
    v_and_b32 v203, 0xffff0000, v145
    v_pk_add_f32 v[202:203], v[202:203], v[8:9] op_sel_hi:[1,0]
    v_pk_fma_f32 v[10:11], v[202:203], v[202:203], v[10:11]
    v_lshlrev_b32 v204, 16, v146
    v_and_b32 v205, 0xffff0000, v146
    v_pk_add_f32 v[204:205], v[204:205], v[8:9] op_sel_hi:[1,0]
    v_pk_fma_f32 v[10:11], v[204:205], v[204:205], v[10:11]
    v_lshlrev_b32 v206, 16, v147
    v_and_b32 v207, 0xffff0000, v147
    v_pk_add_f32 v[206:207], v[206:207], v[8:9] op_sel_hi:[1,0]
    v_pk_fma_f32 v[10:11], v[206:207], v[206:207], v[10:11]
    v_lshlrev_b32 v200, 16, v148
    v_and_b32 v201, 0xffff0000, v148
    v_pk_add_f32 v[200:201], v[200:201], v[8:9] op_sel_hi:[1,0]
    v_pk_fma_f32 v[10:11], v[200:201], v[200:201], v[10:11]
    v_lshlrev_b32 v202, 16, v149
    v_and_b32 v203, 0xffff0000, v149
    v_pk_add_f32 v[202:203], v[202:203], v[8:9] op_sel_hi:[1,0]
    v_pk_fma_f32 v[10:11], v[202:203], v[202:203], v[10:11]
    v_lshlrev_b32 v204, 16, v150
    v_and_b32 v205, 0xffff0000, v150
    v_pk_add_f32 v[204:205], v[204:205], v[8:9] op_sel_hi:[1,0]
    v_pk_fma_f32 v[10:11], v[204:205], v[204:205], v[10:11]
    v_lshlrev_b32 v206, 16, v151
    v_and_b32 v207, 0xffff0000, v151
    v_pk_add_f32 v[206:207], v[206:207], v[8:9] op_sel_hi:[1,0]
    v_pk_fma_f32 v[10:11], v[206:207], v[206:207], v[10:11]
    v_lshlrev_b32 v200, 16, v152
    v_and_b32 v201, 0xffff0000, v152
    v_pk_add_f32 v[200:201], v[200:201], v[8:9] op_sel_hi:[1,0]
    v_pk_fma_f32 v[10:11], v[200:201], v[200:201], v[10:11]
    v_lshlrev_b32 v202, 16, v153
    v_and_b32 v203, 0xffff0000, v153
    v_pk_add_f32 v[202:203], v[202:203], v[8:9] op_sel_hi:[1,0]
    v_pk_fma_f32 v[10:11], v[202:203], v[202:203], v[10:11]
    v_lshlrev_b32 v204, 16, v154
    v_and_b32 v205, 0xffff0000, v154
    v_pk_add_f32 v[204:205], v[204:205], v[8:9] op_sel_hi:[1,0]
    v_pk_fma_f32 v[10:11], v[204:205], v[204:205], v[10:11]
    v_lshlrev_b32 v206, 16, v155
    v_and_b32 v207, 0xffff0000, v155
    v_pk_add_f32 v[206:207], v[206:207], v[8:9] op_sel_hi:[1,0]
    v_pk_fma_f32 v[10:11], v[206:207], v[206:207], v[10:11]
    v_lshlrev_b32 v200, 16, v156
    v_and_b32 v201, 0xffff0000, v156
    v_pk_add_f32 v[200:201], v[200:201], v[8:9] op_sel_hi:[1,0]
    v_pk_fma_f32 v[10:11], v[200:201], v[200:201], v[10:11]
    v_lshlrev_b32 v202, 16, v157
    v_and_b32 v203, 0xffff0000, v157
    v_pk_add_f32 v[202:203], v[202:203], v[8:9] op_sel_hi:[1,0]
    v_pk_fma_f32 v[10:11], v[202:203], v[202:203], v[10:11]
    v_lshlrev_b32 v204, 16, v158
    v_and_b32 v205, 0xffff0000, v158
    v_pk_add_f32 v[204:205], v[204:205], v[8:9] op_sel_hi:[1,0]
    v_pk_fma_f32 v[10:11], v[204:205], v[204:205], v[10:11]
    v_lshlrev_b32 v206, 16, v159
    v_and_b32 v207, 0xffff0000, v159
    v_pk_add_f32 v[206:207], v[206:207], v[8:9] op_sel_hi:[1,0]
    v_pk_fma_f32 v[10:11], v[206:207], v[206:207], v[10:11]
    v_lshlrev_b32 v200, 16, v160
    v_and_b32 v201, 0xffff0000, v160
    v_pk_add_f32 v[200:201], v[200:201], v[8:9] op_sel_hi:[1,0]
    v_pk_fma_f32 v[10:11], v[200:201], v[200:201], v[10:11]
    v_lshlrev_b32 v202, 16, v161
    v_and_b32 v203, 0xffff0000, v161
    v_pk_add_f32 v[202:203], v[202:203], v[8:9] op_sel_hi:[1,0]
    v_pk_fma_f32 v[10:11], v[202:203], v[202:203], v[10:11]
    v_lshlrev_b32 v204, 16, v162
    v_and_b32 v205, 0xffff0000, v162
    v_pk_add_f32 v[204:205], v[204:205], v[8:9] op_sel_hi:[1,0]
    v_pk_fma_f32 v[10:11], v[204:205], v[204:205], v[10:11]
    v_lshlrev_b32 v206, 16, v163
    v_and_b32 v207, 0xffff0000, v163
    v_pk_add_f32 v[206:207], v[206:207], v[8:9] op_sel_hi:[1,0]
    v_pk_fma_f32 v[10:11], v[206:207], v[206:207], v[10:11]
    v_lshlrev_b32 v200, 16, v164
    v_and_b32 v201, 0xffff0000, v164
    v_pk_add_f32 v[200:201], v[200:201], v[8:9] op_sel_hi:[1,0]
    v_pk_fma_f32 v[10:11], v[200:201], v[200:201], v[10:11]
    v_lshlrev_b32 v202, 16, v165
    v_and_b32 v203, 0xffff0000, v165
    v_pk_add_f32 v[202:203], v[202:203], v[8:9] op_sel_hi:[1,0]
    v_pk_fma_f32 v[10:11], v[202:203], v[202:203], v[10:11]
    v_lshlrev_b32 v204, 16, v166
    v_and_b32 v205, 0xffff0000, v166
    v_pk_add_f32 v[204:205], v[204:205], v[8:9] op_sel_hi:[1,0]
    v_pk_fma_f32 v[10:11], v[204:205], v[204:205], v[10:11]
    v_lshlrev_b32 v206, 16, v167
    v_and_b32 v207, 0xffff0000, v167
    v_pk_add_f32 v[206:207], v[206:207], v[8:9] op_sel_hi:[1,0]
    v_pk_fma_f32 v[10:11], v[206:207], v[206:207], v[10:11]
    v_lshlrev_b32 v200, 16, v168
    v_and_b32 v201, 0xffff0000, v168
    v_pk_add_f32 v[200:201], v[200:201], v[8:9] op_sel_hi:[1,0]
    v_pk_fma_f32 v[10:11], v[200:201], v[200:201], v[10:11]
    v_lshlrev_b32 v202, 16, v169
    v_and_b32 v203, 0xffff0000, v169
    v_pk_add_f32 v[202:203], v[202:203], v[8:9] op_sel_hi:[1,0]
    v_pk_fma_f32 v[10:11], v[202:203], v[202:203], v[10:11]
    v_lshlrev_b32 v204, 16, v170
    v_and_b32 v205, 0xffff0000, v170
    v_pk_add_f32 v[204:205], v[204:205], v[8:9] op_sel_hi:[1,0]
    v_pk_fma_f32 v[10:11], v[204:205], v[204:205], v[10:11]
    v_lshlrev_b32 v206, 16, v171
    v_and_b32 v207, 0xffff0000, v171
    v_pk_add_f32 v[206:207], v[206:207], v[8:9] op_sel_hi:[1,0]
    v_pk_fma_f32 v[10:11], v[206:207], v[206:207], v[10:11]
    v_lshlrev_b32 v200, 16, v172
    v_and_b32 v201, 0xffff0000, v172
    v_pk_add_f32 v[200:201], v[200:201], v[8:9] op_sel_hi:[1,0]
    v_pk_fma_f32 v[10:11], v[200:201], v[200:201], v[10:11]
    v_lshlrev_b32 v202, 16, v173
    v_and_b32 v203, 0xffff0000, v173
    v_pk_add_f32 v[202:203], v[202:203], v[8:9] op_sel_hi:[1,0]
    v_pk_fma_f32 v[10:11], v[202:203], v[202:203], v[10:11]
    v_lshlrev_b32 v204, 16, v174
    v_and_b32 v205, 0xffff0000, v174
    v_pk_add_f32 v[204:205], v[204:205], v[8:9] op_sel_hi:[1,0]
    v_pk_fma_f32 v[10:11], v[204:205], v[204:205], v[10:11]
    v_lshlrev_b32 v206, 16, v175
    v_and_b32 v207, 0xffff0000, v175
    v_pk_add_f32 v[206:207], v[206:207], v[8:9] op_sel_hi:[1,0]
    v_pk_fma_f32 v[10:11], v[206:207], v[206:207], v[10:11]
    v_lshlrev_b32 v200, 16, v176
    v_and_b32 v201, 0xffff0000, v176
    v_pk_add_f32 v[200:201], v[200:201], v[8:9] op_sel_hi:[1,0]
    v_pk_fma_f32 v[10:11], v[200:201], v[200:201], v[10:11]
    v_lshlrev_b32 v202, 16, v177
    v_and_b32 v203, 0xffff0000, v177
    v_pk_add_f32 v[202:203], v[202:203], v[8:9] op_sel_hi:[1,0]
    v_pk_fma_f32 v[10:11], v[202:203], v[202:203], v[10:11]
    v_lshlrev_b32 v204, 16, v178
    v_and_b32 v205, 0xffff0000, v178
    v_pk_add_f32 v[204:205], v[204:205], v[8:9] op_sel_hi:[1,0]
    v_pk_fma_f32 v[10:11], v[204:205], v[204:205], v[10:11]
    v_lshlrev_b32 v206, 16, v179
    v_and_b32 v207, 0xffff0000, v179
    v_pk_add_f32 v[206:207], v[206:207], v[8:9] op_sel_hi:[1,0]
    v_pk_fma_f32 v[10:11], v[206:207], v[206:207], v[10:11]
    v_lshlrev_b32 v200, 16, v180
    v_and_b32 v201, 0xffff0000, v180
    v_pk_add_f32 v[200:201], v[200:201], v[8:9] op_sel_hi:[1,0]
    v_pk_fma_f32 v[10:11], v[200:201], v[200:201], v[10:11]
    v_lshlrev_b32 v202, 16, v181
    v_and_b32 v203, 0xffff0000, v181
    v_pk_add_f32 v[202:203], v[202:203], v[8:9] op_sel_hi:[1,0]
    v_pk_fma_f32 v[10:11], v[202:203], v[202:203], v[10:11]
    v_lshlrev_b32 v204, 16, v182
    v_and_b32 v205, 0xffff0000, v182
    v_pk_add_f32 v[204:205], v[204:205], v[8:9] op_sel_hi:[1,0]
    v_pk_fma_f32 v[10:11], v[204:205], v[204:205], v[10:11]
    v_lshlrev_b32 v206, 16, v183
    v_and_b32 v207, 0xffff0000, v183
    v_pk_add_f32 v[206:207], v[206:207], v[8:9] op_sel_hi:[1,0]
    v_pk_fma_f32 v[10:11], v[206:207], v[206:207], v[10:11]
    v_lshlrev_b32 v200, 16, v184
    v_and_b32 v201, 0xffff0000, v184
    v_pk_add_f32 v[200:201], v[200:201], v[8:9] op_sel_hi:[1,0]
    v_pk_fma_f32 v[10:11], v[200:201], v[200:201], v[10:11]
    v_lshlrev_b32 v202, 16, v185
    v_and_b32 v203, 0xffff0000, v185
    v_pk_add_f32 v[202:203], v[202:203], v[8:9] op_sel_hi:[1,0]
    v_pk_fma_f32 v[10:11], v[202:203], v[202:203], v[10:11]
    v_lshlrev_b32 v204, 16, v186
    v_and_b32 v205, 0xffff0000, v186
    v_pk_add_f32 v[204:205], v[204:205], v[8:9] op_sel_hi:[1,0]
    v_pk_fma_f32 v[10:11], v[204:205], v[204:205], v[10:11]
    v_lshlrev_b32 v206, 16, v187
    v_and_b32 v207, 0xffff0000, v187
    v_pk_add_f32 v[206:207], v[206:207], v[8:9] op_sel_hi:[1,0]
    v_pk_fma_f32 v[10:11], v[206:207], v[206:207], v[10:11]
    v_lshlrev_b32 v200, 16, v188
    v_and_b32 v201, 0xffff0000, v188
    v_pk_add_f32 v[200:201], v[200:201], v[8:9] op_sel_hi:[1,0]
    v_pk_fma_f32 v[10:11], v[200:201], v[200:201], v[10:11]
    v_lshlrev_b32 v202, 16, v189
    v_and_b32 v203, 0xffff0000, v189
    v_pk_add_f32 v[202:203], v[202:203], v[8:9] op_sel_hi:[1,0]
    v_pk_fma_f32 v[10:11], v[202:203], v[202:203], v[10:11]
    v_lshlrev_b32 v204, 16, v190
    v_and_b32 v205, 0xffff0000, v190
    v_pk_add_f32 v[204:205], v[204:205], v[8:9] op_sel_hi:[1,0]
    v_pk_fma_f32 v[10:11], v[204:205], v[204:205], v[10:11]
    v_lshlrev_b32 v206, 16, v191
    v_and_b32 v207, 0xffff0000, v191
    v_pk_add_f32 v[206:207], v[206:207], v[8:9] op_sel_hi:[1,0]
    v_pk_fma_f32 v[10:11], v[206:207], v[206:207], v[10:11]
    v_add_u32 v254, 0, v199
    buffer_load_dwordx4 v[120:123], v254, s[40:43], 0 offen
    v_add_u32 v254, 2048, v199
    buffer_load_dwordx4 v[124:127], v254, s[40:43], 0 offen
    v_add_u32 v254, 4096, v199
    buffer_load_dwordx4 v[128:131], v254, s[40:43], 0 offen
    s_mov_b32 s16, 0
    buffer_load_dwordx4 v[132:135], v197, s[40:43], s16 offen
    s_mov_b32 s16, 2048
    buffer_load_dwordx4 v[136:139], v197, s[40:43], s16 offen
    s_mov_b32 s16, 4096
    buffer_load_dwordx4 v[140:143], v197, s[40:43], s16 offen
    s_mov_b32 s16, 6144
    buffer_load_dwordx4 v[144:147], v197, s[40:43], s16 offen
    s_mov_b32 s16, 8192
    buffer_load_dwordx4 v[148:151], v197, s[40:43], s16 offen
    s_mov_b32 s16, 10240
    buffer_load_dwordx4 v[152:155], v197, s[40:43], s16 offen
    s_mov_b32 s16, 12288
    buffer_load_dwordx4 v[156:159], v197, s[40:43], s16 offen
    s_mov_b32 s16, 14336
    buffer_load_dwordx4 v[160:163], v197, s[40:43], s16 offen
    s_mov_b32 s16, 0
    buffer_load_dwordx4 v[164:167], v197, s[44:47], s16 offen
    s_mov_b32 s16, 2048
    buffer_load_dwordx4 v[168:171], v197, s[44:47], s16 offen
    s_mov_b32 s16, 4096
    buffer_load_dwordx4 v[172:175], v197, s[44:47], s16 offen
    s_mov_b32 s16, 6144
    buffer_load_dwordx4 v[176:179], v197, s[44:47], s16 offen
    s_mov_b32 s16, 8192
    buffer_load_dwordx4 v[180:183], v197, s[44:47], s16 offen
    s_mov_b32 s16, 10240
    buffer_load_dwordx4 v[184:187], v197, s[44:47], s16 offen
    s_mov_b32 s16, 12288
    buffer_load_dwordx4 v[188:191], v197, s[44:47], s16 offen
    s_mov_b32 s16, 14336
    buffer_load_dwordx4 v[192:195], v197, s[44:47], s16 offen
    v_add_f32 v10, v10, v11
    s_nop 2
    v_add_f32_dpp v10, v10, v10 quad_perm:[1,0,3,2] row_mask:0xf bank_mask:0xf
    s_nop 1
    v_add_f32_dpp v10, v10, v10 quad_perm:[2,3,0,1] row_mask:0xf bank_mask:0xf
    s_nop 1
    v_add_f32_dpp v10, v10, v10 row_half_mirror row_mask:0xf bank_mask:0xf
    v_mul_f32 v10, 0x3a800000, v10
    v_cvt_pk_bf16_f32 v8, v8, v8
    v_and_b32 v8, 0xffff0000, v8
    v_cvt_pk_bf16_f32 v10, v10, v10
    v_and_b32 v10, 0xffff0000, v10
    v_add_f32 v10, 0x3727c5ac, v10
    v_cvt_pk_bf16_f32 v10, v10, v10
    v_and_b32 v10, 0xffff0000, v10
    v_sqrt_f32 v10, v10
    s_nop 0
    v_cvt_pk_bf16_f32 v10, v10, v10
    v_and_b32 v10, 0xffff0000, v10
    v_rcp_f32 v13, v10
    v_mul_f32 v11, v10, v10
    v_fma_f32 v14, -v10, v13, 1.0
    v_fmac_f32 v13, v14, v13
    v_mul_f32 v9, 0xc0135761, v13
    v_mul_f32 v10, v13, v13
    v_mul_f32 v10, v10, v13
    v_mul_f32 v10, 0xbdd2d3e8, v10
    v_sub_f32 v12, 0, v8
    s_lshl_b32 s15, s14, 7
    s_add_u32 s16, s15, 4259840
    s_lshr_b32 s15, s15, 1
    s_add_u32 s15, s15, 4194304
    v_lshlrev_b32 v200, 4, v5
    v_lshlrev_b32 v201, 3, v5
    v_cmp_eq_u32 vcc, 0, v6
    s_and_saveexec_b64 s[18:19], vcc
    buffer_store_dwordx4 v[8:11], v200, s[32:35], s16 offen sc1
    buffer_store_dwordx2 v[12:13], v201, s[32:35], s15 offen sc1
    s_mov_b64 exec, s[18:19]
    s_mov_b32 s16, 0x00003f80
    s_mov_b32 s17, 0x3f800000
    s_waitcnt vmcnt(21)
    v_mov_b32 v208, 0
    v_mov_b32 v209, 0
    v_mov_b32 v210, 0
    v_mov_b32 v211, 0
    v_mov_b32 v212, 0
    v_mov_b32 v213, 0
    v_mov_b32 v214, 0
    v_mov_b32 v215, 0
    v_dot2c_f32_bf16 v208, s16, v32
    v_dot2c_f32_bf16 v209, s17, v32
    v_dot2c_f32_bf16 v210, s16, v33
    v_dot2c_f32_bf16 v211, s17, v33
    v_dot2c_f32_bf16 v212, s16, v34
    v_dot2c_f32_bf16 v213, s17, v34
    v_dot2c_f32_bf16 v214, s16, v35
    v_dot2c_f32_bf16 v215, s17, v35
    v_dot2c_f32_bf16 v208, s16, v36
    v_dot2c_f32_bf16 v209, s17, v36
    v_dot2c_f32_bf16 v210, s16, v37
    v_dot2c_f32_bf16 v211, s17, v37
    v_dot2c_f32_bf16 v212, s16, v38
    v_dot2c_f32_bf16 v213, s17, v38
    v_dot2c_f32_bf16 v214, s16, v39
    v_dot2c_f32_bf16 v215, s17, v39
    v_dot2c_f32_bf16 v208, s16, v40
    v_dot2c_f32_bf16 v209, s17, v40
    v_dot2c_f32_bf16 v210, s16, v41
    v_dot2c_f32_bf16 v211, s17, v41
    v_dot2c_f32_bf16 v212, s16, v42
    v_dot2c_f32_bf16 v213, s17, v42
    v_dot2c_f32_bf16 v214, s16, v43
    v_dot2c_f32_bf16 v215, s17, v43
    v_dot2c_f32_bf16 v208, s16, v44
    v_dot2c_f32_bf16 v209, s17, v44
    v_dot2c_f32_bf16 v210, s16, v45
    v_dot2c_f32_bf16 v211, s17, v45
    v_dot2c_f32_bf16 v212, s16, v46
    v_dot2c_f32_bf16 v213, s17, v46
    v_dot2c_f32_bf16 v214, s16, v47
    v_dot2c_f32_bf16 v215, s17, v47
    v_dot2c_f32_bf16 v208, s16, v48
    v_dot2c_f32_bf16 v209, s17, v48
    v_dot2c_f32_bf16 v210, s16, v49
    v_dot2c_f32_bf16 v211, s17, v49
    v_dot2c_f32_bf16 v212, s16, v50
    v_dot2c_f32_bf16 v213, s17, v50
    v_dot2c_f32_bf16 v214, s16, v51
    v_dot2c_f32_bf16 v215, s17, v51
    v_dot2c_f32_bf16 v208, s16, v52
    v_dot2c_f32_bf16 v209, s17, v52
    v_dot2c_f32_bf16 v210, s16, v53
    v_dot2c_f32_bf16 v211, s17, v53
    v_dot2c_f32_bf16 v212, s16, v54
    v_dot2c_f32_bf16 v213, s17, v54
    v_dot2c_f32_bf16 v214, s16, v55
    v_dot2c_f32_bf16 v215, s17, v55
    v_dot2c_f32_bf16 v208, s16, v56
    v_dot2c_f32_bf16 v209, s17, v56
    v_dot2c_f32_bf16 v210, s16, v57
    v_dot2c_f32_bf16 v211, s17, v57
    v_dot2c_f32_bf16 v212, s16, v58
    v_dot2c_f32_bf16 v213, s17, v58
    v_dot2c_f32_bf16 v214, s16, v59
    v_dot2c_f32_bf16 v215, s17, v59
    v_dot2c_f32_bf16 v208, s16, v60
    v_dot2c_f32_bf16 v209, s17, v60
    v_dot2c_f32_bf16 v210, s16, v61
    v_dot2c_f32_bf16 v211, s17, v61
    v_dot2c_f32_bf16 v212, s16, v62
    v_dot2c_f32_bf16 v213, s17, v62
    v_dot2c_f32_bf16 v214, s16, v63
    v_dot2c_f32_bf16 v215, s17, v63
    v_dot2c_f32_bf16 v208, s16, v64
    v_dot2c_f32_bf16 v209, s17, v64
    v_dot2c_f32_bf16 v210, s16, v65
    v_dot2c_f32_bf16 v211, s17, v65
    v_dot2c_f32_bf16 v212, s16, v66
    v_dot2c_f32_bf16 v213, s17, v66
    v_dot2c_f32_bf16 v214, s16, v67
    v_dot2c_f32_bf16 v215, s17, v67
    v_dot2c_f32_bf16 v208, s16, v68
    v_dot2c_f32_bf16 v209, s17, v68
    v_dot2c_f32_bf16 v210, s16, v69
    v_dot2c_f32_bf16 v211, s17, v69
    v_dot2c_f32_bf16 v212, s16, v70
    v_dot2c_f32_bf16 v213, s17, v70
    v_dot2c_f32_bf16 v214, s16, v71
    v_dot2c_f32_bf16 v215, s17, v71
    v_dot2c_f32_bf16 v208, s16, v72
    v_dot2c_f32_bf16 v209, s17, v72
    v_dot2c_f32_bf16 v210, s16, v73
    v_dot2c_f32_bf16 v211, s17, v73
    v_dot2c_f32_bf16 v212, s16, v74
    v_dot2c_f32_bf16 v213, s17, v74
    v_dot2c_f32_bf16 v214, s16, v75
    v_dot2c_f32_bf16 v215, s17, v75
    v_dot2c_f32_bf16 v208, s16, v76
    v_dot2c_f32_bf16 v209, s17, v76
    v_dot2c_f32_bf16 v210, s16, v77
    v_dot2c_f32_bf16 v211, s17, v77
    v_dot2c_f32_bf16 v212, s16, v78
    v_dot2c_f32_bf16 v213, s17, v78
    v_dot2c_f32_bf16 v214, s16, v79
    v_dot2c_f32_bf16 v215, s17, v79
    v_dot2c_f32_bf16 v208, s16, v80
    v_dot2c_f32_bf16 v209, s17, v80
    v_dot2c_f32_bf16 v210, s16, v81
    v_dot2c_f32_bf16 v211, s17, v81
    v_dot2c_f32_bf16 v212, s16, v82
    v_dot2c_f32_bf16 v213, s17, v82
    v_dot2c_f32_bf16 v214, s16, v83
    v_dot2c_f32_bf16 v215, s17, v83
    v_dot2c_f32_bf16 v208, s16, v84
    v_dot2c_f32_bf16 v209, s17, v84
    v_dot2c_f32_bf16 v210, s16, v85
    v_dot2c_f32_bf16 v211, s17, v85
    v_dot2c_f32_bf16 v212, s16, v86
    v_dot2c_f32_bf16 v213, s17, v86
    v_dot2c_f32_bf16 v214, s16, v87
    v_dot2c_f32_bf16 v215, s17, v87
    v_dot2c_f32_bf16 v208, s16, v88
    v_dot2c_f32_bf16 v209, s17, v88
    v_dot2c_f32_bf16 v210, s16, v89
    v_dot2c_f32_bf16 v211, s17, v89
    v_dot2c_f32_bf16 v212, s16, v90
    v_dot2c_f32_bf16 v213, s17, v90
    v_dot2c_f32_bf16 v214, s16, v91
    v_dot2c_f32_bf16 v215, s17, v91
    v_dot2c_f32_bf16 v208, s16, v92
    v_dot2c_f32_bf16 v209, s17, v92
    v_dot2c_f32_bf16 v210, s16, v93
    v_dot2c_f32_bf16 v211, s17, v93
    v_dot2c_f32_bf16 v212, s16, v94
    v_dot2c_f32_bf16 v213, s17, v94
    v_dot2c_f32_bf16 v214, s16, v95
    v_dot2c_f32_bf16 v215, s17, v95
    v_dot2c_f32_bf16 v208, s16, v96
    v_dot2c_f32_bf16 v209, s17, v96
    v_dot2c_f32_bf16 v210, s16, v97
    v_dot2c_f32_bf16 v211, s17, v97
    v_dot2c_f32_bf16 v212, s16, v98
    v_dot2c_f32_bf16 v213, s17, v98
    v_dot2c_f32_bf16 v214, s16, v99
    v_dot2c_f32_bf16 v215, s17, v99
    v_dot2c_f32_bf16 v208, s16, v100
    v_dot2c_f32_bf16 v209, s17, v100
    v_dot2c_f32_bf16 v210, s16, v101
    v_dot2c_f32_bf16 v211, s17, v101
    v_dot2c_f32_bf16 v212, s16, v102
    v_dot2c_f32_bf16 v213, s17, v102
    v_dot2c_f32_bf16 v214, s16, v103
    v_dot2c_f32_bf16 v215, s17, v103
    v_dot2c_f32_bf16 v208, s16, v104
    v_dot2c_f32_bf16 v209, s17, v104
    v_dot2c_f32_bf16 v210, s16, v105
    v_dot2c_f32_bf16 v211, s17, v105
    v_dot2c_f32_bf16 v212, s16, v106
    v_dot2c_f32_bf16 v213, s17, v106
    v_dot2c_f32_bf16 v214, s16, v107
    v_dot2c_f32_bf16 v215, s17, v107
    v_dot2c_f32_bf16 v208, s16, v108
    v_dot2c_f32_bf16 v209, s17, v108
    v_dot2c_f32_bf16 v210, s16, v109
    v_dot2c_f32_bf16 v211, s17, v109
    v_dot2c_f32_bf16 v212, s16, v110
    v_dot2c_f32_bf16 v213, s17, v110
    v_dot2c_f32_bf16 v214, s16, v111
    v_dot2c_f32_bf16 v215, s17, v111
    v_lshlrev_b32 v7, 5, v0
    v_add_u32 v254, 1024, v199
    buffer_load_dwordx4 v[32:35], v254, s[40:43], 0 offen
    v_add_u32 v254, 3072, v199
    buffer_load_dwordx4 v[36:39], v254, s[40:43], 0 offen
    v_add_u32 v254, 5120, v199
    buffer_load_dwordx4 v[40:43], v254, s[40:43], 0 offen
    s_mov_b32 s16, 1024
    buffer_load_dwordx4 v[44:47], v197, s[40:43], s16 offen
    s_mov_b32 s16, 3072
    buffer_load_dwordx4 v[48:51], v197, s[40:43], s16 offen
    s_mov_b32 s16, 5120
    buffer_load_dwordx4 v[52:55], v197, s[40:43], s16 offen
    s_mov_b32 s16, 7168
    buffer_load_dwordx4 v[56:59], v197, s[40:43], s16 offen
    s_mov_b32 s16, 9216
    buffer_load_dwordx4 v[60:63], v197, s[40:43], s16 offen
    s_mov_b32 s16, 11264
    buffer_load_dwordx4 v[64:67], v197, s[40:43], s16 offen
    s_mov_b32 s16, 13312
    buffer_load_dwordx4 v[68:71], v197, s[40:43], s16 offen
    s_mov_b32 s16, 15360
    buffer_load_dwordx4 v[72:75], v197, s[40:43], s16 offen
    s_mov_b32 s16, 1024
    buffer_load_dwordx4 v[76:79], v197, s[44:47], s16 offen
    s_mov_b32 s16, 3072
    buffer_load_dwordx4 v[80:83], v197, s[44:47], s16 offen
    s_mov_b32 s16, 5120
    buffer_load_dwordx4 v[84:87], v197, s[44:47], s16 offen
    s_mov_b32 s16, 7168
    buffer_load_dwordx4 v[88:91], v197, s[44:47], s16 offen
    s_mov_b32 s16, 9216
    buffer_load_dwordx4 v[92:95], v197, s[44:47], s16 offen
    s_mov_b32 s16, 11264
    buffer_load_dwordx4 v[96:99], v197, s[44:47], s16 offen
    s_mov_b32 s16, 13312
    buffer_load_dwordx4 v[100:103], v197, s[44:47], s16 offen
    s_mov_b32 s16, 15360
    buffer_load_dwordx4 v[104:107], v197, s[44:47], s16 offen
    ds_write_b128 v7, v[208:211]
    ds_write_b128 v7, v[212:215] offset:16
    s_waitcnt vmcnt(19) lgkmcnt(0)
    ds_bpermute_b32 v208, v255, v152
    ds_bpermute_b32 v209, v255, v153
    ds_bpermute_b32 v210, v255, v154
    ds_bpermute_b32 v211, v255, v155
    ds_bpermute_b32 v212, v255, v156
    ds_bpermute_b32 v213, v255, v157
    ds_bpermute_b32 v214, v255, v158
    ds_bpermute_b32 v215, v255, v159
    ds_bpermute_b32 v216, v255, v160
    ds_bpermute_b32 v217, v255, v161
    ds_bpermute_b32 v218, v255, v162
    ds_bpermute_b32 v219, v255, v163
    v_cmp_lt_u32 vcc, 7, v2
    s_nop 0
    s_waitcnt lgkmcnt(0)
    v_cndmask_b32 v120, v120, v208, vcc
    v_cndmask_b32 v121, v121, v209, vcc
    v_cndmask_b32 v122, v122, v210, vcc
    v_cndmask_b32 v123, v123, v211, vcc
    v_cndmask_b32 v124, v124, v212, vcc
    v_cndmask_b32 v125, v125, v213, vcc
    v_cndmask_b32 v126, v126, v214, vcc
    v_cndmask_b32 v127, v127, v215, vcc
    v_cndmask_b32 v128, v128, v216, vcc
    v_cndmask_b32 v129, v129, v217, vcc
    v_cndmask_b32 v130, v130, v218, vcc
    v_cndmask_b32 v131, v131, v219, vcc
    v_lshlrev_b32 v200, 16, v16
    v_lshlrev_b32 v201, 16, v18
    v_and_b32 v202, 0xffff0000, v16
    v_and_b32 v203, 0xffff0000, v18
    v_lshlrev_b32 v204, 16, v17
    v_lshlrev_b32 v205, 16, v19
    v_and_b32 v206, 0xffff0000, v17
    v_and_b32 v207, 0xffff0000, v19
    s_movk_i32 s16, 0x1000
    buffer_load_dwordx4 v[16:19], v198, s[48:51], s16 offen offset:0
    v_lshlrev_b32 v208, 16, v120
    v_and_b32 v209, 0xffff0000, v120
    v_lshlrev_b32 v210, 16, v124
    v_and_b32 v211, 0xffff0000, v124
    v_lshlrev_b32 v212, 16, v128
    v_and_b32 v213, 0xffff0000, v128
    v_lshlrev_b32 v214, 16, v132
    v_and_b32 v215, 0xffff0000, v132
    v_lshlrev_b32 v216, 16, v136
    v_and_b32 v217, 0xffff0000, v136
    v_lshlrev_b32 v218, 16, v140
    v_and_b32 v219, 0xffff0000, v140
    v_lshlrev_b32 v220, 16, v144
    v_and_b32 v221, 0xffff0000, v144
    v_lshlrev_b32 v222, 16, v148
    v_and_b32 v223, 0xffff0000, v148
    v_lshlrev_b32 v224, 16, v152
    v_and_b32 v225, 0xffff0000, v152
    v_lshlrev_b32 v226, 16, v156
    v_and_b32 v227, 0xffff0000, v156
    v_lshlrev_b32 v228, 16, v160
    v_and_b32 v229, 0xffff0000, v160
    v_pk_mul_f32 v[232:233], v[208:209], v[206:207]
    v_pk_fma_f32 v[232:233], v[210:211], v[204:205], v[232:233]
    v_pk_fma_f32 v[232:233], v[212:213], v[202:203], v[232:233]
    v_pk_fma_f32 v[232:233], v[214:215], v[200:201], v[232:233]
    v_pk_mul_f32 v[234:235], v[210:211], v[206:207]
    v_pk_fma_f32 v[234:235], v[212:213], v[204:205], v[234:235]
    v_pk_fma_f32 v[234:235], v[214:215], v[202:203], v[234:235]
    v_pk_fma_f32 v[234:235], v[216:217], v[200:201], v[234:235]
    v_pk_mul_f32 v[236:237], v[212:213], v[206:207]
    v_pk_fma_f32 v[236:237], v[214:215], v[204:205], v[236:237]
    v_pk_fma_f32 v[236:237], v[216:217], v[202:203], v[236:237]
    v_pk_fma_f32 v[236:237], v[218:219], v[200:201], v[236:237]
    v_pk_mul_f32 v[238:239], v[214:215], v[206:207]
    v_pk_fma_f32 v[238:239], v[216:217], v[204:205], v[238:239]
    v_pk_fma_f32 v[238:239], v[218:219], v[202:203], v[238:239]
    v_pk_fma_f32 v[238:239], v[220:221], v[200:201], v[238:239]
    v_pk_mul_f32 v[240:241], v[216:217], v[206:207]
    v_pk_fma_f32 v[240:241], v[218:219], v[204:205], v[240:241]
    v_pk_fma_f32 v[240:241], v[220:221], v[202:203], v[240:241]
    v_pk_fma_f32 v[240:241], v[222:223], v[200:201], v[240:241]
    v_pk_mul_f32 v[242:243], v[218:219], v[206:207]
    v_pk_fma_f32 v[242:243], v[220:221], v[204:205], v[242:243]
    v_pk_fma_f32 v[242:243], v[222:223], v[202:203], v[242:243]
    v_pk_fma_f32 v[242:243], v[224:225], v[200:201], v[242:243]
    v_pk_mul_f32 v[244:245], v[220:221], v[206:207]
    v_pk_fma_f32 v[244:245], v[222:223], v[204:205], v[244:245]
    v_pk_fma_f32 v[244:245], v[224:225], v[202:203], v[244:245]
    v_pk_fma_f32 v[244:245], v[226:227], v[200:201], v[244:245]
    v_pk_mul_f32 v[246:247], v[222:223], v[206:207]
    v_pk_fma_f32 v[246:247], v[224:225], v[204:205], v[246:247]
    v_pk_fma_f32 v[246:247], v[226:227], v[202:203], v[246:247]
    v_pk_fma_f32 v[246:247], v[228:229], v[200:201], v[246:247]
    v_lshlrev_b32 v250, 16, v164
    v_and_b32 v251, 0xffff0000, v164
    v_pk_mul_f32 v[232:233], v[232:233], v[250:251]
    v_lshlrev_b32 v250, 16, v168
    v_and_b32 v251, 0xffff0000, v168
    v_pk_mul_f32 v[234:235], v[234:235], v[250:251]
    v_lshlrev_b32 v250, 16, v172
    v_and_b32 v251, 0xffff0000, v172
    v_pk_mul_f32 v[236:237], v[236:237], v[250:251]
    v_lshlrev_b32 v250, 16, v176
    v_and_b32 v251, 0xffff0000, v176
    v_pk_mul_f32 v[238:239], v[238:239], v[250:251]
    v_lshlrev_b32 v250, 16, v180
    v_and_b32 v251, 0xffff0000, v180
    v_pk_mul_f32 v[240:241], v[240:241], v[250:251]
    v_lshlrev_b32 v250, 16, v184
    v_and_b32 v251, 0xffff0000, v184
    v_pk_mul_f32 v[242:243], v[242:243], v[250:251]
    v_lshlrev_b32 v250, 16, v188
    v_and_b32 v251, 0xffff0000, v188
    v_pk_mul_f32 v[244:245], v[244:245], v[250:251]
    v_lshlrev_b32 v250, 16, v192
    v_and_b32 v251, 0xffff0000, v192
    v_pk_mul_f32 v[246:247], v[246:247], v[250:251]
    v_cvt_pk_bf16_f32 v8, v246, v244
    v_cvt_pk_bf16_f32 v9, v242, v240
    v_cvt_pk_bf16_f32 v10, v238, v236
    v_cvt_pk_bf16_f32 v11, v234, v232
    s_add_u32 s16, s68, 0
    buffer_store_dwordx4 v[8:11], v196, s[32:35], s16 offen sc1
    v_cvt_pk_bf16_f32 v12, v247, v245
    v_cvt_pk_bf16_f32 v13, v243, v241
    v_cvt_pk_bf16_f32 v14, v239, v237
    v_cvt_pk_bf16_f32 v15, v235, v233
    s_add_u32 s16, s68, 4096
    buffer_store_dwordx4 v[12:15], v196, s[32:35], s16 offen sc1
    v_lshlrev_b32 v200, 16, v20
    v_lshlrev_b32 v201, 16, v22
    v_and_b32 v202, 0xffff0000, v20
    v_and_b32 v203, 0xffff0000, v22
    v_lshlrev_b32 v204, 16, v21
    v_lshlrev_b32 v205, 16, v23
    v_and_b32 v206, 0xffff0000, v21
    v_and_b32 v207, 0xffff0000, v23
    s_movk_i32 s16, 0x1000
    buffer_load_dwordx4 v[20:23], v198, s[48:51], s16 offen offset:16
    v_lshlrev_b32 v208, 16, v121
    v_and_b32 v209, 0xffff0000, v121
    v_lshlrev_b32 v210, 16, v125
    v_and_b32 v211, 0xffff0000, v125
    v_lshlrev_b32 v212, 16, v129
    v_and_b32 v213, 0xffff0000, v129
    v_lshlrev_b32 v214, 16, v133
    v_and_b32 v215, 0xffff0000, v133
    v_lshlrev_b32 v216, 16, v137
    v_and_b32 v217, 0xffff0000, v137
    v_lshlrev_b32 v218, 16, v141
    v_and_b32 v219, 0xffff0000, v141
    v_lshlrev_b32 v220, 16, v145
    v_and_b32 v221, 0xffff0000, v145
    v_lshlrev_b32 v222, 16, v149
    v_and_b32 v223, 0xffff0000, v149
    v_lshlrev_b32 v224, 16, v153
    v_and_b32 v225, 0xffff0000, v153
    v_lshlrev_b32 v226, 16, v157
    v_and_b32 v227, 0xffff0000, v157
    v_lshlrev_b32 v228, 16, v161
    v_and_b32 v229, 0xffff0000, v161
    v_pk_mul_f32 v[232:233], v[208:209], v[206:207]
    v_pk_fma_f32 v[232:233], v[210:211], v[204:205], v[232:233]
    v_pk_fma_f32 v[232:233], v[212:213], v[202:203], v[232:233]
    v_pk_fma_f32 v[232:233], v[214:215], v[200:201], v[232:233]
    v_pk_mul_f32 v[234:235], v[210:211], v[206:207]
    v_pk_fma_f32 v[234:235], v[212:213], v[204:205], v[234:235]
    v_pk_fma_f32 v[234:235], v[214:215], v[202:203], v[234:235]
    v_pk_fma_f32 v[234:235], v[216:217], v[200:201], v[234:235]
    v_pk_mul_f32 v[236:237], v[212:213], v[206:207]
    v_pk_fma_f32 v[236:237], v[214:215], v[204:205], v[236:237]
    v_pk_fma_f32 v[236:237], v[216:217], v[202:203], v[236:237]
    v_pk_fma_f32 v[236:237], v[218:219], v[200:201], v[236:237]
    v_pk_mul_f32 v[238:239], v[214:215], v[206:207]
    v_pk_fma_f32 v[238:239], v[216:217], v[204:205], v[238:239]
    v_pk_fma_f32 v[238:239], v[218:219], v[202:203], v[238:239]
    v_pk_fma_f32 v[238:239], v[220:221], v[200:201], v[238:239]
    v_pk_mul_f32 v[240:241], v[216:217], v[206:207]
    v_pk_fma_f32 v[240:241], v[218:219], v[204:205], v[240:241]
    v_pk_fma_f32 v[240:241], v[220:221], v[202:203], v[240:241]
    v_pk_fma_f32 v[240:241], v[222:223], v[200:201], v[240:241]
    v_pk_mul_f32 v[242:243], v[218:219], v[206:207]
    v_pk_fma_f32 v[242:243], v[220:221], v[204:205], v[242:243]
    v_pk_fma_f32 v[242:243], v[222:223], v[202:203], v[242:243]
    v_pk_fma_f32 v[242:243], v[224:225], v[200:201], v[242:243]
    v_pk_mul_f32 v[244:245], v[220:221], v[206:207]
    v_pk_fma_f32 v[244:245], v[222:223], v[204:205], v[244:245]
    v_pk_fma_f32 v[244:245], v[224:225], v[202:203], v[244:245]
    v_pk_fma_f32 v[244:245], v[226:227], v[200:201], v[244:245]
    v_pk_mul_f32 v[246:247], v[222:223], v[206:207]
    v_pk_fma_f32 v[246:247], v[224:225], v[204:205], v[246:247]
    v_pk_fma_f32 v[246:247], v[226:227], v[202:203], v[246:247]
    v_pk_fma_f32 v[246:247], v[228:229], v[200:201], v[246:247]
    v_lshlrev_b32 v250, 16, v165
    v_and_b32 v251, 0xffff0000, v165
    v_pk_mul_f32 v[232:233], v[232:233], v[250:251]
    v_lshlrev_b32 v250, 16, v169
    v_and_b32 v251, 0xffff0000, v169
    v_pk_mul_f32 v[234:235], v[234:235], v[250:251]
    v_lshlrev_b32 v250, 16, v173
    v_and_b32 v251, 0xffff0000, v173
    v_pk_mul_f32 v[236:237], v[236:237], v[250:251]
    v_lshlrev_b32 v250, 16, v177
    v_and_b32 v251, 0xffff0000, v177
    v_pk_mul_f32 v[238:239], v[238:239], v[250:251]
    v_lshlrev_b32 v250, 16, v181
    v_and_b32 v251, 0xffff0000, v181
    v_pk_mul_f32 v[240:241], v[240:241], v[250:251]
    v_lshlrev_b32 v250, 16, v185
    v_and_b32 v251, 0xffff0000, v185
    v_pk_mul_f32 v[242:243], v[242:243], v[250:251]
    v_lshlrev_b32 v250, 16, v189
    v_and_b32 v251, 0xffff0000, v189
    v_pk_mul_f32 v[244:245], v[244:245], v[250:251]
    v_lshlrev_b32 v250, 16, v193
    v_and_b32 v251, 0xffff0000, v193
    v_pk_mul_f32 v[246:247], v[246:247], v[250:251]
    v_cvt_pk_bf16_f32 v8, v246, v244
    v_cvt_pk_bf16_f32 v9, v242, v240
    v_cvt_pk_bf16_f32 v10, v238, v236
    v_cvt_pk_bf16_f32 v11, v234, v232
    s_add_u32 s16, s68, 8192
    buffer_store_dwordx4 v[8:11], v196, s[32:35], s16 offen sc1
    v_cvt_pk_bf16_f32 v12, v247, v245
    v_cvt_pk_bf16_f32 v13, v243, v241
    v_cvt_pk_bf16_f32 v14, v239, v237
    v_cvt_pk_bf16_f32 v15, v235, v233
    s_add_u32 s16, s68, 12288
    buffer_store_dwordx4 v[12:15], v196, s[32:35], s16 offen sc1
    v_lshlrev_b32 v200, 16, v24
    v_lshlrev_b32 v201, 16, v26
    v_and_b32 v202, 0xffff0000, v24
    v_and_b32 v203, 0xffff0000, v26
    v_lshlrev_b32 v204, 16, v25
    v_lshlrev_b32 v205, 16, v27
    v_and_b32 v206, 0xffff0000, v25
    v_and_b32 v207, 0xffff0000, v27
    s_movk_i32 s16, 0x1000
    buffer_load_dwordx4 v[24:27], v198, s[48:51], s16 offen offset:32
    v_lshlrev_b32 v208, 16, v122
    v_and_b32 v209, 0xffff0000, v122
    v_lshlrev_b32 v210, 16, v126
    v_and_b32 v211, 0xffff0000, v126
    v_lshlrev_b32 v212, 16, v130
    v_and_b32 v213, 0xffff0000, v130
    v_lshlrev_b32 v214, 16, v134
    v_and_b32 v215, 0xffff0000, v134
    v_lshlrev_b32 v216, 16, v138
    v_and_b32 v217, 0xffff0000, v138
    v_lshlrev_b32 v218, 16, v142
    v_and_b32 v219, 0xffff0000, v142
    v_lshlrev_b32 v220, 16, v146
    v_and_b32 v221, 0xffff0000, v146
    v_lshlrev_b32 v222, 16, v150
    v_and_b32 v223, 0xffff0000, v150
    v_lshlrev_b32 v224, 16, v154
    v_and_b32 v225, 0xffff0000, v154
    v_lshlrev_b32 v226, 16, v158
    v_and_b32 v227, 0xffff0000, v158
    v_lshlrev_b32 v228, 16, v162
    v_and_b32 v229, 0xffff0000, v162
    v_pk_mul_f32 v[232:233], v[208:209], v[206:207]
    v_pk_fma_f32 v[232:233], v[210:211], v[204:205], v[232:233]
    v_pk_fma_f32 v[232:233], v[212:213], v[202:203], v[232:233]
    v_pk_fma_f32 v[232:233], v[214:215], v[200:201], v[232:233]
    v_pk_mul_f32 v[234:235], v[210:211], v[206:207]
    v_pk_fma_f32 v[234:235], v[212:213], v[204:205], v[234:235]
    v_pk_fma_f32 v[234:235], v[214:215], v[202:203], v[234:235]
    v_pk_fma_f32 v[234:235], v[216:217], v[200:201], v[234:235]
    v_pk_mul_f32 v[236:237], v[212:213], v[206:207]
    v_pk_fma_f32 v[236:237], v[214:215], v[204:205], v[236:237]
    v_pk_fma_f32 v[236:237], v[216:217], v[202:203], v[236:237]
    v_pk_fma_f32 v[236:237], v[218:219], v[200:201], v[236:237]
    v_pk_mul_f32 v[238:239], v[214:215], v[206:207]
    v_pk_fma_f32 v[238:239], v[216:217], v[204:205], v[238:239]
    v_pk_fma_f32 v[238:239], v[218:219], v[202:203], v[238:239]
    v_pk_fma_f32 v[238:239], v[220:221], v[200:201], v[238:239]
    v_pk_mul_f32 v[240:241], v[216:217], v[206:207]
    v_pk_fma_f32 v[240:241], v[218:219], v[204:205], v[240:241]
    v_pk_fma_f32 v[240:241], v[220:221], v[202:203], v[240:241]
    v_pk_fma_f32 v[240:241], v[222:223], v[200:201], v[240:241]
    v_pk_mul_f32 v[242:243], v[218:219], v[206:207]
    v_pk_fma_f32 v[242:243], v[220:221], v[204:205], v[242:243]
    v_pk_fma_f32 v[242:243], v[222:223], v[202:203], v[242:243]
    v_pk_fma_f32 v[242:243], v[224:225], v[200:201], v[242:243]
    v_pk_mul_f32 v[244:245], v[220:221], v[206:207]
    v_pk_fma_f32 v[244:245], v[222:223], v[204:205], v[244:245]
    v_pk_fma_f32 v[244:245], v[224:225], v[202:203], v[244:245]
    v_pk_fma_f32 v[244:245], v[226:227], v[200:201], v[244:245]
    v_pk_mul_f32 v[246:247], v[222:223], v[206:207]
    v_pk_fma_f32 v[246:247], v[224:225], v[204:205], v[246:247]
    v_pk_fma_f32 v[246:247], v[226:227], v[202:203], v[246:247]
    v_pk_fma_f32 v[246:247], v[228:229], v[200:201], v[246:247]
    v_lshlrev_b32 v250, 16, v166
    v_and_b32 v251, 0xffff0000, v166
    v_pk_mul_f32 v[232:233], v[232:233], v[250:251]
    v_lshlrev_b32 v250, 16, v170
    v_and_b32 v251, 0xffff0000, v170
    v_pk_mul_f32 v[234:235], v[234:235], v[250:251]
    v_lshlrev_b32 v250, 16, v174
    v_and_b32 v251, 0xffff0000, v174
    v_pk_mul_f32 v[236:237], v[236:237], v[250:251]
    v_lshlrev_b32 v250, 16, v178
    v_and_b32 v251, 0xffff0000, v178
    v_pk_mul_f32 v[238:239], v[238:239], v[250:251]
    v_lshlrev_b32 v250, 16, v182
    v_and_b32 v251, 0xffff0000, v182
    v_pk_mul_f32 v[240:241], v[240:241], v[250:251]
    v_lshlrev_b32 v250, 16, v186
    v_and_b32 v251, 0xffff0000, v186
    v_pk_mul_f32 v[242:243], v[242:243], v[250:251]
    v_lshlrev_b32 v250, 16, v190
    v_and_b32 v251, 0xffff0000, v190
    v_pk_mul_f32 v[244:245], v[244:245], v[250:251]
    v_lshlrev_b32 v250, 16, v194
    v_and_b32 v251, 0xffff0000, v194
    v_pk_mul_f32 v[246:247], v[246:247], v[250:251]
    v_cvt_pk_bf16_f32 v8, v246, v244
    v_cvt_pk_bf16_f32 v9, v242, v240
    v_cvt_pk_bf16_f32 v10, v238, v236
    v_cvt_pk_bf16_f32 v11, v234, v232
    s_add_u32 s16, s68, 16384
    buffer_store_dwordx4 v[8:11], v196, s[32:35], s16 offen sc1
    v_cvt_pk_bf16_f32 v12, v247, v245
    v_cvt_pk_bf16_f32 v13, v243, v241
    v_cvt_pk_bf16_f32 v14, v239, v237
    v_cvt_pk_bf16_f32 v15, v235, v233
    s_add_u32 s16, s68, 20480
    buffer_store_dwordx4 v[12:15], v196, s[32:35], s16 offen sc1
    v_lshlrev_b32 v200, 16, v28
    v_lshlrev_b32 v201, 16, v30
    v_and_b32 v202, 0xffff0000, v28
    v_and_b32 v203, 0xffff0000, v30
    v_lshlrev_b32 v204, 16, v29
    v_lshlrev_b32 v205, 16, v31
    v_and_b32 v206, 0xffff0000, v29
    v_and_b32 v207, 0xffff0000, v31
    s_movk_i32 s16, 0x1000
    buffer_load_dwordx4 v[28:31], v198, s[48:51], s16 offen offset:48
    v_lshlrev_b32 v208, 16, v123
    v_and_b32 v209, 0xffff0000, v123
    v_lshlrev_b32 v210, 16, v127
    v_and_b32 v211, 0xffff0000, v127
    v_lshlrev_b32 v212, 16, v131
    v_and_b32 v213, 0xffff0000, v131
    v_lshlrev_b32 v214, 16, v135
    v_and_b32 v215, 0xffff0000, v135
    v_lshlrev_b32 v216, 16, v139
    v_and_b32 v217, 0xffff0000, v139
    v_lshlrev_b32 v218, 16, v143
    v_and_b32 v219, 0xffff0000, v143
    v_lshlrev_b32 v220, 16, v147
    v_and_b32 v221, 0xffff0000, v147
    v_lshlrev_b32 v222, 16, v151
    v_and_b32 v223, 0xffff0000, v151
    v_lshlrev_b32 v224, 16, v155
    v_and_b32 v225, 0xffff0000, v155
    v_lshlrev_b32 v226, 16, v159
    v_and_b32 v227, 0xffff0000, v159
    v_lshlrev_b32 v228, 16, v163
    v_and_b32 v229, 0xffff0000, v163
    v_pk_mul_f32 v[232:233], v[208:209], v[206:207]
    v_pk_fma_f32 v[232:233], v[210:211], v[204:205], v[232:233]
    v_pk_fma_f32 v[232:233], v[212:213], v[202:203], v[232:233]
    v_pk_fma_f32 v[232:233], v[214:215], v[200:201], v[232:233]
    v_pk_mul_f32 v[234:235], v[210:211], v[206:207]
    v_pk_fma_f32 v[234:235], v[212:213], v[204:205], v[234:235]
    v_pk_fma_f32 v[234:235], v[214:215], v[202:203], v[234:235]
    v_pk_fma_f32 v[234:235], v[216:217], v[200:201], v[234:235]
    v_pk_mul_f32 v[236:237], v[212:213], v[206:207]
    v_pk_fma_f32 v[236:237], v[214:215], v[204:205], v[236:237]
    v_pk_fma_f32 v[236:237], v[216:217], v[202:203], v[236:237]
    v_pk_fma_f32 v[236:237], v[218:219], v[200:201], v[236:237]
    v_pk_mul_f32 v[238:239], v[214:215], v[206:207]
    v_pk_fma_f32 v[238:239], v[216:217], v[204:205], v[238:239]
    v_pk_fma_f32 v[238:239], v[218:219], v[202:203], v[238:239]
    v_pk_fma_f32 v[238:239], v[220:221], v[200:201], v[238:239]
    v_pk_mul_f32 v[240:241], v[216:217], v[206:207]
    v_pk_fma_f32 v[240:241], v[218:219], v[204:205], v[240:241]
    v_pk_fma_f32 v[240:241], v[220:221], v[202:203], v[240:241]
    v_pk_fma_f32 v[240:241], v[222:223], v[200:201], v[240:241]
    v_pk_mul_f32 v[242:243], v[218:219], v[206:207]
    v_pk_fma_f32 v[242:243], v[220:221], v[204:205], v[242:243]
    v_pk_fma_f32 v[242:243], v[222:223], v[202:203], v[242:243]
    v_pk_fma_f32 v[242:243], v[224:225], v[200:201], v[242:243]
    v_pk_mul_f32 v[244:245], v[220:221], v[206:207]
    v_pk_fma_f32 v[244:245], v[222:223], v[204:205], v[244:245]
    v_pk_fma_f32 v[244:245], v[224:225], v[202:203], v[244:245]
    v_pk_fma_f32 v[244:245], v[226:227], v[200:201], v[244:245]
    v_pk_mul_f32 v[246:247], v[222:223], v[206:207]
    v_pk_fma_f32 v[246:247], v[224:225], v[204:205], v[246:247]
    v_pk_fma_f32 v[246:247], v[226:227], v[202:203], v[246:247]
    v_pk_fma_f32 v[246:247], v[228:229], v[200:201], v[246:247]
    v_lshlrev_b32 v250, 16, v167
    v_and_b32 v251, 0xffff0000, v167
    v_pk_mul_f32 v[232:233], v[232:233], v[250:251]
    v_lshlrev_b32 v250, 16, v171
    v_and_b32 v251, 0xffff0000, v171
    v_pk_mul_f32 v[234:235], v[234:235], v[250:251]
    v_lshlrev_b32 v250, 16, v175
    v_and_b32 v251, 0xffff0000, v175
    v_pk_mul_f32 v[236:237], v[236:237], v[250:251]
    v_lshlrev_b32 v250, 16, v179
    v_and_b32 v251, 0xffff0000, v179
    v_pk_mul_f32 v[238:239], v[238:239], v[250:251]
    v_lshlrev_b32 v250, 16, v183
    v_and_b32 v251, 0xffff0000, v183
    v_pk_mul_f32 v[240:241], v[240:241], v[250:251]
    v_lshlrev_b32 v250, 16, v187
    v_and_b32 v251, 0xffff0000, v187
    v_pk_mul_f32 v[242:243], v[242:243], v[250:251]
    v_lshlrev_b32 v250, 16, v191
    v_and_b32 v251, 0xffff0000, v191
    v_pk_mul_f32 v[244:245], v[244:245], v[250:251]
    v_lshlrev_b32 v250, 16, v195
    v_and_b32 v251, 0xffff0000, v195
    v_pk_mul_f32 v[246:247], v[246:247], v[250:251]
    v_cvt_pk_bf16_f32 v8, v246, v244
    v_cvt_pk_bf16_f32 v9, v242, v240
    v_cvt_pk_bf16_f32 v10, v238, v236
    v_cvt_pk_bf16_f32 v11, v234, v232
    s_add_u32 s16, s68, 24576
    buffer_store_dwordx4 v[8:11], v196, s[32:35], s16 offen sc1
    v_cvt_pk_bf16_f32 v12, v247, v245
    v_cvt_pk_bf16_f32 v13, v243, v241
    v_cvt_pk_bf16_f32 v14, v239, v237
    v_cvt_pk_bf16_f32 v15, v235, v233
    s_add_u32 s16, s68, 28672
    buffer_store_dwordx4 v[12:15], v196, s[32:35], s16 offen sc1
    v_mov_b32 v252, 16
    buffer_load_dword v253, v252, s[36:39], 0 offen sc1
    s_barrier
    s_cmp_ge_u32 s2, 28
    s_cbranch_scc1 L_nocs2
    s_cmp_ge_u32 s3, 4
    s_cbranch_scc1 L_nocs2
    v_lshlrev_b32 v7, 2, v0
    ds_read2st64_b32 v[128:129], v7 offset0:0 offset1:4
    ds_read2st64_b32 v[130:131], v7 offset0:8 offset1:12
    ds_read2st64_b32 v[132:133], v7 offset0:16 offset1:20
    ds_read2st64_b32 v[134:135], v7 offset0:24 offset1:28
    ds_read2st64_b32 v[136:137], v7 offset0:32 offset1:36
    ds_read2st64_b32 v[138:139], v7 offset0:40 offset1:44
    ds_read2st64_b32 v[140:141], v7 offset0:48 offset1:52
    ds_read2st64_b32 v[142:143], v7 offset0:56 offset1:60
    s_waitcnt lgkmcnt(0)
    v_add_f32 v128, v128, v129
    v_add_f32 v128, v128, v130
    v_add_f32 v128, v128, v131
    v_add_f32 v128, v128, v132
    v_add_f32 v128, v128, v133
    v_add_f32 v128, v128, v134
    v_add_f32 v128, v128, v135
    v_add_f32 v128, v128, v136
    v_add_f32 v128, v128, v137
    v_add_f32 v128, v128, v138
    v_add_f32 v128, v128, v139
    v_add_f32 v128, v128, v140
    v_add_f32 v128, v128, v141
    v_add_f32 v128, v128, v142
    v_add_f32 v128, v128, v143
    s_lshl_b32 s16, s2, 10
    s_add_u32 s16, s16, 4886528
    buffer_store_dword v128, v7, s[32:35], s16 offen sc1
L_nocs2:
    s_waitcnt vmcnt(0)
    s_barrier
    v_cmp_gt_u32 vcc, 32, v253
    s_cmp_eq_u32 s3, 0
    s_cselect_b64 s[18:19], vcc, 0
    s_cmp_lg_u64 s[18:19], 0
    s_cbranch_scc1 L_hzsl
L_hzok:
    s_lshl_b32 s16, s2, 7
    s_add_u32 s16, s16, 32571392
    s_cmp_eq_u32 s3, 0
    s_cselect_b32 s16, s16, 0x20000000
    v_mov_b32 v14, 1
    v_mov_b32 v15, 0
    buffer_store_dword v14, v15, s[32:35], s16 offen sc1
    ds_bpermute_b32 v208, v255, v64
    ds_bpermute_b32 v209, v255, v65
    ds_bpermute_b32 v210, v255, v66
    ds_bpermute_b32 v211, v255, v67
    ds_bpermute_b32 v212, v255, v68
    ds_bpermute_b32 v213, v255, v69
    ds_bpermute_b32 v214, v255, v70
    ds_bpermute_b32 v215, v255, v71
    ds_bpermute_b32 v216, v255, v72
    ds_bpermute_b32 v217, v255, v73
    ds_bpermute_b32 v218, v255, v74
    ds_bpermute_b32 v219, v255, v75
    v_cmp_lt_u32 vcc, 7, v2
    s_nop 0
    s_waitcnt lgkmcnt(0)
    v_cndmask_b32 v32, v32, v208, vcc
    v_cndmask_b32 v33, v33, v209, vcc
    v_cndmask_b32 v34, v34, v210, vcc
    v_cndmask_b32 v35, v35, v211, vcc
    v_cndmask_b32 v36, v36, v212, vcc
    v_cndmask_b32 v37, v37, v213, vcc
    v_cndmask_b32 v38, v38, v214, vcc
    v_cndmask_b32 v39, v39, v215, vcc
    v_cndmask_b32 v40, v40, v216, vcc
    v_cndmask_b32 v41, v41, v217, vcc
    v_cndmask_b32 v42, v42, v218, vcc
    v_cndmask_b32 v43, v43, v219, vcc
    v_lshlrev_b32 v200, 16, v16
    v_lshlrev_b32 v201, 16, v18
    v_and_b32 v202, 0xffff0000, v16
    v_and_b32 v203, 0xffff0000, v18
    v_lshlrev_b32 v204, 16, v17
    v_lshlrev_b32 v205, 16, v19
    v_and_b32 v206, 0xffff0000, v17
    v_and_b32 v207, 0xffff0000, v19
    v_lshlrev_b32 v208, 16, v32
    v_and_b32 v209, 0xffff0000, v32
    v_lshlrev_b32 v210, 16, v36
    v_and_b32 v211, 0xffff0000, v36
    v_lshlrev_b32 v212, 16, v40
    v_and_b32 v213, 0xffff0000, v40
    v_lshlrev_b32 v214, 16, v44
    v_and_b32 v215, 0xffff0000, v44
    v_lshlrev_b32 v216, 16, v48
    v_and_b32 v217, 0xffff0000, v48
    v_lshlrev_b32 v218, 16, v52
    v_and_b32 v219, 0xffff0000, v52
    v_lshlrev_b32 v220, 16, v56
    v_and_b32 v221, 0xffff0000, v56
    v_lshlrev_b32 v222, 16, v60
    v_and_b32 v223, 0xffff0000, v60
    v_lshlrev_b32 v224, 16, v64
    v_and_b32 v225, 0xffff0000, v64
    v_lshlrev_b32 v226, 16, v68
    v_and_b32 v227, 0xffff0000, v68
    v_lshlrev_b32 v228, 16, v72
    v_and_b32 v229, 0xffff0000, v72
    v_pk_mul_f32 v[232:233], v[208:209], v[206:207]
    v_pk_fma_f32 v[232:233], v[210:211], v[204:205], v[232:233]
    v_pk_fma_f32 v[232:233], v[212:213], v[202:203], v[232:233]
    v_pk_fma_f32 v[232:233], v[214:215], v[200:201], v[232:233]
    v_pk_mul_f32 v[234:235], v[210:211], v[206:207]
    v_pk_fma_f32 v[234:235], v[212:213], v[204:205], v[234:235]
    v_pk_fma_f32 v[234:235], v[214:215], v[202:203], v[234:235]
    v_pk_fma_f32 v[234:235], v[216:217], v[200:201], v[234:235]
    v_pk_mul_f32 v[236:237], v[212:213], v[206:207]
    v_pk_fma_f32 v[236:237], v[214:215], v[204:205], v[236:237]
    v_pk_fma_f32 v[236:237], v[216:217], v[202:203], v[236:237]
    v_pk_fma_f32 v[236:237], v[218:219], v[200:201], v[236:237]
    v_pk_mul_f32 v[238:239], v[214:215], v[206:207]
    v_pk_fma_f32 v[238:239], v[216:217], v[204:205], v[238:239]
    v_pk_fma_f32 v[238:239], v[218:219], v[202:203], v[238:239]
    v_pk_fma_f32 v[238:239], v[220:221], v[200:201], v[238:239]
    v_pk_mul_f32 v[240:241], v[216:217], v[206:207]
    v_pk_fma_f32 v[240:241], v[218:219], v[204:205], v[240:241]
    v_pk_fma_f32 v[240:241], v[220:221], v[202:203], v[240:241]
    v_pk_fma_f32 v[240:241], v[222:223], v[200:201], v[240:241]
    v_pk_mul_f32 v[242:243], v[218:219], v[206:207]
    v_pk_fma_f32 v[242:243], v[220:221], v[204:205], v[242:243]
    v_pk_fma_f32 v[242:243], v[222:223], v[202:203], v[242:243]
    v_pk_fma_f32 v[242:243], v[224:225], v[200:201], v[242:243]
    v_pk_mul_f32 v[244:245], v[220:221], v[206:207]
    v_pk_fma_f32 v[244:245], v[222:223], v[204:205], v[244:245]
    v_pk_fma_f32 v[244:245], v[224:225], v[202:203], v[244:245]
    v_pk_fma_f32 v[244:245], v[226:227], v[200:201], v[244:245]
    v_pk_mul_f32 v[246:247], v[222:223], v[206:207]
    v_pk_fma_f32 v[246:247], v[224:225], v[204:205], v[246:247]
    v_pk_fma_f32 v[246:247], v[226:227], v[202:203], v[246:247]
    v_pk_fma_f32 v[246:247], v[228:229], v[200:201], v[246:247]
    v_lshlrev_b32 v250, 16, v76
    v_and_b32 v251, 0xffff0000, v76
    v_pk_mul_f32 v[232:233], v[232:233], v[250:251]
    v_lshlrev_b32 v250, 16, v80
    v_and_b32 v251, 0xffff0000, v80
    v_pk_mul_f32 v[234:235], v[234:235], v[250:251]
    v_lshlrev_b32 v250, 16, v84
    v_and_b32 v251, 0xffff0000, v84
    v_pk_mul_f32 v[236:237], v[236:237], v[250:251]
    v_lshlrev_b32 v250, 16, v88
    v_and_b32 v251, 0xffff0000, v88
    v_pk_mul_f32 v[238:239], v[238:239], v[250:251]
    v_lshlrev_b32 v250, 16, v92
    v_and_b32 v251, 0xffff0000, v92
    v_pk_mul_f32 v[240:241], v[240:241], v[250:251]
    v_lshlrev_b32 v250, 16, v96
    v_and_b32 v251, 0xffff0000, v96
    v_pk_mul_f32 v[242:243], v[242:243], v[250:251]
    v_lshlrev_b32 v250, 16, v100
    v_and_b32 v251, 0xffff0000, v100
    v_pk_mul_f32 v[244:245], v[244:245], v[250:251]
    v_lshlrev_b32 v250, 16, v104
    v_and_b32 v251, 0xffff0000, v104
    v_pk_mul_f32 v[246:247], v[246:247], v[250:251]
    v_cvt_pk_bf16_f32 v8, v246, v244
    v_cvt_pk_bf16_f32 v9, v242, v240
    v_cvt_pk_bf16_f32 v10, v238, v236
    v_cvt_pk_bf16_f32 v11, v234, v232
    s_add_u32 s16, s68, 2097152
    buffer_store_dwordx4 v[8:11], v196, s[32:35], s16 offen sc1
    v_cvt_pk_bf16_f32 v12, v247, v245
    v_cvt_pk_bf16_f32 v13, v243, v241
    v_cvt_pk_bf16_f32 v14, v239, v237
    v_cvt_pk_bf16_f32 v15, v235, v233
    s_add_u32 s16, s68, 2101248
    buffer_store_dwordx4 v[12:15], v196, s[32:35], s16 offen sc1
    v_lshlrev_b32 v200, 16, v20
    v_lshlrev_b32 v201, 16, v22
    v_and_b32 v202, 0xffff0000, v20
    v_and_b32 v203, 0xffff0000, v22
    v_lshlrev_b32 v204, 16, v21
    v_lshlrev_b32 v205, 16, v23
    v_and_b32 v206, 0xffff0000, v21
    v_and_b32 v207, 0xffff0000, v23
    v_lshlrev_b32 v208, 16, v33
    v_and_b32 v209, 0xffff0000, v33
    v_lshlrev_b32 v210, 16, v37
    v_and_b32 v211, 0xffff0000, v37
    v_lshlrev_b32 v212, 16, v41
    v_and_b32 v213, 0xffff0000, v41
    v_lshlrev_b32 v214, 16, v45
    v_and_b32 v215, 0xffff0000, v45
    v_lshlrev_b32 v216, 16, v49
    v_and_b32 v217, 0xffff0000, v49
    v_lshlrev_b32 v218, 16, v53
    v_and_b32 v219, 0xffff0000, v53
    v_lshlrev_b32 v220, 16, v57
    v_and_b32 v221, 0xffff0000, v57
    v_lshlrev_b32 v222, 16, v61
    v_and_b32 v223, 0xffff0000, v61
    v_lshlrev_b32 v224, 16, v65
    v_and_b32 v225, 0xffff0000, v65
    v_lshlrev_b32 v226, 16, v69
    v_and_b32 v227, 0xffff0000, v69
    v_lshlrev_b32 v228, 16, v73
    v_and_b32 v229, 0xffff0000, v73
    v_pk_mul_f32 v[232:233], v[208:209], v[206:207]
    v_pk_fma_f32 v[232:233], v[210:211], v[204:205], v[232:233]
    v_pk_fma_f32 v[232:233], v[212:213], v[202:203], v[232:233]
    v_pk_fma_f32 v[232:233], v[214:215], v[200:201], v[232:233]
    v_pk_mul_f32 v[234:235], v[210:211], v[206:207]
    v_pk_fma_f32 v[234:235], v[212:213], v[204:205], v[234:235]
    v_pk_fma_f32 v[234:235], v[214:215], v[202:203], v[234:235]
    v_pk_fma_f32 v[234:235], v[216:217], v[200:201], v[234:235]
    v_pk_mul_f32 v[236:237], v[212:213], v[206:207]
    v_pk_fma_f32 v[236:237], v[214:215], v[204:205], v[236:237]
    v_pk_fma_f32 v[236:237], v[216:217], v[202:203], v[236:237]
    v_pk_fma_f32 v[236:237], v[218:219], v[200:201], v[236:237]
    v_pk_mul_f32 v[238:239], v[214:215], v[206:207]
    v_pk_fma_f32 v[238:239], v[216:217], v[204:205], v[238:239]
    v_pk_fma_f32 v[238:239], v[218:219], v[202:203], v[238:239]
    v_pk_fma_f32 v[238:239], v[220:221], v[200:201], v[238:239]
    v_pk_mul_f32 v[240:241], v[216:217], v[206:207]
    v_pk_fma_f32 v[240:241], v[218:219], v[204:205], v[240:241]
    v_pk_fma_f32 v[240:241], v[220:221], v[202:203], v[240:241]
    v_pk_fma_f32 v[240:241], v[222:223], v[200:201], v[240:241]
    v_pk_mul_f32 v[242:243], v[218:219], v[206:207]
    v_pk_fma_f32 v[242:243], v[220:221], v[204:205], v[242:243]
    v_pk_fma_f32 v[242:243], v[222:223], v[202:203], v[242:243]
    v_pk_fma_f32 v[242:243], v[224:225], v[200:201], v[242:243]
    v_pk_mul_f32 v[244:245], v[220:221], v[206:207]
    v_pk_fma_f32 v[244:245], v[222:223], v[204:205], v[244:245]
    v_pk_fma_f32 v[244:245], v[224:225], v[202:203], v[244:245]
    v_pk_fma_f32 v[244:245], v[226:227], v[200:201], v[244:245]
    v_pk_mul_f32 v[246:247], v[222:223], v[206:207]
    v_pk_fma_f32 v[246:247], v[224:225], v[204:205], v[246:247]
    v_pk_fma_f32 v[246:247], v[226:227], v[202:203], v[246:247]
    v_pk_fma_f32 v[246:247], v[228:229], v[200:201], v[246:247]
    v_lshlrev_b32 v250, 16, v77
    v_and_b32 v251, 0xffff0000, v77
    v_pk_mul_f32 v[232:233], v[232:233], v[250:251]
    v_lshlrev_b32 v250, 16, v81
    v_and_b32 v251, 0xffff0000, v81
    v_pk_mul_f32 v[234:235], v[234:235], v[250:251]
    v_lshlrev_b32 v250, 16, v85
    v_and_b32 v251, 0xffff0000, v85
    v_pk_mul_f32 v[236:237], v[236:237], v[250:251]
    v_lshlrev_b32 v250, 16, v89
    v_and_b32 v251, 0xffff0000, v89
    v_pk_mul_f32 v[238:239], v[238:239], v[250:251]
    v_lshlrev_b32 v250, 16, v93
    v_and_b32 v251, 0xffff0000, v93
    v_pk_mul_f32 v[240:241], v[240:241], v[250:251]
    v_lshlrev_b32 v250, 16, v97
    v_and_b32 v251, 0xffff0000, v97
    v_pk_mul_f32 v[242:243], v[242:243], v[250:251]
    v_lshlrev_b32 v250, 16, v101
    v_and_b32 v251, 0xffff0000, v101
    v_pk_mul_f32 v[244:245], v[244:245], v[250:251]
    v_lshlrev_b32 v250, 16, v105
    v_and_b32 v251, 0xffff0000, v105
    v_pk_mul_f32 v[246:247], v[246:247], v[250:251]
    v_cvt_pk_bf16_f32 v8, v246, v244
    v_cvt_pk_bf16_f32 v9, v242, v240
    v_cvt_pk_bf16_f32 v10, v238, v236
    v_cvt_pk_bf16_f32 v11, v234, v232
    s_add_u32 s16, s68, 2105344
    buffer_store_dwordx4 v[8:11], v196, s[32:35], s16 offen sc1
    v_cvt_pk_bf16_f32 v12, v247, v245
    v_cvt_pk_bf16_f32 v13, v243, v241
    v_cvt_pk_bf16_f32 v14, v239, v237
    v_cvt_pk_bf16_f32 v15, v235, v233
    s_add_u32 s16, s68, 2109440
    buffer_store_dwordx4 v[12:15], v196, s[32:35], s16 offen sc1
    v_lshlrev_b32 v200, 16, v24
    v_lshlrev_b32 v201, 16, v26
    v_and_b32 v202, 0xffff0000, v24
    v_and_b32 v203, 0xffff0000, v26
    v_lshlrev_b32 v204, 16, v25
    v_lshlrev_b32 v205, 16, v27
    v_and_b32 v206, 0xffff0000, v25
    v_and_b32 v207, 0xffff0000, v27
    v_lshlrev_b32 v208, 16, v34
    v_and_b32 v209, 0xffff0000, v34
    v_lshlrev_b32 v210, 16, v38
    v_and_b32 v211, 0xffff0000, v38
    v_lshlrev_b32 v212, 16, v42
    v_and_b32 v213, 0xffff0000, v42
    v_lshlrev_b32 v214, 16, v46
    v_and_b32 v215, 0xffff0000, v46
    v_lshlrev_b32 v216, 16, v50
    v_and_b32 v217, 0xffff0000, v50
    v_lshlrev_b32 v218, 16, v54
    v_and_b32 v219, 0xffff0000, v54
    v_lshlrev_b32 v220, 16, v58
    v_and_b32 v221, 0xffff0000, v58
    v_lshlrev_b32 v222, 16, v62
    v_and_b32 v223, 0xffff0000, v62
    v_lshlrev_b32 v224, 16, v66
    v_and_b32 v225, 0xffff0000, v66
    v_lshlrev_b32 v226, 16, v70
    v_and_b32 v227, 0xffff0000, v70
    v_lshlrev_b32 v228, 16, v74
    v_and_b32 v229, 0xffff0000, v74
    v_pk_mul_f32 v[232:233], v[208:209], v[206:207]
    v_pk_fma_f32 v[232:233], v[210:211], v[204:205], v[232:233]
    v_pk_fma_f32 v[232:233], v[212:213], v[202:203], v[232:233]
    v_pk_fma_f32 v[232:233], v[214:215], v[200:201], v[232:233]
    v_pk_mul_f32 v[234:235], v[210:211], v[206:207]
    v_pk_fma_f32 v[234:235], v[212:213], v[204:205], v[234:235]
    v_pk_fma_f32 v[234:235], v[214:215], v[202:203], v[234:235]
    v_pk_fma_f32 v[234:235], v[216:217], v[200:201], v[234:235]
    v_pk_mul_f32 v[236:237], v[212:213], v[206:207]
    v_pk_fma_f32 v[236:237], v[214:215], v[204:205], v[236:237]
    v_pk_fma_f32 v[236:237], v[216:217], v[202:203], v[236:237]
    v_pk_fma_f32 v[236:237], v[218:219], v[200:201], v[236:237]
    v_pk_mul_f32 v[238:239], v[214:215], v[206:207]
    v_pk_fma_f32 v[238:239], v[216:217], v[204:205], v[238:239]
    v_pk_fma_f32 v[238:239], v[218:219], v[202:203], v[238:239]
    v_pk_fma_f32 v[238:239], v[220:221], v[200:201], v[238:239]
    v_pk_mul_f32 v[240:241], v[216:217], v[206:207]
    v_pk_fma_f32 v[240:241], v[218:219], v[204:205], v[240:241]
    v_pk_fma_f32 v[240:241], v[220:221], v[202:203], v[240:241]
    v_pk_fma_f32 v[240:241], v[222:223], v[200:201], v[240:241]
    v_pk_mul_f32 v[242:243], v[218:219], v[206:207]
    v_pk_fma_f32 v[242:243], v[220:221], v[204:205], v[242:243]
    v_pk_fma_f32 v[242:243], v[222:223], v[202:203], v[242:243]
    v_pk_fma_f32 v[242:243], v[224:225], v[200:201], v[242:243]
    v_pk_mul_f32 v[244:245], v[220:221], v[206:207]
    v_pk_fma_f32 v[244:245], v[222:223], v[204:205], v[244:245]
    v_pk_fma_f32 v[244:245], v[224:225], v[202:203], v[244:245]
    v_pk_fma_f32 v[244:245], v[226:227], v[200:201], v[244:245]
    v_pk_mul_f32 v[246:247], v[222:223], v[206:207]
    v_pk_fma_f32 v[246:247], v[224:225], v[204:205], v[246:247]
    v_pk_fma_f32 v[246:247], v[226:227], v[202:203], v[246:247]
    v_pk_fma_f32 v[246:247], v[228:229], v[200:201], v[246:247]
    v_lshlrev_b32 v250, 16, v78
    v_and_b32 v251, 0xffff0000, v78
    v_pk_mul_f32 v[232:233], v[232:233], v[250:251]
    v_lshlrev_b32 v250, 16, v82
    v_and_b32 v251, 0xffff0000, v82
    v_pk_mul_f32 v[234:235], v[234:235], v[250:251]
    v_lshlrev_b32 v250, 16, v86
    v_and_b32 v251, 0xffff0000, v86
    v_pk_mul_f32 v[236:237], v[236:237], v[250:251]
    v_lshlrev_b32 v250, 16, v90
    v_and_b32 v251, 0xffff0000, v90
    v_pk_mul_f32 v[238:239], v[238:239], v[250:251]
    v_lshlrev_b32 v250, 16, v94
    v_and_b32 v251, 0xffff0000, v94
    v_pk_mul_f32 v[240:241], v[240:241], v[250:251]
    v_lshlrev_b32 v250, 16, v98
    v_and_b32 v251, 0xffff0000, v98
    v_pk_mul_f32 v[242:243], v[242:243], v[250:251]
    v_lshlrev_b32 v250, 16, v102
    v_and_b32 v251, 0xffff0000, v102
    v_pk_mul_f32 v[244:245], v[244:245], v[250:251]
    v_lshlrev_b32 v250, 16, v106
    v_and_b32 v251, 0xffff0000, v106
    v_pk_mul_f32 v[246:247], v[246:247], v[250:251]
    v_cvt_pk_bf16_f32 v8, v246, v244
    v_cvt_pk_bf16_f32 v9, v242, v240
    v_cvt_pk_bf16_f32 v10, v238, v236
    v_cvt_pk_bf16_f32 v11, v234, v232
    s_add_u32 s16, s68, 2113536
    buffer_store_dwordx4 v[8:11], v196, s[32:35], s16 offen sc1
    v_cvt_pk_bf16_f32 v12, v247, v245
    v_cvt_pk_bf16_f32 v13, v243, v241
    v_cvt_pk_bf16_f32 v14, v239, v237
    v_cvt_pk_bf16_f32 v15, v235, v233
    s_add_u32 s16, s68, 2117632
    buffer_store_dwordx4 v[12:15], v196, s[32:35], s16 offen sc1
    v_lshlrev_b32 v200, 16, v28
    v_lshlrev_b32 v201, 16, v30
    v_and_b32 v202, 0xffff0000, v28
    v_and_b32 v203, 0xffff0000, v30
    v_lshlrev_b32 v204, 16, v29
    v_lshlrev_b32 v205, 16, v31
    v_and_b32 v206, 0xffff0000, v29
    v_and_b32 v207, 0xffff0000, v31
    v_lshlrev_b32 v208, 16, v35
    v_and_b32 v209, 0xffff0000, v35
    v_lshlrev_b32 v210, 16, v39
    v_and_b32 v211, 0xffff0000, v39
    v_lshlrev_b32 v212, 16, v43
    v_and_b32 v213, 0xffff0000, v43
    v_lshlrev_b32 v214, 16, v47
    v_and_b32 v215, 0xffff0000, v47
    v_lshlrev_b32 v216, 16, v51
    v_and_b32 v217, 0xffff0000, v51
    v_lshlrev_b32 v218, 16, v55
    v_and_b32 v219, 0xffff0000, v55
    v_lshlrev_b32 v220, 16, v59
    v_and_b32 v221, 0xffff0000, v59
    v_lshlrev_b32 v222, 16, v63
    v_and_b32 v223, 0xffff0000, v63
    v_lshlrev_b32 v224, 16, v67
    v_and_b32 v225, 0xffff0000, v67
    v_lshlrev_b32 v226, 16, v71
    v_and_b32 v227, 0xffff0000, v71
    v_lshlrev_b32 v228, 16, v75
    v_and_b32 v229, 0xffff0000, v75
    v_pk_mul_f32 v[232:233], v[208:209], v[206:207]
    v_pk_fma_f32 v[232:233], v[210:211], v[204:205], v[232:233]
    v_pk_fma_f32 v[232:233], v[212:213], v[202:203], v[232:233]
    v_pk_fma_f32 v[232:233], v[214:215], v[200:201], v[232:233]
    v_pk_mul_f32 v[234:235], v[210:211], v[206:207]
    v_pk_fma_f32 v[234:235], v[212:213], v[204:205], v[234:235]
    v_pk_fma_f32 v[234:235], v[214:215], v[202:203], v[234:235]
    v_pk_fma_f32 v[234:235], v[216:217], v[200:201], v[234:235]
    v_pk_mul_f32 v[236:237], v[212:213], v[206:207]
    v_pk_fma_f32 v[236:237], v[214:215], v[204:205], v[236:237]
    v_pk_fma_f32 v[236:237], v[216:217], v[202:203], v[236:237]
    v_pk_fma_f32 v[236:237], v[218:219], v[200:201], v[236:237]
    v_pk_mul_f32 v[238:239], v[214:215], v[206:207]
    v_pk_fma_f32 v[238:239], v[216:217], v[204:205], v[238:239]
    v_pk_fma_f32 v[238:239], v[218:219], v[202:203], v[238:239]
    v_pk_fma_f32 v[238:239], v[220:221], v[200:201], v[238:239]
    v_pk_mul_f32 v[240:241], v[216:217], v[206:207]
    v_pk_fma_f32 v[240:241], v[218:219], v[204:205], v[240:241]
    v_pk_fma_f32 v[240:241], v[220:221], v[202:203], v[240:241]
    v_pk_fma_f32 v[240:241], v[222:223], v[200:201], v[240:241]
    v_pk_mul_f32 v[242:243], v[218:219], v[206:207]
    v_pk_fma_f32 v[242:243], v[220:221], v[204:205], v[242:243]
    v_pk_fma_f32 v[242:243], v[222:223], v[202:203], v[242:243]
    v_pk_fma_f32 v[242:243], v[224:225], v[200:201], v[242:243]
    v_pk_mul_f32 v[244:245], v[220:221], v[206:207]
    v_pk_fma_f32 v[244:245], v[222:223], v[204:205], v[244:245]
    v_pk_fma_f32 v[244:245], v[224:225], v[202:203], v[244:245]
    v_pk_fma_f32 v[244:245], v[226:227], v[200:201], v[244:245]
    v_pk_mul_f32 v[246:247], v[222:223], v[206:207]
    v_pk_fma_f32 v[246:247], v[224:225], v[204:205], v[246:247]
    v_pk_fma_f32 v[246:247], v[226:227], v[202:203], v[246:247]
    v_pk_fma_f32 v[246:247], v[228:229], v[200:201], v[246:247]
    v_lshlrev_b32 v250, 16, v79
    v_and_b32 v251, 0xffff0000, v79
    v_pk_mul_f32 v[232:233], v[232:233], v[250:251]
    v_lshlrev_b32 v250, 16, v83
    v_and_b32 v251, 0xffff0000, v83
    v_pk_mul_f32 v[234:235], v[234:235], v[250:251]
    v_lshlrev_b32 v250, 16, v87
    v_and_b32 v251, 0xffff0000, v87
    v_pk_mul_f32 v[236:237], v[236:237], v[250:251]
    v_lshlrev_b32 v250, 16, v91
    v_and_b32 v251, 0xffff0000, v91
    v_pk_mul_f32 v[238:239], v[238:239], v[250:251]
    v_lshlrev_b32 v250, 16, v95
    v_and_b32 v251, 0xffff0000, v95
    v_pk_mul_f32 v[240:241], v[240:241], v[250:251]
    v_lshlrev_b32 v250, 16, v99
    v_and_b32 v251, 0xffff0000, v99
    v_pk_mul_f32 v[242:243], v[242:243], v[250:251]
    v_lshlrev_b32 v250, 16, v103
    v_and_b32 v251, 0xffff0000, v103
    v_pk_mul_f32 v[244:245], v[244:245], v[250:251]
    v_lshlrev_b32 v250, 16, v107
    v_and_b32 v251, 0xffff0000, v107
    v_pk_mul_f32 v[246:247], v[246:247], v[250:251]
    v_cvt_pk_bf16_f32 v8, v246, v244
    v_cvt_pk_bf16_f32 v9, v242, v240
    v_cvt_pk_bf16_f32 v10, v238, v236
    v_cvt_pk_bf16_f32 v11, v234, v232
    s_add_u32 s16, s68, 2121728
    buffer_store_dwordx4 v[8:11], v196, s[32:35], s16 offen sc1
    v_cvt_pk_bf16_f32 v12, v247, v245
    v_cvt_pk_bf16_f32 v13, v243, v241
    v_cvt_pk_bf16_f32 v14, v239, v237
    v_cvt_pk_bf16_f32 v15, v235, v233
    s_add_u32 s16, s68, 2125824
    buffer_store_dwordx4 v[12:15], v196, s[32:35], s16 offen sc1
    s_waitcnt vmcnt(0)
    s_barrier
    s_lshl_b32 s16, s2, 7
    s_add_u32 s16, s16, 32702464
    s_cmp_eq_u32 s3, 0
    s_cselect_b32 s16, s16, 0x20000000
    v_mov_b32 v16, 1
    v_mov_b32 v17, 0
    buffer_store_dword v16, v17, s[32:35], s16 offen sc1
    s_add_u32 s100, s2, 224
    s_mov_b32 s98, 0x20000000
    s_mov_b32 s99, 0x20000000
    v_and_b32 v6, 31, v2
    v_lshlrev_b32 v6, 7, v6
    s_mov_b32 s72, 32702464
    v_mov_b32 v7, 0
    s_nop 0
    v_cmp_ne_u32 vcc, 1, v7
    s_cmp_eq_u32 s3, 0
    s_cselect_b64 s[18:19], vcc, 0
    s_cmp_lg_u64 s[18:19], 0
    s_cbranch_scc1 L_ok2hsl
L_ok2hok:
    s_barrier
    s_and_b32 s71, s3, 3
    s_lshl_b32 s18, s2, 2
    s_add_u32 s18, s18, s71
    s_mul_i32 s17, s71, 21248
    s_add_u32 s17, s17, 98304
    s_cmp_eq_u32 s71, 3
    s_cselect_b32 s71, 5120, s17
    s_lshl_b32 s73, s18, 12
    v_add_u32 v0, v3, v4
    v_subrev_u32 v0, 15, v0
    v_lshlrev_b32 v0, 1, v0
    v_cmp_gt_i32 vcc, 0, v0
    v_add_u32 v0, s73, v0
    s_lshl_b32 s17, s18, 1
    v_cndmask_b32 v0, v0, -1, vcc
    v_mov_b32 v1, s17
    buffer_load_ushort v0, v0, s[56:59], 0 offen
    buffer_load_ushort v1, v1, s[60:63], 0 offen
    s_lshr_b32 s17, s3, 2
    s_lshl_b32 s17, s17, 11
    s_add_u32 s74, s71, s17
    s_add_u32 s75, s73, s17
    v_lshlrev_b32 v15, 4, v2
    s_add_u32 m0, s74, 32
    s_add_u32 s17, s75, 2
    buffer_load_dwordx4 v15, s[56:59], s17 offen  lds
    s_add_u32 m0, s74, 4188
    s_add_u32 s17, s75, 0
    buffer_load_dwordx4 v15, s[56:59], s17 offen  lds
    s_add_u32 m0, s74, 8348
    s_add_u32 s17, s75, 2
    buffer_load_dwordx4 v15, s[56:59], s17 offen  lds
    s_add_u32 m0, s74, 12504
    s_add_u32 s17, s75, 0
    buffer_load_dwordx4 v15, s[56:59], s17 offen  lds
    s_add_u32 m0, s74, 1056
    s_add_u32 s17, s75, 1026
    buffer_load_dwordx4 v15, s[56:59], s17 offen  lds
    s_add_u32 m0, s74, 5212
    s_add_u32 s17, s75, 1024
    buffer_load_dwordx4 v15, s[56:59], s17 offen  lds
    s_add_u32 m0, s74, 9372
    s_add_u32 s17, s75, 1026
    buffer_load_dwordx4 v15, s[56:59], s17 offen  lds
    s_add_u32 m0, s74, 13528
    s_add_u32 s17, s75, 1024
    buffer_load_dwordx4 v15, s[56:59], s17 offen  lds
    s_add_u32 m0, s74, 16640
    s_add_u32 s17, s75, 5242880
    buffer_load_dwordx4 v15, s[32:35], s17 offen sc1 lds
    s_add_u32 m0, s74, 17664
    s_add_u32 s17, s75, 5243904
    buffer_load_dwordx4 v15, s[32:35], s17 offen sc1 lds
    s_waitcnt vmcnt(0)
L_conv:
    s_cmp_ge_u32 s3, 4
    s_cbranch_scc1 L_cskip
    v_mov_b32 v10, 0
    v_mov_b32 v11, 0
    v_lshlrev_b32 v9, 3, v2
    v_add_u32 v9, s71, v9
    v_mul_u32_u24 v14, 4160, v3
    v_lshl_add_u32 v14, v4, 1, v14
    v_add_u32 v14, s71, v14
    ds_write_b64 v9, v[10:11] offset:20736
    ds_write_b16 v14, v0
    v_and_b32 v9, 3, v4
    v_mul_u32_u24 v9, 4160, v9
    v_and_b32 v10, 12, v4
    v_lshl_add_u32 v10, v3, 3, v10
    v_lshl_add_u32 v9, v10, 1, v9
    v_add_u32 v12, s71, v9
    v_lshlrev_b32 v9, 5, v4
    v_sub_u32 v9, 17120, v9
    v_lshl_add_u32 v9, v3, 4, v9
    v_add_u32 v13, s71, v9
    s_waitcnt lgkmcnt(0)
L_cskip:
    s_barrier
    s_cmp_ge_u32 s3, 4
    s_cbranch_scc1 L_idle
    ds_read_b128 v[64:67], v13 offset:3584
    ds_read_b64 v[60:61], v12 offset:3584
    ds_read_b64 v[62:63], v12 offset:3592
    ds_read_b64 v[56:57], v12 offset:3072
    ds_read_b64 v[58:59], v12 offset:3080
    ds_read_b128 v[68:71], v13 offset:3072
    ds_read_b64 v[52:53], v12 offset:2560
    ds_read_b64 v[54:55], v12 offset:2568
    ds_read_b128 v[72:75], v13 offset:2560
    ds_read_b64 v[48:49], v12 offset:2048
    ds_read_b64 v[50:51], v12 offset:2056
    ds_read_b128 v[76:79], v13 offset:2048
    ds_read_b64 v[44:45], v12 offset:1536
    ds_read_b64 v[46:47], v12 offset:1544
    ds_read_b128 v[80:83], v13 offset:1536
    ds_read_b64 v[40:41], v12 offset:1024
    ds_read_b64 v[42:43], v12 offset:1032
    ds_read_b128 v[84:87], v13 offset:1024
    ds_read_b64 v[36:37], v12 offset:512
    ds_read_b64 v[38:39], v12 offset:520
    ds_read_b128 v[88:91], v13 offset:512
    ds_read_b64 v[32:33], v12 offset:0
    ds_read_b64 v[34:35], v12 offset:8
    ds_read_b128 v[92:95], v13 offset:0
    v_lshl_add_u32 v5, v3, 3, v4
    v_sub_u32 v5, 15, v5
    v_and_b32 v6, 1, v5
    v_lshlrev_b32 v6, 4, v6
    v_lshlrev_b32 v6, v6, v1
    v_lshrrev_b32 v5, 1, v5
    v_cmp_eq_u32 vcc, 0, v5
    s_nop 1
    v_cndmask_b32 v24, 0, v6, vcc
    v_cmp_eq_u32 vcc, 1, v5
    s_nop 1
    v_cndmask_b32 v25, 0, v6, vcc
    v_cmp_eq_u32 vcc, 2, v5
    s_nop 1
    v_cndmask_b32 v26, 0, v6, vcc
    v_cmp_eq_u32 vcc, 3, v5
    s_nop 1
    v_cndmask_b32 v27, 0, v6, vcc
    s_and_b32 s8, s101, 1
    s_bfe_u32 s16, s101, 0x10001
    s_lshl_b32 s16, s16, 3
    s_bfe_u32 s17, s101, 0x30003
    s_add_u32 s9, s16, s17
    s_bfe_u32 s16, s101, 0x10002
    s_lshl_b32 s16, s16, 2
    s_lshr_b32 s17, s101, 6
    s_add_u32 s10, s16, s17
    s_lshr_b32 s11, s3, 2
    s_and_b32 s12, s3, 3
    s_lshl_b32 s16, s3, 2
    v_add_u32 v5, s16, v3
    v_and_b32 v6, 7, v5
    v_lshlrev_b32 v6, 1, v6
    v_xor_b32 v6, v6, v4
    v_lshlrev_b32 v5, 11, v5
    v_lshl_add_u32 v20, v6, 4, v5
    s_mul_i32 s13, s8, 3670016
    s_lshl_b32 s16, s10, 8
    s_add_u32 s13, s13, s16
    s_lshl_b32 s66, s3, 10
    s_mul_i32 s16, s8, 56
    s_add_u32 s16, s16, s11
    s_lshl_b32 s16, s16, 7
    s_lshl_b32 s17, s9, 3
    s_add_u32 s16, s16, s17
    s_lshl_b32 s17, s12, 1
    s_add_u32 s16, s16, s17
    s_lshl_b32 s16, s16, 10
    s_add_u32 s14, s16, 10485760
    s_lshl_b32 s16, s11, 10
    v_lshl_add_u32 v21, v2, 4, s16
    v_xor_b32 v22, 0x400, v21
    s_waitcnt lgkmcnt(15)
    v_mfma_f32_16x16x32_bf16 v[124:127], v[60:63], v[64:67], 0
    ds_read_b64 v[60:61], v12 offset:3648
    v_mfma_f32_16x16x32_bf16 v[120:123], v[56:59], v[64:67], 0
    ds_read_b64 v[62:63], v12 offset:3656
    v_mfma_f32_16x16x32_bf16 v[124:127], v[56:59], v[68:71], v[124:127]
    ds_read_b64 v[56:57], v12 offset:3136
    v_mfma_f32_16x16x32_bf16 v[116:119], v[52:55], v[64:67], 0
    ds_read_b64 v[58:59], v12 offset:3144
    v_mfma_f32_16x16x32_bf16 v[120:123], v[52:55], v[68:71], v[120:123]
    v_mfma_f32_16x16x32_bf16 v[124:127], v[52:55], v[72:75], v[124:127]
    ds_read_b64 v[52:53], v12 offset:2624
    s_waitcnt lgkmcnt(15)
    v_mfma_f32_16x16x32_bf16 v[112:115], v[48:51], v[64:67], 0
    ds_read_b64 v[54:55], v12 offset:2632
    v_mfma_f32_16x16x32_bf16 v[116:119], v[48:51], v[68:71], v[116:119]
    v_mfma_f32_16x16x32_bf16 v[120:123], v[48:51], v[72:75], v[120:123]
    v_mfma_f32_16x16x32_bf16 v[124:127], v[48:51], v[76:79], v[124:127]
    ds_read_b64 v[48:49], v12 offset:2112
    v_mfma_f32_16x16x32_bf16 v[108:111], v[44:47], v[64:67], 0
    ds_read_b64 v[50:51], v12 offset:2120
    v_mfma_f32_16x16x32_bf16 v[112:115], v[44:47], v[68:71], v[112:115]
    v_mfma_f32_16x16x32_bf16 v[116:119], v[44:47], v[72:75], v[116:119]
    v_mfma_f32_16x16x32_bf16 v[120:123], v[44:47], v[76:79], v[120:123]
    s_waitcnt lgkmcnt(15)
    v_mfma_f32_16x16x32_bf16 v[124:127], v[44:47], v[80:83], v[124:127]
    ds_read_b64 v[44:45], v12 offset:1600
    v_mfma_f32_16x16x32_bf16 v[104:107], v[40:43], v[64:67], 0
    ds_read_b64 v[46:47], v12 offset:1608
    v_mfma_f32_16x16x32_bf16 v[108:111], v[40:43], v[68:71], v[108:111]
    v_mfma_f32_16x16x32_bf16 v[112:115], v[40:43], v[72:75], v[112:115]
    v_mfma_f32_16x16x32_bf16 v[116:119], v[40:43], v[76:79], v[116:119]
    v_mfma_f32_16x16x32_bf16 v[120:123], v[40:43], v[80:83], v[120:123]
    s_waitcnt lgkmcnt(15)
    v_mfma_f32_16x16x32_bf16 v[124:127], v[40:43], v[84:87], v[124:127]
    ds_read_b64 v[40:41], v12 offset:1088
    v_mfma_f32_16x16x32_bf16 v[100:103], v[36:39], v[64:67], 0
    ds_read_b64 v[42:43], v12 offset:1096
    v_mfma_f32_16x16x32_bf16 v[104:107], v[36:39], v[68:71], v[104:107]
    v_mfma_f32_16x16x32_bf16 v[108:111], v[36:39], v[72:75], v[108:111]
    v_mfma_f32_16x16x32_bf16 v[112:115], v[36:39], v[76:79], v[112:115]
    v_mfma_f32_16x16x32_bf16 v[116:119], v[36:39], v[80:83], v[116:119]
    v_mfma_f32_16x16x32_bf16 v[120:123], v[36:39], v[84:87], v[120:123]
    s_waitcnt lgkmcnt(15)
    v_mfma_f32_16x16x32_bf16 v[124:127], v[36:39], v[88:91], v[124:127]
    ds_read_b64 v[36:37], v12 offset:576
    s_waitcnt lgkmcnt(14)
    v_mfma_f32_16x16x32_bf16 v[96:99], v[24:27], v[64:67], 0
    v_mfma_f32_16x16x32_bf16 v[96:99], v[32:35], v[64:67], v[96:99]
    ds_read_b64 v[38:39], v12 offset:584
    ds_read_b128 v[64:67], v13 offset:3648
    v_mfma_f32_16x16x32_bf16 v[100:103], v[24:27], v[68:71], v[100:103]
    v_mfma_f32_16x16x32_bf16 v[100:103], v[32:35], v[68:71], v[100:103]
    ds_read_b128 v[68:71], v13 offset:3136
    v_mfma_f32_16x16x32_bf16 v[104:107], v[24:27], v[72:75], v[104:107]
    v_mfma_f32_16x16x32_bf16 v[104:107], v[32:35], v[72:75], v[104:107]
    ds_read_b128 v[72:75], v13 offset:2624
    v_mfma_f32_16x16x32_bf16 v[108:111], v[24:27], v[76:79], v[108:111]
    v_mfma_f32_16x16x32_bf16 v[108:111], v[32:35], v[76:79], v[108:111]
    ds_read_b128 v[76:79], v13 offset:2112
    v_mfma_f32_16x16x32_bf16 v[112:115], v[24:27], v[80:83], v[112:115]
    v_mfma_f32_16x16x32_bf16 v[112:115], v[32:35], v[80:83], v[112:115]
    ds_read_b128 v[80:83], v13 offset:1600
    v_mfma_f32_16x16x32_bf16 v[116:119], v[24:27], v[84:87], v[116:119]
    v_mfma_f32_16x16x32_bf16 v[116:119], v[32:35], v[84:87], v[116:119]
    ds_read_b128 v[84:87], v13 offset:1088
    v_mfma_f32_16x16x32_bf16 v[120:123], v[24:27], v[88:91], v[120:123]
    v_mfma_f32_16x16x32_bf16 v[120:123], v[32:35], v[88:91], v[120:123]
    ds_read_b128 v[88:91], v13 offset:576
    s_waitcnt lgkmcnt(15)
    v_mfma_f32_16x16x32_bf16 v[124:127], v[24:27], v[92:95], v[124:127]
    v_mfma_f32_16x16x32_bf16 v[124:127], v[32:35], v[92:95], v[124:127]
    ds_read_b128 v[92:95], v13 offset:64
    ds_read_b64 v[32:33], v12 offset:64
    s_waitcnt lgkmcnt(8)
    v_mfma_f32_16x16x32_bf16 v[124:127], v[60:63], v[64:67], v[124:127]
    ds_read_b64 v[34:35], v12 offset:72
    v_lshrrev_b32 v5, 2, v2
    ds_read_b64 v[60:61], v12 offset:3712
    v_mfma_f32_16x16x32_bf16 v[120:123], v[56:59], v[64:67], v[120:123]
    ds_read_b64 v[62:63], v12 offset:3720
    v_and_b32 v5, 3, v5
    s_waitcnt lgkmcnt(10)
    v_mfma_f32_16x16x32_bf16 v[124:127], v[56:59], v[68:71], v[124:127]
    v_lshl_add_u32 v5, v3, 2, v5
    ds_read_b64 v[56:57], v12 offset:3200
    v_mfma_f32_16x16x32_bf16 v[116:119], v[52:55], v[64:67], v[116:119]
    ds_read_b64 v[58:59], v12 offset:3208
    v_and_b32 v6, 7, v5
    v_mfma_f32_16x16x32_bf16 v[120:123], v[52:55], v[68:71], v[120:123]
    v_lshlrev_b32 v6, 5, v6
    s_waitcnt lgkmcnt(11)
    v_mfma_f32_16x16x32_bf16 v[124:127], v[52:55], v[72:75], v[124:127]
    v_lshl_add_u32 v6, v5, 8, v6
    ds_read_b64 v[52:53], v12 offset:2688
    v_mfma_f32_16x16x32_bf16 v[112:115], v[48:51], v[64:67], v[112:115]
    ds_read_b64 v[54:55], v12 offset:2696
    v_and_b32 v5, 3, v2
    v_mfma_f32_16x16x32_bf16 v[116:119], v[48:51], v[68:71], v[116:119]
    v_lshl_add_u32 v10, v5, 3, v6
    v_mfma_f32_16x16x32_bf16 v[120:123], v[48:51], v[72:75], v[120:123]
    s_lshl_b32 s16, s11, 13
    s_waitcnt lgkmcnt(12)
    v_mfma_f32_16x16x32_bf16 v[124:127], v[48:51], v[76:79], v[124:127]
    v_add_u32 v6, s16, v10
    ds_read_b64 v[48:49], v12 offset:2176
    v_mfma_f32_16x16x32_bf16 v[108:111], v[44:47], v[64:67], v[108:111]
    ds_read_b64 v[50:51], v12 offset:2184
    s_lshl_b32 s16, s8, 7
    v_mfma_f32_16x16x32_bf16 v[112:115], v[44:47], v[68:71], v[112:115]
    v_xor_b32 v6, s16, v6
    v_mfma_f32_16x16x32_bf16 v[116:119], v[44:47], v[72:75], v[116:119]
    v_xor_b32 v23, 0, v6
    v_mfma_f32_16x16x32_bf16 v[120:123], v[44:47], v[76:79], v[120:123]
    v_xor_b32 v24, 32, v6
    s_waitcnt lgkmcnt(13)
    v_mfma_f32_16x16x32_bf16 v[124:127], v[44:47], v[80:83], v[124:127]
    v_xor_b32 v25, 64, v6
    ds_read_b64 v[44:45], v12 offset:1664
    v_mfma_f32_16x16x32_bf16 v[104:107], v[40:43], v[64:67], v[104:107]
    ds_read_b64 v[46:47], v12 offset:1672
    v_xor_b32 v26, 96, v6
    v_mfma_f32_16x16x32_bf16 v[108:111], v[40:43], v[68:71], v[108:111]
    v_xor_b32 v27, 128, v6
    v_mfma_f32_16x16x32_bf16 v[112:115], v[40:43], v[72:75], v[112:115]
    v_xor_b32 v28, 160, v6
    v_mfma_f32_16x16x32_bf16 v[116:119], v[40:43], v[76:79], v[116:119]
    v_xor_b32 v29, 192, v6
    v_mfma_f32_16x16x32_bf16 v[120:123], v[40:43], v[80:83], v[120:123]
    v_xor_b32 v30, 224, v6
    s_waitcnt lgkmcnt(14)
    v_mfma_f32_16x16x32_bf16 v[124:127], v[40:43], v[84:87], v[124:127]
    ds_read_b64 v[40:41], v12 offset:1152
    v_mfma_f32_16x16x32_bf16 v[100:103], v[36:39], v[64:67], v[100:103]
    ds_read_b64 v[42:43], v12 offset:1160
    v_mfma_f32_16x16x32_bf16 v[104:107], v[36:39], v[68:71], v[104:107]
    v_mfma_f32_16x16x32_bf16 v[108:111], v[36:39], v[72:75], v[108:111]
    v_mfma_f32_16x16x32_bf16 v[112:115], v[36:39], v[76:79], v[112:115]
    v_mfma_f32_16x16x32_bf16 v[116:119], v[36:39], v[80:83], v[116:119]
    v_mfma_f32_16x16x32_bf16 v[120:123], v[36:39], v[84:87], v[120:123]
    s_waitcnt lgkmcnt(15)
    v_mfma_f32_16x16x32_bf16 v[124:127], v[36:39], v[88:91], v[124:127]
    ds_read_b64 v[36:37], v12 offset:640
    s_waitcnt lgkmcnt(13)
    v_mfma_f32_16x16x32_bf16 v[96:99], v[32:35], v[64:67], v[96:99]
    ds_read_b64 v[38:39], v12 offset:648
    ds_read_b128 v[64:67], v13 offset:3712
    v_mfma_f32_16x16x32_bf16 v[100:103], v[32:35], v[68:71], v[100:103]
    ds_read_b128 v[68:71], v13 offset:3200
    v_mfma_f32_16x16x32_bf16 v[104:107], v[32:35], v[72:75], v[104:107]
    ds_read_b128 v[72:75], v13 offset:2688
    v_mfma_f32_16x16x32_bf16 v[108:111], v[32:35], v[76:79], v[108:111]
    ds_read_b128 v[76:79], v13 offset:2176
    v_mfma_f32_16x16x32_bf16 v[112:115], v[32:35], v[80:83], v[112:115]
    ds_read_b128 v[80:83], v13 offset:1664
    v_mfma_f32_16x16x32_bf16 v[116:119], v[32:35], v[84:87], v[116:119]
    ds_read_b128 v[84:87], v13 offset:1152
    v_mfma_f32_16x16x32_bf16 v[120:123], v[32:35], v[88:91], v[120:123]
    ds_read_b128 v[88:91], v13 offset:640
    v_mfma_f32_16x16x32_bf16 v[124:127], v[32:35], v[92:95], v[124:127]
    ds_read_b128 v[92:95], v13 offset:128
    ds_read_b64 v[32:33], v12 offset:128
    s_waitcnt lgkmcnt(8)
    v_mfma_f32_16x16x32_bf16 v[124:127], v[60:63], v[64:67], v[124:127]
    ds_read_b64 v[34:35], v12 offset:136
    s_waitcnt vmcnt(0)
    s_barrier
    ds_read_b64 v[60:61], v12 offset:3776
    v_mfma_f32_16x16x32_bf16 v[120:123], v[56:59], v[64:67], v[120:123]
    ds_read_b64 v[62:63], v12 offset:3784
    s_waitcnt lgkmcnt(10)
    v_mfma_f32_16x16x32_bf16 v[124:127], v[56:59], v[68:71], v[124:127]
    ds_read_b64 v[56:57], v12 offset:3264
    v_mfma_f32_16x16x32_bf16 v[116:119], v[52:55], v[64:67], v[116:119]
    ds_read_b64 v[58:59], v12 offset:3272
    v_mfma_f32_16x16x32_bf16 v[120:123], v[52:55], v[68:71], v[120:123]
    s_waitcnt lgkmcnt(11)
    v_mfma_f32_16x16x32_bf16 v[124:127], v[52:55], v[72:75], v[124:127]
    ds_read_b64 v[52:53], v12 offset:2752
    v_mfma_f32_16x16x32_bf16 v[112:115], v[48:51], v[64:67], v[112:115]
    ds_read_b64 v[54:55], v12 offset:2760
    v_mfma_f32_16x16x32_bf16 v[116:119], v[48:51], v[68:71], v[116:119]
    v_mfma_f32_16x16x32_bf16 v[120:123], v[48:51], v[72:75], v[120:123]
    s_waitcnt lgkmcnt(12)
    v_mfma_f32_16x16x32_bf16 v[124:127], v[48:51], v[76:79], v[124:127]
    ds_read_b64 v[48:49], v12 offset:2240
    v_mfma_f32_16x16x32_bf16 v[108:111], v[44:47], v[64:67], v[108:111]
    ds_read_b64 v[50:51], v12 offset:2248
    v_mfma_f32_16x16x32_bf16 v[112:115], v[44:47], v[68:71], v[112:115]
    v_mfma_f32_16x16x32_bf16 v[116:119], v[44:47], v[72:75], v[116:119]
    v_mfma_f32_16x16x32_bf16 v[120:123], v[44:47], v[76:79], v[120:123]
    s_waitcnt lgkmcnt(13)
    v_mfma_f32_16x16x32_bf16 v[124:127], v[44:47], v[80:83], v[124:127]
    ds_read_b64 v[44:45], v12 offset:1728
    v_mfma_f32_16x16x32_bf16 v[104:107], v[40:43], v[64:67], v[104:107]
    ds_read_b64 v[46:47], v12 offset:1736
    v_mfma_f32_16x16x32_bf16 v[108:111], v[40:43], v[68:71], v[108:111]
    v_mfma_f32_16x16x32_bf16 v[112:115], v[40:43], v[72:75], v[112:115]
    v_mfma_f32_16x16x32_bf16 v[116:119], v[40:43], v[76:79], v[116:119]
    v_mfma_f32_16x16x32_bf16 v[120:123], v[40:43], v[80:83], v[120:123]
    s_waitcnt lgkmcnt(14)
    v_mfma_f32_16x16x32_bf16 v[124:127], v[40:43], v[84:87], v[124:127]
    ds_read_b64 v[40:41], v12 offset:1216
    v_mfma_f32_16x16x32_bf16 v[100:103], v[36:39], v[64:67], v[100:103]
    ds_read_b64 v[42:43], v12 offset:1224
    v_mfma_f32_16x16x32_bf16 v[104:107], v[36:39], v[68:71], v[104:107]
    v_mfma_f32_16x16x32_bf16 v[108:111], v[36:39], v[72:75], v[108:111]
    v_mfma_f32_16x16x32_bf16 v[112:115], v[36:39], v[76:79], v[112:115]
    v_mfma_f32_16x16x32_bf16 v[116:119], v[36:39], v[80:83], v[116:119]
    v_mfma_f32_16x16x32_bf16 v[120:123], v[36:39], v[84:87], v[120:123]
    s_waitcnt lgkmcnt(15)
    v_mfma_f32_16x16x32_bf16 v[124:127], v[36:39], v[88:91], v[124:127]
    ds_read_b64 v[36:37], v12 offset:704
    s_waitcnt lgkmcnt(13)
    v_mfma_f32_16x16x32_bf16 v[96:99], v[32:35], v[64:67], v[96:99]
    ds_read_b64 v[38:39], v12 offset:712
    ds_read_b128 v[64:67], v13 offset:3776
    v_mfma_f32_16x16x32_bf16 v[100:103], v[32:35], v[68:71], v[100:103]
    ds_read_b128 v[68:71], v13 offset:3264
    v_mfma_f32_16x16x32_bf16 v[104:107], v[32:35], v[72:75], v[104:107]
    ds_read_b128 v[72:75], v13 offset:2752
    v_mfma_f32_16x16x32_bf16 v[108:111], v[32:35], v[76:79], v[108:111]
    ds_read_b128 v[76:79], v13 offset:2240
    v_mfma_f32_16x16x32_bf16 v[112:115], v[32:35], v[80:83], v[112:115]
    ds_read_b128 v[80:83], v13 offset:1728
    v_mfma_f32_16x16x32_bf16 v[116:119], v[32:35], v[84:87], v[116:119]
    ds_read_b128 v[84:87], v13 offset:1216
    v_mfma_f32_16x16x32_bf16 v[120:123], v[32:35], v[88:91], v[120:123]
    ds_read_b128 v[88:91], v13 offset:704
    v_mfma_f32_16x16x32_bf16 v[124:127], v[32:35], v[92:95], v[124:127]
    ds_read_b128 v[92:95], v13 offset:192
    ds_read_b64 v[32:33], v12 offset:192
    s_waitcnt lgkmcnt(8)
    v_mfma_f32_16x16x32_bf16 v[124:127], v[60:63], v[64:67], v[124:127]
    ds_read_b64 v[34:35], v12 offset:200
    ds_read_b64 v[60:61], v12 offset:3840
    v_mfma_f32_16x16x32_bf16 v[120:123], v[56:59], v[64:67], v[120:123]
    ds_read_b64 v[62:63], v12 offset:3848
    s_waitcnt lgkmcnt(10)
    v_mfma_f32_16x16x32_bf16 v[124:127], v[56:59], v[68:71], v[124:127]
    ds_read_b64 v[56:57], v12 offset:3328
    v_mfma_f32_16x16x32_bf16 v[116:119], v[52:55], v[64:67], v[116:119]
    ds_read_b64 v[58:59], v12 offset:3336
    v_mfma_f32_16x16x32_bf16 v[120:123], v[52:55], v[68:71], v[120:123]
    s_waitcnt lgkmcnt(11)
    v_mfma_f32_16x16x32_bf16 v[124:127], v[52:55], v[72:75], v[124:127]
    ds_read_b64 v[52:53], v12 offset:2816
    v_mfma_f32_16x16x32_bf16 v[112:115], v[48:51], v[64:67], v[112:115]
    ds_read_b64 v[54:55], v12 offset:2824
    v_mfma_f32_16x16x32_bf16 v[116:119], v[48:51], v[68:71], v[116:119]
    v_mfma_f32_16x16x32_bf16 v[120:123], v[48:51], v[72:75], v[120:123]
    s_waitcnt lgkmcnt(12)
    v_mfma_f32_16x16x32_bf16 v[124:127], v[48:51], v[76:79], v[124:127]
    ds_read_b64 v[48:49], v12 offset:2304
    v_mfma_f32_16x16x32_bf16 v[108:111], v[44:47], v[64:67], v[108:111]
    ds_read_b64 v[50:51], v12 offset:2312
    v_mfma_f32_16x16x32_bf16 v[112:115], v[44:47], v[68:71], v[112:115]
    v_mfma_f32_16x16x32_bf16 v[116:119], v[44:47], v[72:75], v[116:119]
    v_mfma_f32_16x16x32_bf16 v[120:123], v[44:47], v[76:79], v[120:123]
    s_waitcnt lgkmcnt(13)
    v_mfma_f32_16x16x32_bf16 v[124:127], v[44:47], v[80:83], v[124:127]
    ds_read_b64 v[44:45], v12 offset:1792
    v_mfma_f32_16x16x32_bf16 v[104:107], v[40:43], v[64:67], v[104:107]
    ds_read_b64 v[46:47], v12 offset:1800
    v_mfma_f32_16x16x32_bf16 v[108:111], v[40:43], v[68:71], v[108:111]
    v_mfma_f32_16x16x32_bf16 v[112:115], v[40:43], v[72:75], v[112:115]
    v_mfma_f32_16x16x32_bf16 v[116:119], v[40:43], v[76:79], v[116:119]
    v_mfma_f32_16x16x32_bf16 v[120:123], v[40:43], v[80:83], v[120:123]
    s_waitcnt lgkmcnt(14)
    v_mfma_f32_16x16x32_bf16 v[124:127], v[40:43], v[84:87], v[124:127]
    ds_read_b64 v[40:41], v12 offset:1280
    v_mfma_f32_16x16x32_bf16 v[100:103], v[36:39], v[64:67], v[100:103]
    ds_read_b64 v[42:43], v12 offset:1288
    v_mfma_f32_16x16x32_bf16 v[104:107], v[36:39], v[68:71], v[104:107]
    v_mfma_f32_16x16x32_bf16 v[108:111], v[36:39], v[72:75], v[108:111]
    v_mfma_f32_16x16x32_bf16 v[112:115], v[36:39], v[76:79], v[112:115]
    v_mfma_f32_16x16x32_bf16 v[116:119], v[36:39], v[80:83], v[116:119]
    v_mfma_f32_16x16x32_bf16 v[120:123], v[36:39], v[84:87], v[120:123]
    s_waitcnt lgkmcnt(15)
    v_mfma_f32_16x16x32_bf16 v[124:127], v[36:39], v[88:91], v[124:127]
    ds_read_b64 v[36:37], v12 offset:768
    s_waitcnt lgkmcnt(13)
    v_mfma_f32_16x16x32_bf16 v[96:99], v[32:35], v[64:67], v[96:99]
    ds_read_b64 v[38:39], v12 offset:776
    ds_read_b128 v[64:67], v13 offset:3840
    v_mfma_f32_16x16x32_bf16 v[100:103], v[32:35], v[68:71], v[100:103]
    ds_read_b128 v[68:71], v13 offset:3328
    v_mfma_f32_16x16x32_bf16 v[104:107], v[32:35], v[72:75], v[104:107]
    ds_read_b128 v[72:75], v13 offset:2816
    v_mfma_f32_16x16x32_bf16 v[108:111], v[32:35], v[76:79], v[108:111]
    ds_read_b128 v[76:79], v13 offset:2304
    v_mfma_f32_16x16x32_bf16 v[112:115], v[32:35], v[80:83], v[112:115]
    ds_read_b128 v[80:83], v13 offset:1792
    v_mfma_f32_16x16x32_bf16 v[116:119], v[32:35], v[84:87], v[116:119]
    ds_read_b128 v[84:87], v13 offset:1280
    v_mfma_f32_16x16x32_bf16 v[120:123], v[32:35], v[88:91], v[120:123]
    ds_read_b128 v[88:91], v13 offset:768
    v_mfma_f32_16x16x32_bf16 v[124:127], v[32:35], v[92:95], v[124:127]
    ds_read_b128 v[92:95], v13 offset:256
    ds_read_b64 v[32:33], v12 offset:256
    s_waitcnt lgkmcnt(8)
    v_mfma_f32_16x16x32_bf16 v[124:127], v[60:63], v[64:67], v[124:127]
    ds_read_b64 v[34:35], v12 offset:264
    ds_read_b64 v[60:61], v12 offset:3904
    v_mfma_f32_16x16x32_bf16 v[120:123], v[56:59], v[64:67], v[120:123]
    ds_read_b64 v[62:63], v12 offset:3912
    s_waitcnt lgkmcnt(10)
    v_mfma_f32_16x16x32_bf16 v[124:127], v[56:59], v[68:71], v[124:127]
    ds_read_b64 v[56:57], v12 offset:3392
    v_mfma_f32_16x16x32_bf16 v[116:119], v[52:55], v[64:67], v[116:119]
    ds_read_b64 v[58:59], v12 offset:3400
    v_mfma_f32_16x16x32_bf16 v[120:123], v[52:55], v[68:71], v[120:123]
    s_waitcnt lgkmcnt(11)
    v_mfma_f32_16x16x32_bf16 v[124:127], v[52:55], v[72:75], v[124:127]
    ds_read_b64 v[52:53], v12 offset:2880
    v_mfma_f32_16x16x32_bf16 v[112:115], v[48:51], v[64:67], v[112:115]
    ds_read_b64 v[54:55], v12 offset:2888
    v_mfma_f32_16x16x32_bf16 v[116:119], v[48:51], v[68:71], v[116:119]
    v_mfma_f32_16x16x32_bf16 v[120:123], v[48:51], v[72:75], v[120:123]
    s_waitcnt lgkmcnt(12)
    v_mfma_f32_16x16x32_bf16 v[124:127], v[48:51], v[76:79], v[124:127]
    ds_read_b64 v[48:49], v12 offset:2368
    v_mfma_f32_16x16x32_bf16 v[108:111], v[44:47], v[64:67], v[108:111]
    ds_read_b64 v[50:51], v12 offset:2376
    v_mfma_f32_16x16x32_bf16 v[112:115], v[44:47], v[68:71], v[112:115]
    v_mfma_f32_16x16x32_bf16 v[116:119], v[44:47], v[72:75], v[116:119]
    v_mfma_f32_16x16x32_bf16 v[120:123], v[44:47], v[76:79], v[120:123]
    s_waitcnt lgkmcnt(13)
    v_mfma_f32_16x16x32_bf16 v[124:127], v[44:47], v[80:83], v[124:127]
    ds_read_b64 v[44:45], v12 offset:1856
    v_mfma_f32_16x16x32_bf16 v[104:107], v[40:43], v[64:67], v[104:107]
    ds_read_b64 v[46:47], v12 offset:1864
    v_mfma_f32_16x16x32_bf16 v[108:111], v[40:43], v[68:71], v[108:111]
    v_mfma_f32_16x16x32_bf16 v[112:115], v[40:43], v[72:75], v[112:115]
    v_mfma_f32_16x16x32_bf16 v[116:119], v[40:43], v[76:79], v[116:119]
    v_mfma_f32_16x16x32_bf16 v[120:123], v[40:43], v[80:83], v[120:123]
    s_waitcnt lgkmcnt(14)
    v_mfma_f32_16x16x32_bf16 v[124:127], v[40:43], v[84:87], v[124:127]
    ds_read_b64 v[40:41], v12 offset:1344
    v_mfma_f32_16x16x32_bf16 v[100:103], v[36:39], v[64:67], v[100:103]
    ds_read_b64 v[42:43], v12 offset:1352
    v_mfma_f32_16x16x32_bf16 v[104:107], v[36:39], v[68:71], v[104:107]
    v_mfma_f32_16x16x32_bf16 v[108:111], v[36:39], v[72:75], v[108:111]
    v_mfma_f32_16x16x32_bf16 v[112:115], v[36:39], v[76:79], v[112:115]
    v_mfma_f32_16x16x32_bf16 v[116:119], v[36:39], v[80:83], v[116:119]
    v_mfma_f32_16x16x32_bf16 v[120:123], v[36:39], v[84:87], v[120:123]
    s_waitcnt lgkmcnt(15)
    v_mfma_f32_16x16x32_bf16 v[124:127], v[36:39], v[88:91], v[124:127]
    ds_read_b64 v[36:37], v12 offset:832
    s_waitcnt lgkmcnt(13)
    v_mfma_f32_16x16x32_bf16 v[96:99], v[32:35], v[64:67], v[96:99]
    ds_read_b64 v[38:39], v12 offset:840
    ds_read_b128 v[64:67], v13 offset:3904
    v_mfma_f32_16x16x32_bf16 v[100:103], v[32:35], v[68:71], v[100:103]
    ds_read_b128 v[68:71], v13 offset:3392
    v_mfma_f32_16x16x32_bf16 v[104:107], v[32:35], v[72:75], v[104:107]
    ds_read_b128 v[72:75], v13 offset:2880
    v_mfma_f32_16x16x32_bf16 v[108:111], v[32:35], v[76:79], v[108:111]
    ds_read_b128 v[76:79], v13 offset:2368
    v_mfma_f32_16x16x32_bf16 v[112:115], v[32:35], v[80:83], v[112:115]
    ds_read_b128 v[80:83], v13 offset:1856
    v_mfma_f32_16x16x32_bf16 v[116:119], v[32:35], v[84:87], v[116:119]
    ds_read_b128 v[84:87], v13 offset:1344
    v_mfma_f32_16x16x32_bf16 v[120:123], v[32:35], v[88:91], v[120:123]
    ds_read_b128 v[88:91], v13 offset:832
    v_mfma_f32_16x16x32_bf16 v[124:127], v[32:35], v[92:95], v[124:127]
    ds_read_b128 v[92:95], v13 offset:320
    ds_read_b64 v[32:33], v12 offset:320
    s_waitcnt lgkmcnt(8)
    v_mfma_f32_16x16x32_bf16 v[124:127], v[60:63], v[64:67], v[124:127]
    ds_read_b64 v[34:35], v12 offset:328
    ds_read_b64 v[60:61], v12 offset:3968
    v_mfma_f32_16x16x32_bf16 v[120:123], v[56:59], v[64:67], v[120:123]
    ds_read_b64 v[62:63], v12 offset:3976
    s_waitcnt lgkmcnt(10)
    v_mfma_f32_16x16x32_bf16 v[124:127], v[56:59], v[68:71], v[124:127]
    ds_read_b64 v[56:57], v12 offset:3456
    v_mfma_f32_16x16x32_bf16 v[116:119], v[52:55], v[64:67], v[116:119]
    ds_read_b64 v[58:59], v12 offset:3464
    v_mfma_f32_16x16x32_bf16 v[120:123], v[52:55], v[68:71], v[120:123]
    s_waitcnt lgkmcnt(11)
    v_mfma_f32_16x16x32_bf16 v[124:127], v[52:55], v[72:75], v[124:127]
    ds_read_b64 v[52:53], v12 offset:2944
    v_mfma_f32_16x16x32_bf16 v[112:115], v[48:51], v[64:67], v[112:115]
    ds_read_b64 v[54:55], v12 offset:2952
    v_mfma_f32_16x16x32_bf16 v[116:119], v[48:51], v[68:71], v[116:119]
    v_mfma_f32_16x16x32_bf16 v[120:123], v[48:51], v[72:75], v[120:123]
    s_waitcnt lgkmcnt(12)
    v_mfma_f32_16x16x32_bf16 v[124:127], v[48:51], v[76:79], v[124:127]
    ds_read_b64 v[48:49], v12 offset:2432
    v_mfma_f32_16x16x32_bf16 v[108:111], v[44:47], v[64:67], v[108:111]
    ds_read_b64 v[50:51], v12 offset:2440
    v_mfma_f32_16x16x32_bf16 v[112:115], v[44:47], v[68:71], v[112:115]
    v_mfma_f32_16x16x32_bf16 v[116:119], v[44:47], v[72:75], v[116:119]
    v_mfma_f32_16x16x32_bf16 v[120:123], v[44:47], v[76:79], v[120:123]
    s_waitcnt lgkmcnt(13)
    v_mfma_f32_16x16x32_bf16 v[124:127], v[44:47], v[80:83], v[124:127]
    ds_read_b64 v[44:45], v12 offset:1920
    v_mfma_f32_16x16x32_bf16 v[104:107], v[40:43], v[64:67], v[104:107]
    ds_read_b64 v[46:47], v12 offset:1928
    v_mfma_f32_16x16x32_bf16 v[108:111], v[40:43], v[68:71], v[108:111]
    v_mfma_f32_16x16x32_bf16 v[112:115], v[40:43], v[72:75], v[112:115]
    v_mfma_f32_16x16x32_bf16 v[116:119], v[40:43], v[76:79], v[116:119]
    v_mfma_f32_16x16x32_bf16 v[120:123], v[40:43], v[80:83], v[120:123]
    s_waitcnt lgkmcnt(14)
    v_mfma_f32_16x16x32_bf16 v[124:127], v[40:43], v[84:87], v[124:127]
    ds_read_b64 v[40:41], v12 offset:1408
    v_mfma_f32_16x16x32_bf16 v[100:103], v[36:39], v[64:67], v[100:103]
    ds_read_b64 v[42:43], v12 offset:1416
    v_mfma_f32_16x16x32_bf16 v[104:107], v[36:39], v[68:71], v[104:107]
    v_mfma_f32_16x16x32_bf16 v[108:111], v[36:39], v[72:75], v[108:111]
    v_mfma_f32_16x16x32_bf16 v[112:115], v[36:39], v[76:79], v[112:115]
    v_mfma_f32_16x16x32_bf16 v[116:119], v[36:39], v[80:83], v[116:119]
    v_mfma_f32_16x16x32_bf16 v[120:123], v[36:39], v[84:87], v[120:123]
    s_waitcnt lgkmcnt(15)
    v_mfma_f32_16x16x32_bf16 v[124:127], v[36:39], v[88:91], v[124:127]
    ds_read_b64 v[36:37], v12 offset:896
    s_waitcnt lgkmcnt(13)
    v_mfma_f32_16x16x32_bf16 v[96:99], v[32:35], v[64:67], v[96:99]
    ds_read_b64 v[38:39], v12 offset:904
    ds_read_b128 v[64:67], v13 offset:3968
    v_mfma_f32_16x16x32_bf16 v[100:103], v[32:35], v[68:71], v[100:103]
    ds_read_b128 v[68:71], v13 offset:3456
    v_mfma_f32_16x16x32_bf16 v[104:107], v[32:35], v[72:75], v[104:107]
    ds_read_b128 v[72:75], v13 offset:2944
    v_mfma_f32_16x16x32_bf16 v[108:111], v[32:35], v[76:79], v[108:111]
    ds_read_b128 v[76:79], v13 offset:2432
    v_mfma_f32_16x16x32_bf16 v[112:115], v[32:35], v[80:83], v[112:115]
    ds_read_b128 v[80:83], v13 offset:1920
    v_mfma_f32_16x16x32_bf16 v[116:119], v[32:35], v[84:87], v[116:119]
    ds_read_b128 v[84:87], v13 offset:1408
    v_mfma_f32_16x16x32_bf16 v[120:123], v[32:35], v[88:91], v[120:123]
    ds_read_b128 v[88:91], v13 offset:896
    v_mfma_f32_16x16x32_bf16 v[124:127], v[32:35], v[92:95], v[124:127]
    ds_read_b128 v[92:95], v13 offset:384
    ds_read_b64 v[32:33], v12 offset:384
    s_waitcnt lgkmcnt(8)
    v_mfma_f32_16x16x32_bf16 v[124:127], v[60:63], v[64:67], v[124:127]
    ds_read_b64 v[34:35], v12 offset:392
    s_barrier
    v_lshlrev_b32 v9, 5, v4
    ds_read_b64 v[60:61], v12 offset:4032
    v_mfma_f32_16x16x32_bf16 v[120:123], v[56:59], v[64:67], v[120:123]
    ds_read_b64 v[62:63], v12 offset:4040
    v_lshrrev_b32 v11, 1, v3
    s_waitcnt lgkmcnt(10)
    v_mfma_f32_16x16x32_bf16 v[124:127], v[56:59], v[68:71], v[124:127]
    v_lshl_add_u32 v9, v11, 4, v9
    ds_read_b64 v[56:57], v12 offset:3520
    v_mfma_f32_16x16x32_bf16 v[116:119], v[52:55], v[64:67], v[116:119]
    ds_read_b64 v[58:59], v12 offset:3528
    s_add_u32 s67, s14, 0
    buffer_load_dwordx4 v[160:163], v21, s[32:35], s67 offen sc1
    buffer_load_dwordx4 v[164:167], v22, s[32:35], s67 offen sc1
    v_and_b32 v11, 1, v3
    v_mfma_f32_16x16x32_bf16 v[120:123], v[52:55], v[68:71], v[120:123]
    v_lshl_add_u32 v9, v11, 9, v9
    s_waitcnt lgkmcnt(11)
    v_mfma_f32_16x16x32_bf16 v[124:127], v[52:55], v[72:75], v[124:127]
    s_add_u32 s68, s73, 5242880
    ds_read_b64 v[52:53], v12 offset:3008
    v_mfma_f32_16x16x32_bf16 v[112:115], v[48:51], v[64:67], v[112:115]
    ds_read_b64 v[54:55], v12 offset:3016
    v_mfma_f32_16x16x32_bf16 v[116:119], v[48:51], v[68:71], v[116:119]
    s_add_u32 s67, s14, 262144
    buffer_load_dwordx4 v[168:171], v21, s[32:35], s67 offen sc1
    buffer_load_dwordx4 v[172:175], v22, s[32:35], s67 offen sc1
    v_mfma_f32_16x16x32_bf16 v[120:123], v[48:51], v[72:75], v[120:123]
    s_waitcnt lgkmcnt(12)
    v_mfma_f32_16x16x32_bf16 v[124:127], v[48:51], v[76:79], v[124:127]
    ds_read_b64 v[48:49], v12 offset:2496
    v_mfma_f32_16x16x32_bf16 v[108:111], v[44:47], v[64:67], v[108:111]
    ds_read_b64 v[50:51], v12 offset:2504
    v_mfma_f32_16x16x32_bf16 v[112:115], v[44:47], v[68:71], v[112:115]
    s_add_u32 s67, s14, 524288
    buffer_load_dwordx4 v[176:179], v21, s[32:35], s67 offen sc1
    buffer_load_dwordx4 v[180:183], v22, s[32:35], s67 offen sc1
    v_mfma_f32_16x16x32_bf16 v[116:119], v[44:47], v[72:75], v[116:119]
    v_mfma_f32_16x16x32_bf16 v[120:123], v[44:47], v[76:79], v[120:123]
    s_waitcnt lgkmcnt(13)
    v_mfma_f32_16x16x32_bf16 v[124:127], v[44:47], v[80:83], v[124:127]
    ds_read_b64 v[44:45], v12 offset:1984
    v_mfma_f32_16x16x32_bf16 v[104:107], v[40:43], v[64:67], v[104:107]
    ds_read_b64 v[46:47], v12 offset:1992
    s_add_u32 s67, s14, 786432
    buffer_load_dwordx4 v[184:187], v21, s[32:35], s67 offen sc1
    buffer_load_dwordx4 v[188:191], v22, s[32:35], s67 offen sc1
    v_mfma_f32_16x16x32_bf16 v[108:111], v[40:43], v[68:71], v[108:111]
    v_mfma_f32_16x16x32_bf16 v[112:115], v[40:43], v[72:75], v[112:115]
    v_mfma_f32_16x16x32_bf16 v[116:119], v[40:43], v[76:79], v[116:119]
    v_mfma_f32_16x16x32_bf16 v[120:123], v[40:43], v[80:83], v[120:123]
    s_waitcnt lgkmcnt(14)
    v_mfma_f32_16x16x32_bf16 v[124:127], v[40:43], v[84:87], v[124:127]
    ds_read_b64 v[40:41], v12 offset:1472
    v_mfma_f32_16x16x32_bf16 v[100:103], v[36:39], v[64:67], v[100:103]
    ds_read_b64 v[42:43], v12 offset:1480
    v_mfma_f32_16x16x32_bf16 v[104:107], v[36:39], v[68:71], v[104:107]
    v_mfma_f32_16x16x32_bf16 v[108:111], v[36:39], v[72:75], v[108:111]
    v_mfma_f32_16x16x32_bf16 v[112:115], v[36:39], v[76:79], v[112:115]
    v_mfma_f32_16x16x32_bf16 v[116:119], v[36:39], v[80:83], v[116:119]
    v_mfma_f32_16x16x32_bf16 v[120:123], v[36:39], v[84:87], v[120:123]
    s_waitcnt lgkmcnt(15)
    v_mfma_f32_16x16x32_bf16 v[124:127], v[36:39], v[88:91], v[124:127]
    ds_read_b64 v[36:37], v12 offset:960
    s_waitcnt lgkmcnt(13)
    v_mfma_f32_16x16x32_bf16 v[96:99], v[32:35], v[64:67], v[96:99]
    ds_read_b64 v[38:39], v12 offset:968
    ds_read_b128 v[64:67], v13 offset:4032
    v_mfma_f32_16x16x32_bf16 v[100:103], v[32:35], v[68:71], v[100:103]
    ds_read_b128 v[68:71], v13 offset:3520
    v_mfma_f32_16x16x32_bf16 v[104:107], v[32:35], v[72:75], v[104:107]
    ds_read_b128 v[72:75], v13 offset:3008
    v_mfma_f32_16x16x32_bf16 v[108:111], v[32:35], v[76:79], v[108:111]
    ds_read_b128 v[76:79], v13 offset:2496
    v_mfma_f32_16x16x32_bf16 v[112:115], v[32:35], v[80:83], v[112:115]
    ds_read_b128 v[80:83], v13 offset:1984
    v_mfma_f32_16x16x32_bf16 v[116:119], v[32:35], v[84:87], v[116:119]
    ds_read_b128 v[84:87], v13 offset:1472
    v_mfma_f32_16x16x32_bf16 v[120:123], v[32:35], v[88:91], v[120:123]
    ds_read_b128 v[88:91], v13 offset:960
    v_mfma_f32_16x16x32_bf16 v[124:127], v[32:35], v[92:95], v[124:127]
    ds_read_b128 v[92:95], v13 offset:448
    ds_read_b64 v[32:33], v12 offset:448
    s_waitcnt lgkmcnt(8)
    v_mfma_f32_16x16x32_bf16 v[124:127], v[60:63], v[64:67], v[124:127]
    ds_read_b64 v[34:35], v12 offset:456
    v_mfma_f32_16x16x32_bf16 v[120:123], v[56:59], v[64:67], v[120:123]
    s_waitcnt lgkmcnt(8)
    v_mfma_f32_16x16x32_bf16 v[124:127], v[56:59], v[68:71], v[124:127]
    v_mfma_f32_16x16x32_bf16 v[116:119], v[52:55], v[64:67], v[116:119]
    v_mfma_f32_16x16x32_bf16 v[120:123], v[52:55], v[68:71], v[120:123]
    s_waitcnt lgkmcnt(7)
    v_mfma_f32_16x16x32_bf16 v[124:127], v[52:55], v[72:75], v[124:127]
    v_mfma_f32_16x16x32_bf16 v[112:115], v[48:51], v[64:67], v[112:115]
    v_mfma_f32_16x16x32_bf16 v[116:119], v[48:51], v[68:71], v[116:119]
    ds_read_b64_tr_b16 v[128:129], v23 offset:32768
    v_mfma_f32_16x16x32_bf16 v[120:123], v[48:51], v[72:75], v[120:123]
    ds_read_b64_tr_b16 v[130:131], v23 offset:36864
    s_waitcnt lgkmcnt(8)
    v_mfma_f32_16x16x32_bf16 v[124:127], v[48:51], v[76:79], v[124:127]
    ds_read_b64_tr_b16 v[132:133], v24 offset:32768
    v_mfma_f32_16x16x32_bf16 v[108:111], v[44:47], v[64:67], v[108:111]
    ds_read_b64_tr_b16 v[134:135], v24 offset:36864
    v_mfma_f32_16x16x32_bf16 v[112:115], v[44:47], v[68:71], v[112:115]
    ds_read_b64_tr_b16 v[136:137], v25 offset:32768
    v_mfma_f32_16x16x32_bf16 v[116:119], v[44:47], v[72:75], v[116:119]
    ds_read_b64_tr_b16 v[138:139], v25 offset:36864
    v_mfma_f32_16x16x32_bf16 v[120:123], v[44:47], v[76:79], v[120:123]
    ds_read_b64_tr_b16 v[140:141], v26 offset:32768
    s_waitcnt lgkmcnt(12)
    v_mfma_f32_16x16x32_bf16 v[124:127], v[44:47], v[80:83], v[124:127]
    ds_read_b64_tr_b16 v[142:143], v26 offset:36864
    v_mfma_f32_16x16x32_bf16 v[104:107], v[40:43], v[64:67], v[104:107]
    ds_read_b64_tr_b16 v[144:145], v27 offset:32768
    v_mfma_f32_16x16x32_bf16 v[108:111], v[40:43], v[68:71], v[108:111]
    ds_read_b64_tr_b16 v[146:147], v27 offset:36864
    v_mfma_f32_16x16x32_bf16 v[112:115], v[40:43], v[72:75], v[112:115]
    ds_read_b64_tr_b16 v[148:149], v28 offset:32768
    v_mfma_f32_16x16x32_bf16 v[116:119], v[40:43], v[76:79], v[116:119]
    ds_read_b64_tr_b16 v[150:151], v28 offset:36864
    v_mfma_f32_16x16x32_bf16 v[120:123], v[40:43], v[80:83], v[120:123]
    ds_read_b64_tr_b16 v[152:153], v29 offset:32768
    s_waitcnt lgkmcnt(15)
    v_mfma_f32_16x16x32_bf16 v[124:127], v[40:43], v[84:87], v[124:127]
    ds_read_b64_tr_b16 v[154:155], v29 offset:36864
    v_mfma_f32_16x16x32_bf16 v[100:103], v[36:39], v[64:67], v[100:103]
    ds_read_b64_tr_b16 v[156:157], v30 offset:32768
    v_mfma_f32_16x16x32_bf16 v[104:107], v[36:39], v[68:71], v[104:107]
    ds_read_b64_tr_b16 v[158:159], v30 offset:36864
    v_mfma_f32_16x16x32_bf16 v[108:111], v[36:39], v[72:75], v[108:111]
    v_mfma_f32_16x16x32_bf16 v[112:115], v[36:39], v[76:79], v[112:115]
    v_mfma_f32_16x16x32_bf16 v[116:119], v[36:39], v[80:83], v[116:119]
    v_mfma_f32_16x16x32_bf16 v[120:123], v[36:39], v[84:87], v[120:123]
    v_mfma_f32_16x16x32_bf16 v[124:127], v[36:39], v[88:91], v[124:127]
    s_waitcnt lgkmcnt(15)
    v_mfma_f32_16x16x32_bf16 v[96:99], v[32:35], v[64:67], v[96:99]
    v_mfma_f32_16x16x32_bf16 v[100:103], v[32:35], v[68:71], v[100:103]
    v_mfma_f32_16x16x32_bf16 v[104:107], v[32:35], v[72:75], v[104:107]
    v_mfma_f32_16x16x32_bf16 v[108:111], v[32:35], v[76:79], v[108:111]
    v_mfma_f32_16x16x32_bf16 v[112:115], v[32:35], v[80:83], v[112:115]
    v_mfma_f32_16x16x32_bf16 v[116:119], v[32:35], v[84:87], v[116:119]
    v_mfma_f32_16x16x32_bf16 v[120:123], v[32:35], v[88:91], v[120:123]
    v_mfma_f32_16x16x32_bf16 v[124:127], v[32:35], v[92:95], v[124:127]
    s_nop 1
    v_cvt_pk_bf16_f32 v64, v96, v97
    v_cvt_pk_bf16_f32 v65, v98, v99
    v_cvt_pk_bf16_f32 v66, v100, v101
    v_cvt_pk_bf16_f32 v67, v102, v103
    v_cvt_pk_bf16_f32 v68, v104, v105
    v_cvt_pk_bf16_f32 v69, v106, v107
    v_cvt_pk_bf16_f32 v70, v108, v109
    v_cvt_pk_bf16_f32 v71, v110, v111
    v_permlane16_swap_b32 v64, v66
    v_permlane16_swap_b32 v65, v67
    buffer_store_dwordx4 v[64:67], v9, s[32:35], s68 offen offset:0 sc1
    v_cvt_pk_bf16_f32 v72, v112, v113
    v_cvt_pk_bf16_f32 v73, v114, v115
    v_cvt_pk_bf16_f32 v74, v116, v117
    v_cvt_pk_bf16_f32 v75, v118, v119
    v_permlane16_swap_b32 v68, v70
    v_permlane16_swap_b32 v69, v71
    buffer_store_dwordx4 v[68:71], v9, s[32:35], s68 offen offset:1024 sc1
    v_cvt_pk_bf16_f32 v76, v120, v121
    v_cvt_pk_bf16_f32 v77, v122, v123
    v_cvt_pk_bf16_f32 v78, v124, v125
    v_cvt_pk_bf16_f32 v79, v126, v127
    v_permlane16_swap_b32 v72, v74
    v_permlane16_swap_b32 v73, v75
    buffer_store_dwordx4 v[72:75], v9, s[32:35], s68 offen offset:2048 sc1
    s_nop 1
    v_permlane16_swap_b32 v76, v78
    v_permlane16_swap_b32 v77, v79
    buffer_store_dwordx4 v[76:79], v9, s[32:35], s68 offen offset:3072 sc1
    s_branch L_join
L_idle:
    s_and_b32 s8, s101, 1
    s_bfe_u32 s16, s101, 0x10001
    s_lshl_b32 s16, s16, 3
    s_bfe_u32 s17, s101, 0x30003
    s_add_u32 s9, s16, s17
    s_bfe_u32 s16, s101, 0x10002
    s_lshl_b32 s16, s16, 2
    s_lshr_b32 s17, s101, 6
    s_add_u32 s10, s16, s17
    s_lshr_b32 s11, s3, 2
    s_and_b32 s12, s3, 3
    s_lshl_b32 s16, s3, 2
    v_add_u32 v5, s16, v3
    v_and_b32 v6, 7, v5
    v_lshlrev_b32 v6, 1, v6
    v_xor_b32 v6, v6, v4
    v_lshlrev_b32 v5, 11, v5
    v_lshl_add_u32 v20, v6, 4, v5
    s_mul_i32 s13, s8, 3670016
    s_lshl_b32 s16, s10, 8
    s_add_u32 s13, s13, s16
    s_lshl_b32 s66, s3, 10
    s_mul_i32 s16, s8, 56
    s_add_u32 s16, s16, s11
    s_lshl_b32 s16, s16, 7
    s_lshl_b32 s17, s9, 3
    s_add_u32 s16, s16, s17
    s_lshl_b32 s17, s12, 1
    s_add_u32 s16, s16, s17
    s_lshl_b32 s16, s16, 10
    s_add_u32 s14, s16, 10485760
    s_lshl_b32 s16, s11, 10
    v_lshl_add_u32 v21, v2, 4, s16
    v_xor_b32 v22, 0x400, v21
    s_cmp_lt_u32 s2, 32
    s_cbranch_scc1 L_hs0
    s_sub_u32 s16, s2, 32
    s_lshl_b32 s16, s16, 2
    s_add_u32 s16, s16, s12
    s_mul_i32 s16, s16, 46
    v_min_u32 v5, 45, v2
    v_add_u32 v5, s16, v5
    v_min_u32 v5, 0x9fff, v5
    v_cmp_lt_u32 vcc, 0x4fff, v5
    v_lshlrev_b32 v5, 7, v5
    v_add_u32 v6, 1048576, v5
    v_cndmask_b32 v11, v5, v6, vcc
    s_mov_b32 s96, 1048576
    s_mov_b32 s97, 0x20000000
    s_branch L_hs1
L_hs0:
    s_lshl_b32 s16, s2, 2
    s_add_u32 s16, s16, s12
    s_and_b32 s17, s16, 1
    s_mul_i32 s17, s17, 3670016
    s_lshr_b32 s16, s16, 1
    s_lshl_b32 s16, s16, 14
    s_add_u32 s96, s16, s17
    s_add_u32 s97, s96, 8192
    v_lshlrev_b32 v11, 7, v2
L_hs1:
    buffer_load_dword v8, v11, s[52:55], s96 offen
    buffer_load_dword v9, v11, s[52:55], s97 offen
    s_mov_b32 s19, 0x76543210
    v_min_u32 v5, 13, v2
    s_mul_i32 s16, s8, 14
    v_add_u32 v5, s16, v5
    v_lshlrev_b32 v5, 3, v5
    s_lshr_b32 s16, s9, 1
    s_add_u32 s16, s16, 256
    v_add_u32 v5, s16, v5
    v_lshlrev_b32 v5, 7, v5
    s_mov_b32 s72, 32571392
    s_lshl_b32 s70, s100, 7
    s_add_u32 s70, s70, 32604160
    v_mov_b32 v6, 0
    s_waitcnt vmcnt(2)
    s_barrier
    v_subrev_u32 v13, 32768, v20
    s_cmp_eq_u32 s3, 4
    s_cselect_b32 s70, s70, 0x20000000
    v_mov_b32 v16, 1
    v_mov_b32 v17, 0
    buffer_store_dword v16, v17, s[32:35], s70 offen sc1
    s_add_u32 m0, s66, 32768
    s_add_u32 s67, s13, 0
    buffer_load_dwordx4 v20, s[52:55], s67 offen  lds
    s_add_u32 m0, s66, 28672
    s_add_u32 s67, s13, 0
    buffer_load_dwordx4 v13, s[52:55], s67 offen lds
    s_add_u32 m0, s66, 40960
    s_add_u32 s67, s13, 65536
    buffer_load_dwordx4 v20, s[52:55], s67 offen  lds
    s_add_u32 m0, s66, 36864
    s_add_u32 s67, s13, 65536
    buffer_load_dwordx4 v13, s[52:55], s67 offen lds
    s_add_u32 m0, s66, 49152
    s_add_u32 s67, s13, 131072
    buffer_load_dwordx4 v20, s[52:55], s67 offen  lds
    s_add_u32 m0, s66, 45056
    s_add_u32 s67, s13, 131072
    buffer_load_dwordx4 v13, s[52:55], s67 offen lds
    s_add_u32 m0, s66, 57344
    s_add_u32 s67, s13, 196608
    buffer_load_dwordx4 v20, s[52:55], s67 offen  lds
    s_add_u32 m0, s66, 53248
    s_add_u32 s67, s13, 196608
    buffer_load_dwordx4 v13, s[52:55], s67 offen lds
    s_add_u32 m0, s66, 65536
    s_add_u32 s67, s13, 262144
    buffer_load_dwordx4 v20, s[52:55], s67 offen  lds
    s_add_u32 m0, s66, 61440
    s_add_u32 s67, s13, 262144
    buffer_load_dwordx4 v13, s[52:55], s67 offen lds
    s_add_u32 m0, s66, 73728
    s_add_u32 s67, s13, 327680
    buffer_load_dwordx4 v20, s[52:55], s67 offen  lds
    s_add_u32 m0, s66, 69632
    s_add_u32 s67, s13, 327680
    buffer_load_dwordx4 v13, s[52:55], s67 offen lds
    s_add_u32 m0, s66, 81920
    s_add_u32 s67, s13, 393216
    buffer_load_dwordx4 v20, s[52:55], s67 offen  lds
    s_add_u32 m0, s66, 77824
    s_add_u32 s67, s13, 393216
    buffer_load_dwordx4 v13, s[52:55], s67 offen lds
    s_add_u32 m0, s66, 90112
    s_add_u32 s67, s13, 458752
    buffer_load_dwordx4 v20, s[52:55], s67 offen  lds
    s_add_u32 m0, s66, 86016
    s_add_u32 s67, s13, 458752
    buffer_load_dwordx4 v13, s[52:55], s67 offen lds
    v_cmp_ne_u32 vcc, 1, v6
    s_cmp_eq_u32 s3, 4
    s_cselect_b64 s[18:19], vcc, 0
    s_cmp_lg_u64 s[18:19], 0
    s_cbranch_scc1 L_dsl
L_dok:
    v_lshrrev_b32 v5, 2, v2
    v_and_b32 v5, 3, v5
    v_lshl_add_u32 v5, v3, 2, v5
    v_and_b32 v6, 7, v5
    v_lshlrev_b32 v6, 5, v6
    v_lshl_add_u32 v6, v5, 8, v6
    v_and_b32 v5, 3, v2
    v_lshl_add_u32 v10, v5, 3, v6
    s_lshl_b32 s16, s11, 13
    v_add_u32 v6, s16, v10
    s_lshl_b32 s16, s8, 7
    v_xor_b32 v6, s16, v6
    v_xor_b32 v23, 0, v6
    v_xor_b32 v24, 32, v6
    v_xor_b32 v25, 64, v6
    v_xor_b32 v26, 96, v6
    v_xor_b32 v27, 128, v6
    v_xor_b32 v28, 160, v6
    v_xor_b32 v29, 192, v6
    v_xor_b32 v30, 224, v6
    s_waitcnt vmcnt(8)
    s_barrier
    s_add_u32 s67, s14, 0
    buffer_load_dwordx4 v[160:163], v21, s[32:35], s67 offen sc1
    buffer_load_dwordx4 v[164:167], v22, s[32:35], s67 offen sc1
    s_add_u32 s67, s14, 262144
    buffer_load_dwordx4 v[168:171], v21, s[32:35], s67 offen sc1
    buffer_load_dwordx4 v[172:175], v22, s[32:35], s67 offen sc1
    s_add_u32 s67, s14, 524288
    buffer_load_dwordx4 v[176:179], v21, s[32:35], s67 offen sc1
    buffer_load_dwordx4 v[180:183], v22, s[32:35], s67 offen sc1
    s_add_u32 s67, s14, 786432
    buffer_load_dwordx4 v[184:187], v21, s[32:35], s67 offen sc1
    buffer_load_dwordx4 v[188:191], v22, s[32:35], s67 offen sc1
    ds_read_b64_tr_b16 v[128:129], v23 offset:32768
    ds_read_b64_tr_b16 v[130:131], v23 offset:36864
    ds_read_b64_tr_b16 v[132:133], v24 offset:32768
    ds_read_b64_tr_b16 v[134:135], v24 offset:36864
    ds_read_b64_tr_b16 v[136:137], v25 offset:32768
    ds_read_b64_tr_b16 v[138:139], v25 offset:36864
    ds_read_b64_tr_b16 v[140:141], v26 offset:32768
    ds_read_b64_tr_b16 v[142:143], v26 offset:36864
    ds_read_b64_tr_b16 v[144:145], v27 offset:32768
    ds_read_b64_tr_b16 v[146:147], v27 offset:36864
    ds_read_b64_tr_b16 v[148:149], v28 offset:32768
    ds_read_b64_tr_b16 v[150:151], v28 offset:36864
    ds_read_b64_tr_b16 v[152:153], v29 offset:32768
    ds_read_b64_tr_b16 v[154:155], v29 offset:36864
    ds_read_b64_tr_b16 v[156:157], v30 offset:32768
    ds_read_b64_tr_b16 v[158:159], v30 offset:36864
L_join:
    s_waitcnt vmcnt(6) lgkmcnt(14)
    v_mfma_f32_16x16x32_bf16 v[192:195], v[128:131], v[160:163], 0
    v_add_u32 v32, 0x10000, v23
    v_mfma_f32_16x16x32_bf16 v[196:199], v[128:131], v[164:167], 0
    ds_read_b64_tr_b16 v[128:129], v23 offset:49152
    ds_read_b64_tr_b16 v[130:131], v23 offset:53248
    v_add_u32 v33, 0x10000, v24
    s_waitcnt lgkmcnt(14)
    v_mfma_f32_16x16x32_bf16 v[204:207], v[132:135], v[164:167], 0
    v_add_u32 v34, 0x10000, v25
    v_mfma_f32_16x16x32_bf16 v[200:203], v[132:135], v[160:163], 0
    ds_read_b64_tr_b16 v[132:133], v24 offset:49152
    ds_read_b64_tr_b16 v[134:135], v24 offset:53248
    v_add_u32 v35, 0x10000, v26
    s_waitcnt lgkmcnt(14)
    v_mfma_f32_16x16x32_bf16 v[208:211], v[136:139], v[160:163], 0
    v_add_u32 v36, 0x10000, v27
    v_mfma_f32_16x16x32_bf16 v[212:215], v[136:139], v[164:167], 0
    ds_read_b64_tr_b16 v[136:137], v25 offset:49152
    ds_read_b64_tr_b16 v[138:139], v25 offset:53248
    v_add_u32 v37, 0x10000, v28
    s_waitcnt lgkmcnt(14)
    v_mfma_f32_16x16x32_bf16 v[220:223], v[140:143], v[164:167], 0
    v_add_u32 v38, 0x10000, v29
    v_mfma_f32_16x16x32_bf16 v[216:219], v[140:143], v[160:163], 0
    ds_read_b64_tr_b16 v[140:141], v26 offset:49152
    ds_read_b64_tr_b16 v[142:143], v26 offset:53248
    v_add_u32 v39, 0x10000, v30
    s_waitcnt lgkmcnt(14)
    v_mfma_f32_16x16x32_bf16 v[224:227], v[144:147], v[160:163], 0
    v_mfma_f32_16x16x32_bf16 v[228:231], v[144:147], v[164:167], 0
    ds_read_b64_tr_b16 v[144:145], v27 offset:49152
    ds_read_b64_tr_b16 v[146:147], v27 offset:53248
    s_waitcnt lgkmcnt(14)
    v_mfma_f32_16x16x32_bf16 v[236:239], v[148:151], v[164:167], 0
    v_mfma_f32_16x16x32_bf16 v[232:235], v[148:151], v[160:163], 0
    ds_read_b64_tr_b16 v[148:149], v28 offset:49152
    ds_read_b64_tr_b16 v[150:151], v28 offset:53248
    s_waitcnt lgkmcnt(14)
    v_mfma_f32_16x16x32_bf16 v[240:243], v[152:155], v[160:163], 0
    v_mfma_f32_16x16x32_bf16 v[244:247], v[152:155], v[164:167], 0
    ds_read_b64_tr_b16 v[152:153], v29 offset:49152
    ds_read_b64_tr_b16 v[154:155], v29 offset:53248
    s_waitcnt lgkmcnt(14)
    v_mfma_f32_16x16x32_bf16 v[252:255], v[156:159], v[164:167], 0
    v_mfma_f32_16x16x32_bf16 v[248:251], v[156:159], v[160:163], 0
    ds_read_b64_tr_b16 v[156:157], v30 offset:49152
    ds_read_b64_tr_b16 v[158:159], v30 offset:53248
    s_add_u32 s67, s14, 1048576
    buffer_load_dwordx4 v[160:163], v21, s[32:35], s67 offen sc1
    buffer_load_dwordx4 v[164:167], v22, s[32:35], s67 offen sc1
    s_waitcnt vmcnt(6) lgkmcnt(14)
    v_mfma_f32_16x16x32_bf16 v[192:195], v[128:131], v[168:171], v[192:195]
    v_mfma_f32_16x16x32_bf16 v[196:199], v[128:131], v[172:175], v[196:199]
    s_waitcnt vmcnt(10) lgkmcnt(0)
    s_barrier
    v_mfma_f32_16x16x32_bf16 v[204:207], v[132:135], v[172:175], v[204:207]
    ds_read_b64_tr_b16 v[128:129], v32 offset:0
    ds_read_b64_tr_b16 v[130:131], v32 offset:4096
    s_add_u32 m0, s66, 0
    s_add_u32 s67, s13, 524288
    v_mfma_f32_16x16x32_bf16 v[200:203], v[132:135], v[168:171], v[200:203]
    ds_read_b64_tr_b16 v[132:133], v33 offset:0
    ds_read_b64_tr_b16 v[134:135], v33 offset:4096
    buffer_load_dwordx4 v20, s[52:55], s67 offen  lds
    s_add_u32 m0, s66, 8192
    v_mfma_f32_16x16x32_bf16 v[208:211], v[136:139], v[168:171], v[208:211]
    s_add_u32 s67, s13, 589824
    buffer_load_dwordx4 v20, s[52:55], s67 offen  lds
    v_mfma_f32_16x16x32_bf16 v[212:215], v[136:139], v[172:175], v[212:215]
    ds_read_b64_tr_b16 v[136:137], v34 offset:0
    ds_read_b64_tr_b16 v[138:139], v34 offset:4096
    s_add_u32 m0, s66, 16384
    s_add_u32 s67, s13, 655360
    v_mfma_f32_16x16x32_bf16 v[220:223], v[140:143], v[172:175], v[220:223]
    buffer_load_dwordx4 v20, s[52:55], s67 offen  lds
    v_mfma_f32_16x16x32_bf16 v[216:219], v[140:143], v[168:171], v[216:219]
    ds_read_b64_tr_b16 v[140:141], v35 offset:0
    ds_read_b64_tr_b16 v[142:143], v35 offset:4096
    s_add_u32 m0, s66, 24576
    v_mfma_f32_16x16x32_bf16 v[224:227], v[144:147], v[168:171], v[224:227]
    s_add_u32 s67, s13, 720896
    v_mfma_f32_16x16x32_bf16 v[228:231], v[144:147], v[172:175], v[228:231]
    ds_read_b64_tr_b16 v[144:145], v36 offset:0
    ds_read_b64_tr_b16 v[146:147], v36 offset:4096
    buffer_load_dwordx4 v20, s[52:55], s67 offen  lds
    v_mfma_f32_16x16x32_bf16 v[236:239], v[148:151], v[172:175], v[236:239]
    s_add_u32 m0, s66, 32768
    v_mfma_f32_16x16x32_bf16 v[232:235], v[148:151], v[168:171], v[232:235]
    ds_read_b64_tr_b16 v[148:149], v37 offset:0
    ds_read_b64_tr_b16 v[150:151], v37 offset:4096
    s_add_u32 s67, s13, 786432
    v_mfma_f32_16x16x32_bf16 v[240:243], v[152:155], v[168:171], v[240:243]
    buffer_load_dwordx4 v20, s[52:55], s67 offen  lds
    v_mfma_f32_16x16x32_bf16 v[244:247], v[152:155], v[172:175], v[244:247]
    ds_read_b64_tr_b16 v[152:153], v38 offset:0
    ds_read_b64_tr_b16 v[154:155], v38 offset:4096
    s_add_u32 m0, s66, 40960
    v_mfma_f32_16x16x32_bf16 v[252:255], v[156:159], v[172:175], v[252:255]
    s_add_u32 s67, s13, 851968
    v_mfma_f32_16x16x32_bf16 v[248:251], v[156:159], v[168:171], v[248:251]
    ds_read_b64_tr_b16 v[156:157], v39 offset:0
    ds_read_b64_tr_b16 v[158:159], v39 offset:4096
    buffer_load_dwordx4 v20, s[52:55], s67 offen  lds
    s_add_u32 s67, s14, 1310720
    buffer_load_dwordx4 v[168:171], v21, s[32:35], s67 offen sc1
    buffer_load_dwordx4 v[172:175], v22, s[32:35], s67 offen sc1
    s_waitcnt vmcnt(12) lgkmcnt(14)
    v_mfma_f32_16x16x32_bf16 v[192:195], v[128:131], v[176:179], v[192:195]
    s_add_u32 m0, s66, 49152
    v_mfma_f32_16x16x32_bf16 v[196:199], v[128:131], v[180:183], v[196:199]
    ds_read_b64_tr_b16 v[128:129], v32 offset:16384
    ds_read_b64_tr_b16 v[130:131], v32 offset:20480
    s_add_u32 s67, s13, 917504
    s_waitcnt lgkmcnt(14)
    v_mfma_f32_16x16x32_bf16 v[204:207], v[132:135], v[180:183], v[204:207]
    buffer_load_dwordx4 v20, s[52:55], s67 offen  lds
    v_mfma_f32_16x16x32_bf16 v[200:203], v[132:135], v[176:179], v[200:203]
    ds_read_b64_tr_b16 v[132:133], v33 offset:16384
    ds_read_b64_tr_b16 v[134:135], v33 offset:20480
    s_add_u32 m0, s66, 57344
    s_waitcnt lgkmcnt(14)
    v_mfma_f32_16x16x32_bf16 v[208:211], v[136:139], v[176:179], v[208:211]
    s_add_u32 s67, s13, 983040
    v_mfma_f32_16x16x32_bf16 v[212:215], v[136:139], v[180:183], v[212:215]
    ds_read_b64_tr_b16 v[136:137], v34 offset:16384
    ds_read_b64_tr_b16 v[138:139], v34 offset:20480
    buffer_load_dwordx4 v20, s[52:55], s67 offen  lds
    s_waitcnt lgkmcnt(14)
    v_mfma_f32_16x16x32_bf16 v[220:223], v[140:143], v[180:183], v[220:223]
    v_mfma_f32_16x16x32_bf16 v[216:219], v[140:143], v[176:179], v[216:219]
    ds_read_b64_tr_b16 v[140:141], v35 offset:16384
    ds_read_b64_tr_b16 v[142:143], v35 offset:20480
    s_waitcnt lgkmcnt(14)
    v_mfma_f32_16x16x32_bf16 v[224:227], v[144:147], v[176:179], v[224:227]
    v_mfma_f32_16x16x32_bf16 v[228:231], v[144:147], v[180:183], v[228:231]
    ds_read_b64_tr_b16 v[144:145], v36 offset:16384
    ds_read_b64_tr_b16 v[146:147], v36 offset:20480
    s_waitcnt lgkmcnt(14)
    v_mfma_f32_16x16x32_bf16 v[236:239], v[148:151], v[180:183], v[236:239]
    v_mfma_f32_16x16x32_bf16 v[232:235], v[148:151], v[176:179], v[232:235]
    ds_read_b64_tr_b16 v[148:149], v37 offset:16384
    ds_read_b64_tr_b16 v[150:151], v37 offset:20480
    s_waitcnt lgkmcnt(14)
    v_mfma_f32_16x16x32_bf16 v[240:243], v[152:155], v[176:179], v[240:243]
    v_mfma_f32_16x16x32_bf16 v[244:247], v[152:155], v[180:183], v[244:247]
    ds_read_b64_tr_b16 v[152:153], v38 offset:16384
    ds_read_b64_tr_b16 v[154:155], v38 offset:20480
    s_waitcnt lgkmcnt(14)
    v_mfma_f32_16x16x32_bf16 v[252:255], v[156:159], v[180:183], v[252:255]
    v_mfma_f32_16x16x32_bf16 v[248:251], v[156:159], v[176:179], v[248:251]
    ds_read_b64_tr_b16 v[156:157], v39 offset:16384
    ds_read_b64_tr_b16 v[158:159], v39 offset:20480
    s_add_u32 s67, s14, 1572864
    buffer_load_dwordx4 v[176:179], v21, s[32:35], s67 offen sc1
    buffer_load_dwordx4 v[180:183], v22, s[32:35], s67 offen sc1
    s_waitcnt vmcnt(14) lgkmcnt(14)
    v_mfma_f32_16x16x32_bf16 v[192:195], v[128:131], v[184:187], v[192:195]
    v_mfma_f32_16x16x32_bf16 v[196:199], v[128:131], v[188:191], v[196:199]
    s_waitcnt vmcnt(8) lgkmcnt(0)
    s_barrier
    v_mfma_f32_16x16x32_bf16 v[204:207], v[132:135], v[188:191], v[204:207]
    ds_read_b64_tr_b16 v[128:129], v23 offset:0
    ds_read_b64_tr_b16 v[130:131], v23 offset:4096
    s_lshl_b32 s70, s2, 7
    v_mfma_f32_16x16x32_bf16 v[200:203], v[132:135], v[184:187], v[200:203]
    ds_read_b64_tr_b16 v[132:133], v24 offset:0
    ds_read_b64_tr_b16 v[134:135], v24 offset:4096
    s_add_u32 s70, s70, 32636928
    v_mfma_f32_16x16x32_bf16 v[208:211], v[136:139], v[184:187], v[208:211]
    s_cmp_eq_u32 s3, 0
    v_mfma_f32_16x16x32_bf16 v[212:215], v[136:139], v[188:191], v[212:215]
    ds_read_b64_tr_b16 v[136:137], v25 offset:0
    ds_read_b64_tr_b16 v[138:139], v25 offset:4096
    s_cselect_b32 s70, s70, 0x20000000
    v_mfma_f32_16x16x32_bf16 v[220:223], v[140:143], v[188:191], v[220:223]
    v_mov_b32 v16, 1
    v_mfma_f32_16x16x32_bf16 v[216:219], v[140:143], v[184:187], v[216:219]
    ds_read_b64_tr_b16 v[140:141], v26 offset:0
    ds_read_b64_tr_b16 v[142:143], v26 offset:4096
    v_mov_b32 v17, 0
    v_mfma_f32_16x16x32_bf16 v[224:227], v[144:147], v[184:187], v[224:227]
    buffer_store_dword v16, v17, s[32:35], s70 offen sc1
    v_mfma_f32_16x16x32_bf16 v[228:231], v[144:147], v[188:191], v[228:231]
    ds_read_b64_tr_b16 v[144:145], v27 offset:0
    ds_read_b64_tr_b16 v[146:147], v27 offset:4096
    s_add_u32 m0, s66, 65536
    v_mfma_f32_16x16x32_bf16 v[236:239], v[148:151], v[188:191], v[236:239]
    s_add_u32 s67, s13, 1048576
    v_mfma_f32_16x16x32_bf16 v[232:235], v[148:151], v[184:187], v[232:235]
    ds_read_b64_tr_b16 v[148:149], v28 offset:0
    ds_read_b64_tr_b16 v[150:151], v28 offset:4096
    buffer_load_dwordx4 v20, s[52:55], s67 offen  lds
    v_mfma_f32_16x16x32_bf16 v[240:243], v[152:155], v[184:187], v[240:243]
    s_add_u32 m0, s66, 73728
    v_mfma_f32_16x16x32_bf16 v[244:247], v[152:155], v[188:191], v[244:247]
    ds_read_b64_tr_b16 v[152:153], v29 offset:0
    ds_read_b64_tr_b16 v[154:155], v29 offset:4096
    s_add_u32 s67, s13, 1114112
    v_mfma_f32_16x16x32_bf16 v[252:255], v[156:159], v[188:191], v[252:255]
    buffer_load_dwordx4 v20, s[52:55], s67 offen  lds
    v_mfma_f32_16x16x32_bf16 v[248:251], v[156:159], v[184:187], v[248:251]
    ds_read_b64_tr_b16 v[156:157], v30 offset:0
    ds_read_b64_tr_b16 v[158:159], v30 offset:4096
    s_add_u32 s67, s14, 1835008
    buffer_load_dwordx4 v[184:187], v21, s[32:35], s67 offen sc1
    buffer_load_dwordx4 v[188:191], v22, s[32:35], s67 offen sc1
    s_waitcnt vmcnt(17) lgkmcnt(14)
    v_mfma_f32_16x16x32_bf16 v[192:195], v[128:131], v[160:163], v[192:195]
    s_add_u32 m0, s66, 81920
    v_mfma_f32_16x16x32_bf16 v[196:199], v[128:131], v[164:167], v[196:199]
    ds_read_b64_tr_b16 v[128:129], v23 offset:16384
    ds_read_b64_tr_b16 v[130:131], v23 offset:20480
    s_add_u32 s67, s13, 1179648
    s_waitcnt lgkmcnt(14)
    v_mfma_f32_16x16x32_bf16 v[204:207], v[132:135], v[164:167], v[204:207]
    buffer_load_dwordx4 v20, s[52:55], s67 offen  lds
    v_mfma_f32_16x16x32_bf16 v[200:203], v[132:135], v[160:163], v[200:203]
    ds_read_b64_tr_b16 v[132:133], v24 offset:16384
    ds_read_b64_tr_b16 v[134:135], v24 offset:20480
    s_add_u32 m0, s66, 90112
    s_waitcnt lgkmcnt(14)
    v_mfma_f32_16x16x32_bf16 v[208:211], v[136:139], v[160:163], v[208:211]
    s_add_u32 s67, s13, 1245184
    v_mfma_f32_16x16x32_bf16 v[212:215], v[136:139], v[164:167], v[212:215]
    ds_read_b64_tr_b16 v[136:137], v25 offset:16384
    ds_read_b64_tr_b16 v[138:139], v25 offset:20480
    buffer_load_dwordx4 v20, s[52:55], s67 offen  lds
    s_waitcnt lgkmcnt(14)
    v_mfma_f32_16x16x32_bf16 v[220:223], v[140:143], v[164:167], v[220:223]
    v_mfma_f32_16x16x32_bf16 v[216:219], v[140:143], v[160:163], v[216:219]
    ds_read_b64_tr_b16 v[140:141], v26 offset:16384
    ds_read_b64_tr_b16 v[142:143], v26 offset:20480
    s_waitcnt lgkmcnt(14)
    v_mfma_f32_16x16x32_bf16 v[224:227], v[144:147], v[160:163], v[224:227]
    v_mfma_f32_16x16x32_bf16 v[228:231], v[144:147], v[164:167], v[228:231]
    ds_read_b64_tr_b16 v[144:145], v27 offset:16384
    ds_read_b64_tr_b16 v[146:147], v27 offset:20480
    s_waitcnt lgkmcnt(14)
    v_mfma_f32_16x16x32_bf16 v[236:239], v[148:151], v[164:167], v[236:239]
    v_mfma_f32_16x16x32_bf16 v[232:235], v[148:151], v[160:163], v[232:235]
    ds_read_b64_tr_b16 v[148:149], v28 offset:16384
    ds_read_b64_tr_b16 v[150:151], v28 offset:20480
    s_waitcnt lgkmcnt(14)
    v_mfma_f32_16x16x32_bf16 v[240:243], v[152:155], v[160:163], v[240:243]
    v_mfma_f32_16x16x32_bf16 v[244:247], v[152:155], v[164:167], v[244:247]
    ds_read_b64_tr_b16 v[152:153], v29 offset:16384
    ds_read_b64_tr_b16 v[154:155], v29 offset:20480
    s_waitcnt lgkmcnt(14)
    v_mfma_f32_16x16x32_bf16 v[252:255], v[156:159], v[164:167], v[252:255]
    v_mfma_f32_16x16x32_bf16 v[248:251], v[156:159], v[160:163], v[248:251]
    ds_read_b64_tr_b16 v[156:157], v30 offset:16384
    ds_read_b64_tr_b16 v[158:159], v30 offset:20480
    s_add_u32 s67, s14, 2097152
    buffer_load_dwordx4 v[160:163], v21, s[32:35], s67 offen sc1
    buffer_load_dwordx4 v[164:167], v22, s[32:35], s67 offen sc1
    s_waitcnt vmcnt(13) lgkmcnt(14)
    v_mfma_f32_16x16x32_bf16 v[192:195], v[128:131], v[168:171], v[192:195]
    v_mfma_f32_16x16x32_bf16 v[196:199], v[128:131], v[172:175], v[196:199]
    s_waitcnt vmcnt(11) lgkmcnt(0)
    s_barrier
    v_mfma_f32_16x16x32_bf16 v[204:207], v[132:135], v[172:175], v[204:207]
    ds_read_b64_tr_b16 v[128:129], v23 offset:32768
    ds_read_b64_tr_b16 v[130:131], v23 offset:36864
    s_add_u32 m0, s66, 0
    v_mfma_f32_16x16x32_bf16 v[200:203], v[132:135], v[168:171], v[200:203]
    ds_read_b64_tr_b16 v[132:133], v24 offset:32768
    ds_read_b64_tr_b16 v[134:135], v24 offset:36864
    s_add_u32 s67, s13, 1310720
    v_mfma_f32_16x16x32_bf16 v[208:211], v[136:139], v[168:171], v[208:211]
    buffer_load_dwordx4 v20, s[52:55], s67 offen  lds
    v_mfma_f32_16x16x32_bf16 v[212:215], v[136:139], v[172:175], v[212:215]
    ds_read_b64_tr_b16 v[136:137], v25 offset:32768
    ds_read_b64_tr_b16 v[138:139], v25 offset:36864
    s_add_u32 m0, s66, 8192
    v_mfma_f32_16x16x32_bf16 v[220:223], v[140:143], v[172:175], v[220:223]
    s_add_u32 s67, s13, 1376256
    v_mfma_f32_16x16x32_bf16 v[216:219], v[140:143], v[168:171], v[216:219]
    ds_read_b64_tr_b16 v[140:141], v26 offset:32768
    ds_read_b64_tr_b16 v[142:143], v26 offset:36864
    buffer_load_dwordx4 v20, s[52:55], s67 offen  lds
    v_mfma_f32_16x16x32_bf16 v[224:227], v[144:147], v[168:171], v[224:227]
    v_mfma_f32_16x16x32_bf16 v[228:231], v[144:147], v[172:175], v[228:231]
    ds_read_b64_tr_b16 v[144:145], v27 offset:32768
    ds_read_b64_tr_b16 v[146:147], v27 offset:36864
    v_mfma_f32_16x16x32_bf16 v[236:239], v[148:151], v[172:175], v[236:239]
    v_mfma_f32_16x16x32_bf16 v[232:235], v[148:151], v[168:171], v[232:235]
    ds_read_b64_tr_b16 v[148:149], v28 offset:32768
    ds_read_b64_tr_b16 v[150:151], v28 offset:36864
    v_mfma_f32_16x16x32_bf16 v[240:243], v[152:155], v[168:171], v[240:243]
    v_mfma_f32_16x16x32_bf16 v[244:247], v[152:155], v[172:175], v[244:247]
    ds_read_b64_tr_b16 v[152:153], v29 offset:32768
    ds_read_b64_tr_b16 v[154:155], v29 offset:36864
    v_mfma_f32_16x16x32_bf16 v[252:255], v[156:159], v[172:175], v[252:255]
    v_mfma_f32_16x16x32_bf16 v[248:251], v[156:159], v[168:171], v[248:251]
    ds_read_b64_tr_b16 v[156:157], v30 offset:32768
    ds_read_b64_tr_b16 v[158:159], v30 offset:36864
    s_add_u32 s67, s14, 2359296
    buffer_load_dwordx4 v[168:171], v21, s[32:35], s67 offen sc1
    buffer_load_dwordx4 v[172:175], v22, s[32:35], s67 offen sc1
    s_waitcnt vmcnt(13) lgkmcnt(14)
    v_mfma_f32_16x16x32_bf16 v[192:195], v[128:131], v[176:179], v[192:195]
    s_add_u32 m0, s66, 16384
    v_mfma_f32_16x16x32_bf16 v[196:199], v[128:131], v[180:183], v[196:199]
    ds_read_b64_tr_b16 v[128:129], v23 offset:49152
    ds_read_b64_tr_b16 v[130:131], v23 offset:53248
    s_add_u32 s67, s13, 1441792
    s_waitcnt lgkmcnt(14)
    v_mfma_f32_16x16x32_bf16 v[204:207], v[132:135], v[180:183], v[204:207]
    buffer_load_dwordx4 v20, s[52:55], s67 offen  lds
    v_mfma_f32_16x16x32_bf16 v[200:203], v[132:135], v[176:179], v[200:203]
    ds_read_b64_tr_b16 v[132:133], v24 offset:49152
    ds_read_b64_tr_b16 v[134:135], v24 offset:53248
    s_add_u32 m0, s66, 24576
    s_waitcnt lgkmcnt(14)
    v_mfma_f32_16x16x32_bf16 v[208:211], v[136:139], v[176:179], v[208:211]
    s_add_u32 s67, s13, 1507328
    v_mfma_f32_16x16x32_bf16 v[212:215], v[136:139], v[180:183], v[212:215]
    ds_read_b64_tr_b16 v[136:137], v25 offset:49152
    ds_read_b64_tr_b16 v[138:139], v25 offset:53248
    buffer_load_dwordx4 v20, s[52:55], s67 offen  lds
    s_waitcnt lgkmcnt(14)
    v_mfma_f32_16x16x32_bf16 v[220:223], v[140:143], v[180:183], v[220:223]
    v_mfma_f32_16x16x32_bf16 v[216:219], v[140:143], v[176:179], v[216:219]
    ds_read_b64_tr_b16 v[140:141], v26 offset:49152
    ds_read_b64_tr_b16 v[142:143], v26 offset:53248
    s_waitcnt lgkmcnt(14)
    v_mfma_f32_16x16x32_bf16 v[224:227], v[144:147], v[176:179], v[224:227]
    v_mfma_f32_16x16x32_bf16 v[228:231], v[144:147], v[180:183], v[228:231]
    ds_read_b64_tr_b16 v[144:145], v27 offset:49152
    ds_read_b64_tr_b16 v[146:147], v27 offset:53248
    s_waitcnt lgkmcnt(14)
    v_mfma_f32_16x16x32_bf16 v[236:239], v[148:151], v[180:183], v[236:239]
    v_mfma_f32_16x16x32_bf16 v[232:235], v[148:151], v[176:179], v[232:235]
    ds_read_b64_tr_b16 v[148:149], v28 offset:49152
    ds_read_b64_tr_b16 v[150:151], v28 offset:53248
    s_waitcnt lgkmcnt(14)
    v_mfma_f32_16x16x32_bf16 v[240:243], v[152:155], v[176:179], v[240:243]
    v_mfma_f32_16x16x32_bf16 v[244:247], v[152:155], v[180:183], v[244:247]
    ds_read_b64_tr_b16 v[152:153], v29 offset:49152
    ds_read_b64_tr_b16 v[154:155], v29 offset:53248
    s_waitcnt lgkmcnt(14)
    v_mfma_f32_16x16x32_bf16 v[252:255], v[156:159], v[180:183], v[252:255]
    v_mfma_f32_16x16x32_bf16 v[248:251], v[156:159], v[176:179], v[248:251]
    ds_read_b64_tr_b16 v[156:157], v30 offset:49152
    ds_read_b64_tr_b16 v[158:159], v30 offset:53248
    s_add_u32 s67, s14, 2621440
    buffer_load_dwordx4 v[176:179], v21, s[32:35], s67 offen sc1
    buffer_load_dwordx4 v[180:183], v22, s[32:35], s67 offen sc1
    s_waitcnt vmcnt(12) lgkmcnt(14)
    v_mfma_f32_16x16x32_bf16 v[192:195], v[128:131], v[184:187], v[192:195]
    v_mfma_f32_16x16x32_bf16 v[196:199], v[128:131], v[188:191], v[196:199]
    s_waitcnt vmcnt(10) lgkmcnt(0)
    s_barrier
    v_mfma_f32_16x16x32_bf16 v[204:207], v[132:135], v[188:191], v[204:207]
    ds_read_b64_tr_b16 v[128:129], v32 offset:0
    ds_read_b64_tr_b16 v[130:131], v32 offset:4096
    s_add_u32 m0, s66, 32768
    v_mfma_f32_16x16x32_bf16 v[200:203], v[132:135], v[184:187], v[200:203]
    ds_read_b64_tr_b16 v[132:133], v33 offset:0
    ds_read_b64_tr_b16 v[134:135], v33 offset:4096
    s_add_u32 s67, s13, 1572864
    v_mfma_f32_16x16x32_bf16 v[208:211], v[136:139], v[184:187], v[208:211]
    buffer_load_dwordx4 v20, s[52:55], s67 offen  lds
    v_mfma_f32_16x16x32_bf16 v[212:215], v[136:139], v[188:191], v[212:215]
    ds_read_b64_tr_b16 v[136:137], v34 offset:0
    ds_read_b64_tr_b16 v[138:139], v34 offset:4096
    s_add_u32 m0, s66, 40960
    v_mfma_f32_16x16x32_bf16 v[220:223], v[140:143], v[188:191], v[220:223]
    s_add_u32 s67, s13, 1638400
    v_mfma_f32_16x16x32_bf16 v[216:219], v[140:143], v[184:187], v[216:219]
    ds_read_b64_tr_b16 v[140:141], v35 offset:0
    ds_read_b64_tr_b16 v[142:143], v35 offset:4096
    buffer_load_dwordx4 v20, s[52:55], s67 offen  lds
    v_mfma_f32_16x16x32_bf16 v[224:227], v[144:147], v[184:187], v[224:227]
    v_mfma_f32_16x16x32_bf16 v[228:231], v[144:147], v[188:191], v[228:231]
    ds_read_b64_tr_b16 v[144:145], v36 offset:0
    ds_read_b64_tr_b16 v[146:147], v36 offset:4096
    v_mfma_f32_16x16x32_bf16 v[236:239], v[148:151], v[188:191], v[236:239]
    v_mfma_f32_16x16x32_bf16 v[232:235], v[148:151], v[184:187], v[232:235]
    ds_read_b64_tr_b16 v[148:149], v37 offset:0
    ds_read_b64_tr_b16 v[150:151], v37 offset:4096
    v_mfma_f32_16x16x32_bf16 v[240:243], v[152:155], v[184:187], v[240:243]
    v_mfma_f32_16x16x32_bf16 v[244:247], v[152:155], v[188:191], v[244:247]
    ds_read_b64_tr_b16 v[152:153], v38 offset:0
    ds_read_b64_tr_b16 v[154:155], v38 offset:4096
    v_mfma_f32_16x16x32_bf16 v[252:255], v[156:159], v[188:191], v[252:255]
    v_mfma_f32_16x16x32_bf16 v[248:251], v[156:159], v[184:187], v[248:251]
    ds_read_b64_tr_b16 v[156:157], v39 offset:0
    ds_read_b64_tr_b16 v[158:159], v39 offset:4096
    s_add_u32 s67, s14, 2883584
    buffer_load_dwordx4 v[184:187], v21, s[32:35], s67 offen sc1
    buffer_load_dwordx4 v[188:191], v22, s[32:35], s67 offen sc1
    s_waitcnt vmcnt(12) lgkmcnt(14)
    v_mfma_f32_16x16x32_bf16 v[192:195], v[128:131], v[160:163], v[192:195]
    s_add_u32 m0, s66, 49152
    v_mfma_f32_16x16x32_bf16 v[196:199], v[128:131], v[164:167], v[196:199]
    ds_read_b64_tr_b16 v[128:129], v32 offset:16384
    ds_read_b64_tr_b16 v[130:131], v32 offset:20480
    s_add_u32 s67, s13, 1703936
    s_waitcnt lgkmcnt(14)
    v_mfma_f32_16x16x32_bf16 v[204:207], v[132:135], v[164:167], v[204:207]
    buffer_load_dwordx4 v20, s[52:55], s67 offen  lds
    v_mfma_f32_16x16x32_bf16 v[200:203], v[132:135], v[160:163], v[200:203]
    ds_read_b64_tr_b16 v[132:133], v33 offset:16384
    ds_read_b64_tr_b16 v[134:135], v33 offset:20480
    s_add_u32 m0, s66, 57344
    s_waitcnt lgkmcnt(14)
    v_mfma_f32_16x16x32_bf16 v[208:211], v[136:139], v[160:163], v[208:211]
    s_add_u32 s67, s13, 1769472
    v_mfma_f32_16x16x32_bf16 v[212:215], v[136:139], v[164:167], v[212:215]
    ds_read_b64_tr_b16 v[136:137], v34 offset:16384
    ds_read_b64_tr_b16 v[138:139], v34 offset:20480
    buffer_load_dwordx4 v20, s[52:55], s67 offen  lds
    s_waitcnt lgkmcnt(14)
    v_mfma_f32_16x16x32_bf16 v[220:223], v[140:143], v[164:167], v[220:223]
    v_mfma_f32_16x16x32_bf16 v[216:219], v[140:143], v[160:163], v[216:219]
    ds_read_b64_tr_b16 v[140:141], v35 offset:16384
    ds_read_b64_tr_b16 v[142:143], v35 offset:20480
    s_waitcnt lgkmcnt(14)
    v_mfma_f32_16x16x32_bf16 v[224:227], v[144:147], v[160:163], v[224:227]
    v_mfma_f32_16x16x32_bf16 v[228:231], v[144:147], v[164:167], v[228:231]
    ds_read_b64_tr_b16 v[144:145], v36 offset:16384
    ds_read_b64_tr_b16 v[146:147], v36 offset:20480
    s_waitcnt lgkmcnt(14)
    v_mfma_f32_16x16x32_bf16 v[236:239], v[148:151], v[164:167], v[236:239]
    v_mfma_f32_16x16x32_bf16 v[232:235], v[148:151], v[160:163], v[232:235]
    ds_read_b64_tr_b16 v[148:149], v37 offset:16384
    ds_read_b64_tr_b16 v[150:151], v37 offset:20480
    s_waitcnt lgkmcnt(14)
    v_mfma_f32_16x16x32_bf16 v[240:243], v[152:155], v[160:163], v[240:243]
    v_mfma_f32_16x16x32_bf16 v[244:247], v[152:155], v[164:167], v[244:247]
    ds_read_b64_tr_b16 v[152:153], v38 offset:16384
    ds_read_b64_tr_b16 v[154:155], v38 offset:20480
    s_waitcnt lgkmcnt(14)
    v_mfma_f32_16x16x32_bf16 v[252:255], v[156:159], v[164:167], v[252:255]
    v_mfma_f32_16x16x32_bf16 v[248:251], v[156:159], v[160:163], v[248:251]
    ds_read_b64_tr_b16 v[156:157], v39 offset:16384
    ds_read_b64_tr_b16 v[158:159], v39 offset:20480
    s_add_u32 s67, s14, 3145728
    buffer_load_dwordx4 v[160:163], v21, s[32:35], s67 offen sc1
    buffer_load_dwordx4 v[164:167], v22, s[32:35], s67 offen sc1
    s_waitcnt vmcnt(12) lgkmcnt(14)
    v_mfma_f32_16x16x32_bf16 v[192:195], v[128:131], v[168:171], v[192:195]
    v_mfma_f32_16x16x32_bf16 v[196:199], v[128:131], v[172:175], v[196:199]
    s_waitcnt vmcnt(10) lgkmcnt(0)
    s_barrier
    v_mfma_f32_16x16x32_bf16 v[204:207], v[132:135], v[172:175], v[204:207]
    ds_read_b64_tr_b16 v[128:129], v23 offset:0
    ds_read_b64_tr_b16 v[130:131], v23 offset:4096
    s_add_u32 m0, s66, 65536
    v_mfma_f32_16x16x32_bf16 v[200:203], v[132:135], v[168:171], v[200:203]
    ds_read_b64_tr_b16 v[132:133], v24 offset:0
    ds_read_b64_tr_b16 v[134:135], v24 offset:4096
    s_add_u32 s67, s13, 1835008
    v_mfma_f32_16x16x32_bf16 v[208:211], v[136:139], v[168:171], v[208:211]
    buffer_load_dwordx4 v20, s[52:55], s67 offen  lds
    v_mfma_f32_16x16x32_bf16 v[212:215], v[136:139], v[172:175], v[212:215]
    ds_read_b64_tr_b16 v[136:137], v25 offset:0
    ds_read_b64_tr_b16 v[138:139], v25 offset:4096
    s_add_u32 m0, s66, 73728
    v_mfma_f32_16x16x32_bf16 v[220:223], v[140:143], v[172:175], v[220:223]
    s_add_u32 s67, s13, 1900544
    v_mfma_f32_16x16x32_bf16 v[216:219], v[140:143], v[168:171], v[216:219]
    ds_read_b64_tr_b16 v[140:141], v26 offset:0
    ds_read_b64_tr_b16 v[142:143], v26 offset:4096
    buffer_load_dwordx4 v20, s[52:55], s67 offen  lds
    v_mfma_f32_16x16x32_bf16 v[224:227], v[144:147], v[168:171], v[224:227]
    v_mfma_f32_16x16x32_bf16 v[228:231], v[144:147], v[172:175], v[228:231]
    ds_read_b64_tr_b16 v[144:145], v27 offset:0
    ds_read_b64_tr_b16 v[146:147], v27 offset:4096
    v_mfma_f32_16x16x32_bf16 v[236:239], v[148:151], v[172:175], v[236:239]
    v_mfma_f32_16x16x32_bf16 v[232:235], v[148:151], v[168:171], v[232:235]
    ds_read_b64_tr_b16 v[148:149], v28 offset:0
    ds_read_b64_tr_b16 v[150:151], v28 offset:4096
    v_mfma_f32_16x16x32_bf16 v[240:243], v[152:155], v[168:171], v[240:243]
    v_mfma_f32_16x16x32_bf16 v[244:247], v[152:155], v[172:175], v[244:247]
    ds_read_b64_tr_b16 v[152:153], v29 offset:0
    ds_read_b64_tr_b16 v[154:155], v29 offset:4096
    v_mfma_f32_16x16x32_bf16 v[252:255], v[156:159], v[172:175], v[252:255]
    v_mfma_f32_16x16x32_bf16 v[248:251], v[156:159], v[168:171], v[248:251]
    ds_read_b64_tr_b16 v[156:157], v30 offset:0
    ds_read_b64_tr_b16 v[158:159], v30 offset:4096
    s_add_u32 s67, s14, 3407872
    buffer_load_dwordx4 v[168:171], v21, s[32:35], s67 offen sc1
    buffer_load_dwordx4 v[172:175], v22, s[32:35], s67 offen sc1
    s_waitcnt vmcnt(12) lgkmcnt(14)
    v_mfma_f32_16x16x32_bf16 v[192:195], v[128:131], v[176:179], v[192:195]
    s_add_u32 m0, s66, 81920
    v_mfma_f32_16x16x32_bf16 v[196:199], v[128:131], v[180:183], v[196:199]
    ds_read_b64_tr_b16 v[128:129], v23 offset:16384
    ds_read_b64_tr_b16 v[130:131], v23 offset:20480
    s_add_u32 s67, s13, 1966080
    s_waitcnt lgkmcnt(14)
    v_mfma_f32_16x16x32_bf16 v[204:207], v[132:135], v[180:183], v[204:207]
    buffer_load_dwordx4 v20, s[52:55], s67 offen  lds
    v_mfma_f32_16x16x32_bf16 v[200:203], v[132:135], v[176:179], v[200:203]
    ds_read_b64_tr_b16 v[132:133], v24 offset:16384
    ds_read_b64_tr_b16 v[134:135], v24 offset:20480
    s_add_u32 m0, s66, 90112
    s_waitcnt lgkmcnt(14)
    v_mfma_f32_16x16x32_bf16 v[208:211], v[136:139], v[176:179], v[208:211]
    s_add_u32 s67, s13, 2031616
    v_mfma_f32_16x16x32_bf16 v[212:215], v[136:139], v[180:183], v[212:215]
    ds_read_b64_tr_b16 v[136:137], v25 offset:16384
    ds_read_b64_tr_b16 v[138:139], v25 offset:20480
    buffer_load_dwordx4 v20, s[52:55], s67 offen  lds
    s_waitcnt lgkmcnt(14)
    v_mfma_f32_16x16x32_bf16 v[220:223], v[140:143], v[180:183], v[220:223]
    v_mfma_f32_16x16x32_bf16 v[216:219], v[140:143], v[176:179], v[216:219]
    ds_read_b64_tr_b16 v[140:141], v26 offset:16384
    ds_read_b64_tr_b16 v[142:143], v26 offset:20480
    s_waitcnt lgkmcnt(14)
    v_mfma_f32_16x16x32_bf16 v[224:227], v[144:147], v[176:179], v[224:227]
    v_mfma_f32_16x16x32_bf16 v[228:231], v[144:147], v[180:183], v[228:231]
    ds_read_b64_tr_b16 v[144:145], v27 offset:16384
    ds_read_b64_tr_b16 v[146:147], v27 offset:20480
    s_waitcnt lgkmcnt(14)
    v_mfma_f32_16x16x32_bf16 v[236:239], v[148:151], v[180:183], v[236:239]
    v_mfma_f32_16x16x32_bf16 v[232:235], v[148:151], v[176:179], v[232:235]
    ds_read_b64_tr_b16 v[148:149], v28 offset:16384
    ds_read_b64_tr_b16 v[150:151], v28 offset:20480
    s_waitcnt lgkmcnt(14)
    v_mfma_f32_16x16x32_bf16 v[240:243], v[152:155], v[176:179], v[240:243]
    v_mfma_f32_16x16x32_bf16 v[244:247], v[152:155], v[180:183], v[244:247]
    ds_read_b64_tr_b16 v[152:153], v29 offset:16384
    ds_read_b64_tr_b16 v[154:155], v29 offset:20480
    s_waitcnt lgkmcnt(14)
    v_mfma_f32_16x16x32_bf16 v[252:255], v[156:159], v[180:183], v[252:255]
    v_mfma_f32_16x16x32_bf16 v[248:251], v[156:159], v[176:179], v[248:251]
    ds_read_b64_tr_b16 v[156:157], v30 offset:16384
    ds_read_b64_tr_b16 v[158:159], v30 offset:20480
    s_add_u32 s67, s14, 3670016
    buffer_load_dwordx4 v[176:179], v21, s[32:35], s67 offen sc1
    buffer_load_dwordx4 v[180:183], v22, s[32:35], s67 offen sc1
    s_waitcnt vmcnt(12) lgkmcnt(14)
    v_mfma_f32_16x16x32_bf16 v[192:195], v[128:131], v[184:187], v[192:195]
    v_mfma_f32_16x16x32_bf16 v[196:199], v[128:131], v[188:191], v[196:199]
    s_waitcnt vmcnt(10) lgkmcnt(0)
    s_barrier
    v_mfma_f32_16x16x32_bf16 v[204:207], v[132:135], v[188:191], v[204:207]
    ds_read_b64_tr_b16 v[128:129], v23 offset:32768
    ds_read_b64_tr_b16 v[130:131], v23 offset:36864
    s_add_u32 m0, s66, 0
    v_mfma_f32_16x16x32_bf16 v[200:203], v[132:135], v[184:187], v[200:203]
    ds_read_b64_tr_b16 v[132:133], v24 offset:32768
    ds_read_b64_tr_b16 v[134:135], v24 offset:36864
    s_add_u32 s67, s13, 2097152
    v_mfma_f32_16x16x32_bf16 v[208:211], v[136:139], v[184:187], v[208:211]
    buffer_load_dwordx4 v20, s[52:55], s67 offen  lds
    v_mfma_f32_16x16x32_bf16 v[212:215], v[136:139], v[188:191], v[212:215]
    ds_read_b64_tr_b16 v[136:137], v25 offset:32768
    ds_read_b64_tr_b16 v[138:139], v25 offset:36864
    s_add_u32 m0, s66, 8192
    v_mfma_f32_16x16x32_bf16 v[220:223], v[140:143], v[188:191], v[220:223]
    s_add_u32 s67, s13, 2162688
    v_mfma_f32_16x16x32_bf16 v[216:219], v[140:143], v[184:187], v[216:219]
    ds_read_b64_tr_b16 v[140:141], v26 offset:32768
    ds_read_b64_tr_b16 v[142:143], v26 offset:36864
    buffer_load_dwordx4 v20, s[52:55], s67 offen  lds
    v_mfma_f32_16x16x32_bf16 v[224:227], v[144:147], v[184:187], v[224:227]
    v_mfma_f32_16x16x32_bf16 v[228:231], v[144:147], v[188:191], v[228:231]
    ds_read_b64_tr_b16 v[144:145], v27 offset:32768
    ds_read_b64_tr_b16 v[146:147], v27 offset:36864
    v_mfma_f32_16x16x32_bf16 v[236:239], v[148:151], v[188:191], v[236:239]
    v_mfma_f32_16x16x32_bf16 v[232:235], v[148:151], v[184:187], v[232:235]
    ds_read_b64_tr_b16 v[148:149], v28 offset:32768
    ds_read_b64_tr_b16 v[150:151], v28 offset:36864
    v_mfma_f32_16x16x32_bf16 v[240:243], v[152:155], v[184:187], v[240:243]
    v_mfma_f32_16x16x32_bf16 v[244:247], v[152:155], v[188:191], v[244:247]
    ds_read_b64_tr_b16 v[152:153], v29 offset:32768
    ds_read_b64_tr_b16 v[154:155], v29 offset:36864
    v_mfma_f32_16x16x32_bf16 v[252:255], v[156:159], v[188:191], v[252:255]
    v_mfma_f32_16x16x32_bf16 v[248:251], v[156:159], v[184:187], v[248:251]
    ds_read_b64_tr_b16 v[156:157], v30 offset:32768
    ds_read_b64_tr_b16 v[158:159], v30 offset:36864
    s_add_u32 s67, s14, 3932160
    buffer_load_dwordx4 v[184:187], v21, s[32:35], s67 offen sc1
    buffer_load_dwordx4 v[188:191], v22, s[32:35], s67 offen sc1
    s_waitcnt vmcnt(12) lgkmcnt(14)
    v_mfma_f32_16x16x32_bf16 v[192:195], v[128:131], v[160:163], v[192:195]
    s_add_u32 m0, s66, 16384
    v_mfma_f32_16x16x32_bf16 v[196:199], v[128:131], v[164:167], v[196:199]
    ds_read_b64_tr_b16 v[128:129], v23 offset:49152
    ds_read_b64_tr_b16 v[130:131], v23 offset:53248
    s_add_u32 s67, s13, 2228224
    s_waitcnt lgkmcnt(14)
    v_mfma_f32_16x16x32_bf16 v[204:207], v[132:135], v[164:167], v[204:207]
    buffer_load_dwordx4 v20, s[52:55], s67 offen  lds
    v_mfma_f32_16x16x32_bf16 v[200:203], v[132:135], v[160:163], v[200:203]
    ds_read_b64_tr_b16 v[132:133], v24 offset:49152
    ds_read_b64_tr_b16 v[134:135], v24 offset:53248
    s_add_u32 m0, s66, 24576
    s_waitcnt lgkmcnt(14)
    v_mfma_f32_16x16x32_bf16 v[208:211], v[136:139], v[160:163], v[208:211]
    s_add_u32 s67, s13, 2293760
    v_mfma_f32_16x16x32_bf16 v[212:215], v[136:139], v[164:167], v[212:215]
    ds_read_b64_tr_b16 v[136:137], v25 offset:49152
    ds_read_b64_tr_b16 v[138:139], v25 offset:53248
    buffer_load_dwordx4 v20, s[52:55], s67 offen  lds
    s_waitcnt lgkmcnt(14)
    v_mfma_f32_16x16x32_bf16 v[220:223], v[140:143], v[164:167], v[220:223]
    v_mfma_f32_16x16x32_bf16 v[216:219], v[140:143], v[160:163], v[216:219]
    ds_read_b64_tr_b16 v[140:141], v26 offset:49152
    ds_read_b64_tr_b16 v[142:143], v26 offset:53248
    s_waitcnt lgkmcnt(14)
    v_mfma_f32_16x16x32_bf16 v[224:227], v[144:147], v[160:163], v[224:227]
    v_mfma_f32_16x16x32_bf16 v[228:231], v[144:147], v[164:167], v[228:231]
    ds_read_b64_tr_b16 v[144:145], v27 offset:49152
    ds_read_b64_tr_b16 v[146:147], v27 offset:53248
    s_waitcnt lgkmcnt(14)
    v_mfma_f32_16x16x32_bf16 v[236:239], v[148:151], v[164:167], v[236:239]
    v_mfma_f32_16x16x32_bf16 v[232:235], v[148:151], v[160:163], v[232:235]
    ds_read_b64_tr_b16 v[148:149], v28 offset:49152
    ds_read_b64_tr_b16 v[150:151], v28 offset:53248
    s_waitcnt lgkmcnt(14)
    v_mfma_f32_16x16x32_bf16 v[240:243], v[152:155], v[160:163], v[240:243]
    v_mfma_f32_16x16x32_bf16 v[244:247], v[152:155], v[164:167], v[244:247]
    ds_read_b64_tr_b16 v[152:153], v29 offset:49152
    ds_read_b64_tr_b16 v[154:155], v29 offset:53248
    s_waitcnt lgkmcnt(14)
    v_mfma_f32_16x16x32_bf16 v[252:255], v[156:159], v[164:167], v[252:255]
    v_mfma_f32_16x16x32_bf16 v[248:251], v[156:159], v[160:163], v[248:251]
    ds_read_b64_tr_b16 v[156:157], v30 offset:49152
    ds_read_b64_tr_b16 v[158:159], v30 offset:53248
    s_add_u32 s67, s14, 4194304
    buffer_load_dwordx4 v[160:163], v21, s[32:35], s67 offen sc1
    buffer_load_dwordx4 v[164:167], v22, s[32:35], s67 offen sc1
    s_waitcnt vmcnt(12) lgkmcnt(14)
    v_mfma_f32_16x16x32_bf16 v[192:195], v[128:131], v[168:171], v[192:195]
    v_mfma_f32_16x16x32_bf16 v[196:199], v[128:131], v[172:175], v[196:199]
    s_waitcnt vmcnt(10) lgkmcnt(0)
    s_barrier
    v_mfma_f32_16x16x32_bf16 v[204:207], v[132:135], v[172:175], v[204:207]
    ds_read_b64_tr_b16 v[128:129], v32 offset:0
    ds_read_b64_tr_b16 v[130:131], v32 offset:4096
    s_add_u32 m0, s66, 32768
    v_mfma_f32_16x16x32_bf16 v[200:203], v[132:135], v[168:171], v[200:203]
    ds_read_b64_tr_b16 v[132:133], v33 offset:0
    ds_read_b64_tr_b16 v[134:135], v33 offset:4096
    s_add_u32 s67, s13, 2359296
    v_mfma_f32_16x16x32_bf16 v[208:211], v[136:139], v[168:171], v[208:211]
    buffer_load_dwordx4 v20, s[52:55], s67 offen  lds
    v_mfma_f32_16x16x32_bf16 v[212:215], v[136:139], v[172:175], v[212:215]
    ds_read_b64_tr_b16 v[136:137], v34 offset:0
    ds_read_b64_tr_b16 v[138:139], v34 offset:4096
    s_add_u32 m0, s66, 40960
    v_mfma_f32_16x16x32_bf16 v[220:223], v[140:143], v[172:175], v[220:223]
    s_add_u32 s67, s13, 2424832
    v_mfma_f32_16x16x32_bf16 v[216:219], v[140:143], v[168:171], v[216:219]
    ds_read_b64_tr_b16 v[140:141], v35 offset:0
    ds_read_b64_tr_b16 v[142:143], v35 offset:4096
    buffer_load_dwordx4 v20, s[52:55], s67 offen  lds
    v_mfma_f32_16x16x32_bf16 v[224:227], v[144:147], v[168:171], v[224:227]
    v_mfma_f32_16x16x32_bf16 v[228:231], v[144:147], v[172:175], v[228:231]
    ds_read_b64_tr_b16 v[144:145], v36 offset:0
    ds_read_b64_tr_b16 v[146:147], v36 offset:4096
    v_mfma_f32_16x16x32_bf16 v[236:239], v[148:151], v[172:175], v[236:239]
    v_mfma_f32_16x16x32_bf16 v[232:235], v[148:151], v[168:171], v[232:235]
    ds_read_b64_tr_b16 v[148:149], v37 offset:0
    ds_read_b64_tr_b16 v[150:151], v37 offset:4096
    v_mfma_f32_16x16x32_bf16 v[240:243], v[152:155], v[168:171], v[240:243]
    v_mfma_f32_16x16x32_bf16 v[244:247], v[152:155], v[172:175], v[244:247]
    ds_read_b64_tr_b16 v[152:153], v38 offset:0
    ds_read_b64_tr_b16 v[154:155], v38 offset:4096
    v_mfma_f32_16x16x32_bf16 v[252:255], v[156:159], v[172:175], v[252:255]
    v_mfma_f32_16x16x32_bf16 v[248:251], v[156:159], v[168:171], v[248:251]
    ds_read_b64_tr_b16 v[156:157], v39 offset:0
    ds_read_b64_tr_b16 v[158:159], v39 offset:4096
    s_add_u32 s67, s14, 4456448
    buffer_load_dwordx4 v[168:171], v21, s[32:35], s67 offen sc1
    buffer_load_dwordx4 v[172:175], v22, s[32:35], s67 offen sc1
    s_waitcnt vmcnt(12) lgkmcnt(14)
    v_mfma_f32_16x16x32_bf16 v[192:195], v[128:131], v[176:179], v[192:195]
    s_add_u32 m0, s66, 49152
    v_mfma_f32_16x16x32_bf16 v[196:199], v[128:131], v[180:183], v[196:199]
    ds_read_b64_tr_b16 v[128:129], v32 offset:16384
    ds_read_b64_tr_b16 v[130:131], v32 offset:20480
    s_add_u32 s67, s13, 2490368
    s_waitcnt lgkmcnt(14)
    v_mfma_f32_16x16x32_bf16 v[204:207], v[132:135], v[180:183], v[204:207]
    buffer_load_dwordx4 v20, s[52:55], s67 offen  lds
    v_mfma_f32_16x16x32_bf16 v[200:203], v[132:135], v[176:179], v[200:203]
    ds_read_b64_tr_b16 v[132:133], v33 offset:16384
    ds_read_b64_tr_b16 v[134:135], v33 offset:20480
    s_add_u32 m0, s66, 57344
    s_waitcnt lgkmcnt(14)
    v_mfma_f32_16x16x32_bf16 v[208:211], v[136:139], v[176:179], v[208:211]
    s_add_u32 s67, s13, 2555904
    v_mfma_f32_16x16x32_bf16 v[212:215], v[136:139], v[180:183], v[212:215]
    ds_read_b64_tr_b16 v[136:137], v34 offset:16384
    ds_read_b64_tr_b16 v[138:139], v34 offset:20480
    buffer_load_dwordx4 v20, s[52:55], s67 offen  lds
    s_waitcnt lgkmcnt(14)
    v_mfma_f32_16x16x32_bf16 v[220:223], v[140:143], v[180:183], v[220:223]
    v_mfma_f32_16x16x32_bf16 v[216:219], v[140:143], v[176:179], v[216:219]
    ds_read_b64_tr_b16 v[140:141], v35 offset:16384
    ds_read_b64_tr_b16 v[142:143], v35 offset:20480
    s_waitcnt lgkmcnt(14)
    v_mfma_f32_16x16x32_bf16 v[224:227], v[144:147], v[176:179], v[224:227]
    v_mfma_f32_16x16x32_bf16 v[228:231], v[144:147], v[180:183], v[228:231]
    ds_read_b64_tr_b16 v[144:145], v36 offset:16384
    ds_read_b64_tr_b16 v[146:147], v36 offset:20480
    s_waitcnt lgkmcnt(14)
    v_mfma_f32_16x16x32_bf16 v[236:239], v[148:151], v[180:183], v[236:239]
    v_mfma_f32_16x16x32_bf16 v[232:235], v[148:151], v[176:179], v[232:235]
    ds_read_b64_tr_b16 v[148:149], v37 offset:16384
    ds_read_b64_tr_b16 v[150:151], v37 offset:20480
    s_waitcnt lgkmcnt(14)
    v_mfma_f32_16x16x32_bf16 v[240:243], v[152:155], v[176:179], v[240:243]
    v_mfma_f32_16x16x32_bf16 v[244:247], v[152:155], v[180:183], v[244:247]
    ds_read_b64_tr_b16 v[152:153], v38 offset:16384
    ds_read_b64_tr_b16 v[154:155], v38 offset:20480
    s_waitcnt lgkmcnt(14)
    v_mfma_f32_16x16x32_bf16 v[252:255], v[156:159], v[180:183], v[252:255]
    v_mfma_f32_16x16x32_bf16 v[248:251], v[156:159], v[176:179], v[248:251]
    ds_read_b64_tr_b16 v[156:157], v39 offset:16384
    ds_read_b64_tr_b16 v[158:159], v39 offset:20480
    s_add_u32 s67, s14, 4718592
    buffer_load_dwordx4 v[176:179], v21, s[32:35], s67 offen sc1
    buffer_load_dwordx4 v[180:183], v22, s[32:35], s67 offen sc1
    s_waitcnt vmcnt(12) lgkmcnt(14)
    v_mfma_f32_16x16x32_bf16 v[192:195], v[128:131], v[184:187], v[192:195]
    v_mfma_f32_16x16x32_bf16 v[196:199], v[128:131], v[188:191], v[196:199]
    s_waitcnt vmcnt(10) lgkmcnt(0)
    s_barrier
    v_mfma_f32_16x16x32_bf16 v[204:207], v[132:135], v[188:191], v[204:207]
    ds_read_b64_tr_b16 v[128:129], v23 offset:0
    ds_read_b64_tr_b16 v[130:131], v23 offset:4096
    s_add_u32 m0, s66, 65536
    v_mfma_f32_16x16x32_bf16 v[200:203], v[132:135], v[184:187], v[200:203]
    ds_read_b64_tr_b16 v[132:133], v24 offset:0
    ds_read_b64_tr_b16 v[134:135], v24 offset:4096
    s_add_u32 s67, s13, 2621440
    v_mfma_f32_16x16x32_bf16 v[208:211], v[136:139], v[184:187], v[208:211]
    buffer_load_dwordx4 v20, s[52:55], s67 offen  lds
    v_mfma_f32_16x16x32_bf16 v[212:215], v[136:139], v[188:191], v[212:215]
    ds_read_b64_tr_b16 v[136:137], v25 offset:0
    ds_read_b64_tr_b16 v[138:139], v25 offset:4096
    s_add_u32 m0, s66, 73728
    v_mfma_f32_16x16x32_bf16 v[220:223], v[140:143], v[188:191], v[220:223]
    s_add_u32 s67, s13, 2686976
    v_mfma_f32_16x16x32_bf16 v[216:219], v[140:143], v[184:187], v[216:219]
    ds_read_b64_tr_b16 v[140:141], v26 offset:0
    ds_read_b64_tr_b16 v[142:143], v26 offset:4096
    buffer_load_dwordx4 v20, s[52:55], s67 offen  lds
    v_mfma_f32_16x16x32_bf16 v[224:227], v[144:147], v[184:187], v[224:227]
    v_mfma_f32_16x16x32_bf16 v[228:231], v[144:147], v[188:191], v[228:231]
    ds_read_b64_tr_b16 v[144:145], v27 offset:0
    ds_read_b64_tr_b16 v[146:147], v27 offset:4096
    v_mfma_f32_16x16x32_bf16 v[236:239], v[148:151], v[188:191], v[236:239]
    v_mfma_f32_16x16x32_bf16 v[232:235], v[148:151], v[184:187], v[232:235]
    ds_read_b64_tr_b16 v[148:149], v28 offset:0
    ds_read_b64_tr_b16 v[150:151], v28 offset:4096
    v_mfma_f32_16x16x32_bf16 v[240:243], v[152:155], v[184:187], v[240:243]
    v_mfma_f32_16x16x32_bf16 v[244:247], v[152:155], v[188:191], v[244:247]
    ds_read_b64_tr_b16 v[152:153], v29 offset:0
    ds_read_b64_tr_b16 v[154:155], v29 offset:4096
    v_mfma_f32_16x16x32_bf16 v[252:255], v[156:159], v[188:191], v[252:255]
    v_mfma_f32_16x16x32_bf16 v[248:251], v[156:159], v[184:187], v[248:251]
    ds_read_b64_tr_b16 v[156:157], v30 offset:0
    ds_read_b64_tr_b16 v[158:159], v30 offset:4096
    s_add_u32 s67, s14, 4980736
    buffer_load_dwordx4 v[184:187], v21, s[32:35], s67 offen sc1
    buffer_load_dwordx4 v[188:191], v22, s[32:35], s67 offen sc1
    s_waitcnt vmcnt(12) lgkmcnt(14)
    v_mfma_f32_16x16x32_bf16 v[192:195], v[128:131], v[160:163], v[192:195]
    s_add_u32 m0, s66, 81920
    v_mfma_f32_16x16x32_bf16 v[196:199], v[128:131], v[164:167], v[196:199]
    ds_read_b64_tr_b16 v[128:129], v23 offset:16384
    ds_read_b64_tr_b16 v[130:131], v23 offset:20480
    s_add_u32 s67, s13, 2752512
    s_waitcnt lgkmcnt(14)
    v_mfma_f32_16x16x32_bf16 v[204:207], v[132:135], v[164:167], v[204:207]
    buffer_load_dwordx4 v20, s[52:55], s67 offen  lds
    v_mfma_f32_16x16x32_bf16 v[200:203], v[132:135], v[160:163], v[200:203]
    ds_read_b64_tr_b16 v[132:133], v24 offset:16384
    ds_read_b64_tr_b16 v[134:135], v24 offset:20480
    s_add_u32 m0, s66, 90112
    s_waitcnt lgkmcnt(14)
    v_mfma_f32_16x16x32_bf16 v[208:211], v[136:139], v[160:163], v[208:211]
    s_add_u32 s67, s13, 2818048
    v_mfma_f32_16x16x32_bf16 v[212:215], v[136:139], v[164:167], v[212:215]
    ds_read_b64_tr_b16 v[136:137], v25 offset:16384
    ds_read_b64_tr_b16 v[138:139], v25 offset:20480
    buffer_load_dwordx4 v20, s[52:55], s67 offen  lds
    s_waitcnt lgkmcnt(14)
    v_mfma_f32_16x16x32_bf16 v[220:223], v[140:143], v[164:167], v[220:223]
    v_mfma_f32_16x16x32_bf16 v[216:219], v[140:143], v[160:163], v[216:219]
    ds_read_b64_tr_b16 v[140:141], v26 offset:16384
    ds_read_b64_tr_b16 v[142:143], v26 offset:20480
    s_waitcnt lgkmcnt(14)
    v_mfma_f32_16x16x32_bf16 v[224:227], v[144:147], v[160:163], v[224:227]
    v_mfma_f32_16x16x32_bf16 v[228:231], v[144:147], v[164:167], v[228:231]
    ds_read_b64_tr_b16 v[144:145], v27 offset:16384
    ds_read_b64_tr_b16 v[146:147], v27 offset:20480
    s_waitcnt lgkmcnt(14)
    v_mfma_f32_16x16x32_bf16 v[236:239], v[148:151], v[164:167], v[236:239]
    v_mfma_f32_16x16x32_bf16 v[232:235], v[148:151], v[160:163], v[232:235]
    ds_read_b64_tr_b16 v[148:149], v28 offset:16384
    ds_read_b64_tr_b16 v[150:151], v28 offset:20480
    s_waitcnt lgkmcnt(14)
    v_mfma_f32_16x16x32_bf16 v[240:243], v[152:155], v[160:163], v[240:243]
    v_mfma_f32_16x16x32_bf16 v[244:247], v[152:155], v[164:167], v[244:247]
    ds_read_b64_tr_b16 v[152:153], v29 offset:16384
    ds_read_b64_tr_b16 v[154:155], v29 offset:20480
    s_waitcnt lgkmcnt(14)
    v_mfma_f32_16x16x32_bf16 v[252:255], v[156:159], v[164:167], v[252:255]
    v_mfma_f32_16x16x32_bf16 v[248:251], v[156:159], v[160:163], v[248:251]
    ds_read_b64_tr_b16 v[156:157], v30 offset:16384
    ds_read_b64_tr_b16 v[158:159], v30 offset:20480
    s_add_u32 s67, s14, 5242880
    buffer_load_dwordx4 v[160:163], v21, s[32:35], s67 offen sc1
    buffer_load_dwordx4 v[164:167], v22, s[32:35], s67 offen sc1
    s_waitcnt vmcnt(12) lgkmcnt(14)
    v_mfma_f32_16x16x32_bf16 v[192:195], v[128:131], v[168:171], v[192:195]
    v_mfma_f32_16x16x32_bf16 v[196:199], v[128:131], v[172:175], v[196:199]
    s_waitcnt vmcnt(10) lgkmcnt(0)
    s_barrier
    v_mfma_f32_16x16x32_bf16 v[204:207], v[132:135], v[172:175], v[204:207]
    ds_read_b64_tr_b16 v[128:129], v23 offset:32768
    ds_read_b64_tr_b16 v[130:131], v23 offset:36864
    s_add_u32 m0, s66, 0
    v_mfma_f32_16x16x32_bf16 v[200:203], v[132:135], v[168:171], v[200:203]
    ds_read_b64_tr_b16 v[132:133], v24 offset:32768
    ds_read_b64_tr_b16 v[134:135], v24 offset:36864
    s_add_u32 s67, s13, 2883584
    v_mfma_f32_16x16x32_bf16 v[208:211], v[136:139], v[168:171], v[208:211]
    buffer_load_dwordx4 v20, s[52:55], s67 offen  lds
    v_mfma_f32_16x16x32_bf16 v[212:215], v[136:139], v[172:175], v[212:215]
    ds_read_b64_tr_b16 v[136:137], v25 offset:32768
    ds_read_b64_tr_b16 v[138:139], v25 offset:36864
    s_add_u32 m0, s66, 8192
    v_mfma_f32_16x16x32_bf16 v[220:223], v[140:143], v[172:175], v[220:223]
    s_add_u32 s67, s13, 2949120
    v_mfma_f32_16x16x32_bf16 v[216:219], v[140:143], v[168:171], v[216:219]
    ds_read_b64_tr_b16 v[140:141], v26 offset:32768
    ds_read_b64_tr_b16 v[142:143], v26 offset:36864
    buffer_load_dwordx4 v20, s[52:55], s67 offen  lds
    v_mfma_f32_16x16x32_bf16 v[224:227], v[144:147], v[168:171], v[224:227]
    v_mfma_f32_16x16x32_bf16 v[228:231], v[144:147], v[172:175], v[228:231]
    ds_read_b64_tr_b16 v[144:145], v27 offset:32768
    ds_read_b64_tr_b16 v[146:147], v27 offset:36864
    v_mfma_f32_16x16x32_bf16 v[236:239], v[148:151], v[172:175], v[236:239]
    v_mfma_f32_16x16x32_bf16 v[232:235], v[148:151], v[168:171], v[232:235]
    ds_read_b64_tr_b16 v[148:149], v28 offset:32768
    ds_read_b64_tr_b16 v[150:151], v28 offset:36864
    v_mfma_f32_16x16x32_bf16 v[240:243], v[152:155], v[168:171], v[240:243]
    v_mfma_f32_16x16x32_bf16 v[244:247], v[152:155], v[172:175], v[244:247]
    ds_read_b64_tr_b16 v[152:153], v29 offset:32768
    ds_read_b64_tr_b16 v[154:155], v29 offset:36864
    v_mfma_f32_16x16x32_bf16 v[252:255], v[156:159], v[172:175], v[252:255]
    v_mfma_f32_16x16x32_bf16 v[248:251], v[156:159], v[168:171], v[248:251]
    ds_read_b64_tr_b16 v[156:157], v30 offset:32768
    ds_read_b64_tr_b16 v[158:159], v30 offset:36864
    s_add_u32 s67, s14, 5505024
    buffer_load_dwordx4 v[168:171], v21, s[32:35], s67 offen sc1
    buffer_load_dwordx4 v[172:175], v22, s[32:35], s67 offen sc1
    s_waitcnt vmcnt(12) lgkmcnt(14)
    v_mfma_f32_16x16x32_bf16 v[192:195], v[128:131], v[176:179], v[192:195]
    s_lshl_b32 s15, s10, 1
    s_add_u32 s15, s15, s8
    v_mfma_f32_16x16x32_bf16 v[196:199], v[128:131], v[180:183], v[196:199]
    ds_read_b64_tr_b16 v[128:129], v23 offset:49152
    ds_read_b64_tr_b16 v[130:131], v23 offset:53248
    s_lshl_b32 s16, s15, 4
    s_add_u32 s16, s16, 512
    s_waitcnt lgkmcnt(14)
    v_mfma_f32_16x16x32_bf16 v[204:207], v[132:135], v[180:183], v[204:207]
    v_add_u32 v5, s16, v4
    s_mov_b32 s17, 0xdddcba98
    v_mfma_f32_16x16x32_bf16 v[200:203], v[132:135], v[176:179], v[200:203]
    ds_read_b64_tr_b16 v[132:133], v24 offset:49152
    ds_read_b64_tr_b16 v[134:135], v24 offset:53248
    v_and_b32 v6, 7, v2
    v_lshlrev_b32 v6, 2, v6
    s_waitcnt lgkmcnt(14)
    v_mfma_f32_16x16x32_bf16 v[208:211], v[136:139], v[176:179], v[208:211]
    v_lshrrev_b32 v6, v6, s17
    v_and_b32 v6, 15, v6
    v_mfma_f32_16x16x32_bf16 v[212:215], v[136:139], v[180:183], v[212:215]
    ds_read_b64_tr_b16 v[136:137], v25 offset:49152
    ds_read_b64_tr_b16 v[138:139], v25 offset:53248
    s_mul_i32 s16, s8, 14
    v_add_u32 v6, s16, v6
    s_waitcnt lgkmcnt(14)
    v_mfma_f32_16x16x32_bf16 v[220:223], v[140:143], v[180:183], v[220:223]
    v_lshlrev_b32 v6, 3, v6
    s_lshr_b32 s16, s9, 1
    v_mfma_f32_16x16x32_bf16 v[216:219], v[140:143], v[176:179], v[216:219]
    ds_read_b64_tr_b16 v[140:141], v26 offset:49152
    ds_read_b64_tr_b16 v[142:143], v26 offset:53248
    s_add_u32 s16, s16, 256
    v_add_u32 v6, s16, v6
    s_waitcnt lgkmcnt(14)
    v_mfma_f32_16x16x32_bf16 v[224:227], v[144:147], v[176:179], v[224:227]
    v_cmp_gt_u32 vcc, 64, v2
    s_mov_b32 s72, 32571392
    v_mfma_f32_16x16x32_bf16 v[228:231], v[144:147], v[180:183], v[228:231]
    ds_read_b64_tr_b16 v[144:145], v27 offset:49152
    ds_read_b64_tr_b16 v[146:147], v27 offset:53248
    s_nop 0
    v_cndmask_b32 v5, v6, v5, vcc
    s_waitcnt lgkmcnt(14)
    v_mfma_f32_16x16x32_bf16 v[236:239], v[148:151], v[180:183], v[236:239]
    v_lshlrev_b32 v5, 7, v5
    s_cmp_eq_u32 s3, 0
    v_mfma_f32_16x16x32_bf16 v[232:235], v[148:151], v[176:179], v[232:235]
    ds_read_b64_tr_b16 v[148:149], v28 offset:49152
    ds_read_b64_tr_b16 v[150:151], v28 offset:53248
    s_cselect_b32 s72, s72, 0x20000000
    buffer_load_dword v6, v5, s[32:35], s72 offen sc1
    s_waitcnt lgkmcnt(14)
    v_mfma_f32_16x16x32_bf16 v[240:243], v[152:155], v[176:179], v[240:243]
    s_add_u32 m0, s66, 16384
    s_add_u32 s67, s13, 3014656
    v_mfma_f32_16x16x32_bf16 v[244:247], v[152:155], v[180:183], v[244:247]
    ds_read_b64_tr_b16 v[152:153], v29 offset:49152
    ds_read_b64_tr_b16 v[154:155], v29 offset:53248
    buffer_load_dwordx4 v20, s[52:55], s67 offen  lds
    s_add_u32 m0, s66, 24576
    s_waitcnt lgkmcnt(14)
    v_mfma_f32_16x16x32_bf16 v[252:255], v[156:159], v[180:183], v[252:255]
    s_add_u32 s67, s13, 3080192
    v_mfma_f32_16x16x32_bf16 v[248:251], v[156:159], v[176:179], v[248:251]
    ds_read_b64_tr_b16 v[156:157], v30 offset:49152
    ds_read_b64_tr_b16 v[158:159], v30 offset:53248
    buffer_load_dwordx4 v20, s[52:55], s67 offen  lds
    s_add_u32 s67, s14, 5767168
    buffer_load_dwordx4 v[176:179], v21, s[32:35], s67 offen sc1
    buffer_load_dwordx4 v[180:183], v22, s[32:35], s67 offen sc1
    s_waitcnt vmcnt(13) lgkmcnt(14)
    v_mfma_f32_16x16x32_bf16 v[192:195], v[128:131], v[184:187], v[192:195]
    v_mfma_f32_16x16x32_bf16 v[196:199], v[128:131], v[188:191], v[196:199]
    s_waitcnt vmcnt(11) lgkmcnt(0)
    s_barrier
    v_mfma_f32_16x16x32_bf16 v[204:207], v[132:135], v[188:191], v[204:207]
    ds_read_b64_tr_b16 v[128:129], v32 offset:0
    ds_read_b64_tr_b16 v[130:131], v32 offset:4096
    s_add_u32 m0, s66, 32768
    v_mfma_f32_16x16x32_bf16 v[200:203], v[132:135], v[184:187], v[200:203]
    ds_read_b64_tr_b16 v[132:133], v33 offset:0
    ds_read_b64_tr_b16 v[134:135], v33 offset:4096
    s_add_u32 s67, s13, 3145728
    v_mfma_f32_16x16x32_bf16 v[208:211], v[136:139], v[184:187], v[208:211]
    buffer_load_dwordx4 v20, s[52:55], s67 offen  lds
    v_mfma_f32_16x16x32_bf16 v[212:215], v[136:139], v[188:191], v[212:215]
    ds_read_b64_tr_b16 v[136:137], v34 offset:0
    ds_read_b64_tr_b16 v[138:139], v34 offset:4096
    s_add_u32 m0, s66, 40960
    v_mfma_f32_16x16x32_bf16 v[220:223], v[140:143], v[188:191], v[220:223]
    s_add_u32 s67, s13, 3211264
    v_mfma_f32_16x16x32_bf16 v[216:219], v[140:143], v[184:187], v[216:219]
    ds_read_b64_tr_b16 v[140:141], v35 offset:0
    ds_read_b64_tr_b16 v[142:143], v35 offset:4096
    buffer_load_dwordx4 v20, s[52:55], s67 offen  lds
    v_mfma_f32_16x16x32_bf16 v[224:227], v[144:147], v[184:187], v[224:227]
    v_mfma_f32_16x16x32_bf16 v[228:231], v[144:147], v[188:191], v[228:231]
    ds_read_b64_tr_b16 v[144:145], v36 offset:0
    ds_read_b64_tr_b16 v[146:147], v36 offset:4096
    v_mfma_f32_16x16x32_bf16 v[236:239], v[148:151], v[188:191], v[236:239]
    v_mfma_f32_16x16x32_bf16 v[232:235], v[148:151], v[184:187], v[232:235]
    ds_read_b64_tr_b16 v[148:149], v37 offset:0
    ds_read_b64_tr_b16 v[150:151], v37 offset:4096
    v_mfma_f32_16x16x32_bf16 v[240:243], v[152:155], v[184:187], v[240:243]
    v_mfma_f32_16x16x32_bf16 v[244:247], v[152:155], v[188:191], v[244:247]
    ds_read_b64_tr_b16 v[152:153], v38 offset:0
    ds_read_b64_tr_b16 v[154:155], v38 offset:4096
    v_mfma_f32_16x16x32_bf16 v[252:255], v[156:159], v[188:191], v[252:255]
    v_mfma_f32_16x16x32_bf16 v[248:251], v[156:159], v[184:187], v[248:251]
    ds_read_b64_tr_b16 v[156:157], v39 offset:0
    ds_read_b64_tr_b16 v[158:159], v39 offset:4096
    s_add_u32 s67, s14, 6029312
    buffer_load_dwordx4 v[184:187], v21, s[32:35], s67 offen sc1
    buffer_load_dwordx4 v[188:191], v22, s[32:35], s67 offen sc1
    s_waitcnt vmcnt(13) lgkmcnt(14)
    v_mfma_f32_16x16x32_bf16 v[192:195], v[128:131], v[160:163], v[192:195]
    s_add_u32 m0, s66, 49152
    v_mfma_f32_16x16x32_bf16 v[196:199], v[128:131], v[164:167], v[196:199]
    ds_read_b64_tr_b16 v[128:129], v32 offset:16384
    ds_read_b64_tr_b16 v[130:131], v32 offset:20480
    s_add_u32 s67, s13, 3276800
    s_waitcnt lgkmcnt(14)
    v_mfma_f32_16x16x32_bf16 v[204:207], v[132:135], v[164:167], v[204:207]
    buffer_load_dwordx4 v20, s[52:55], s67 offen  lds
    v_mfma_f32_16x16x32_bf16 v[200:203], v[132:135], v[160:163], v[200:203]
    ds_read_b64_tr_b16 v[132:133], v33 offset:16384
    ds_read_b64_tr_b16 v[134:135], v33 offset:20480
    s_add_u32 m0, s66, 57344
    s_waitcnt lgkmcnt(14)
    v_mfma_f32_16x16x32_bf16 v[208:211], v[136:139], v[160:163], v[208:211]
    s_add_u32 s67, s13, 3342336
    v_mfma_f32_16x16x32_bf16 v[212:215], v[136:139], v[164:167], v[212:215]
    ds_read_b64_tr_b16 v[136:137], v34 offset:16384
    ds_read_b64_tr_b16 v[138:139], v34 offset:20480
    buffer_load_dwordx4 v20, s[52:55], s67 offen  lds
    s_waitcnt lgkmcnt(14)
    v_mfma_f32_16x16x32_bf16 v[220:223], v[140:143], v[164:167], v[220:223]
    v_mfma_f32_16x16x32_bf16 v[216:219], v[140:143], v[160:163], v[216:219]
    ds_read_b64_tr_b16 v[140:141], v35 offset:16384
    ds_read_b64_tr_b16 v[142:143], v35 offset:20480
    s_waitcnt lgkmcnt(14)
    v_mfma_f32_16x16x32_bf16 v[224:227], v[144:147], v[160:163], v[224:227]
    v_mfma_f32_16x16x32_bf16 v[228:231], v[144:147], v[164:167], v[228:231]
    ds_read_b64_tr_b16 v[144:145], v36 offset:16384
    ds_read_b64_tr_b16 v[146:147], v36 offset:20480
    s_waitcnt lgkmcnt(14)
    v_mfma_f32_16x16x32_bf16 v[236:239], v[148:151], v[164:167], v[236:239]
    v_mfma_f32_16x16x32_bf16 v[232:235], v[148:151], v[160:163], v[232:235]
    ds_read_b64_tr_b16 v[148:149], v37 offset:16384
    ds_read_b64_tr_b16 v[150:151], v37 offset:20480
    s_waitcnt lgkmcnt(14)
    v_mfma_f32_16x16x32_bf16 v[240:243], v[152:155], v[160:163], v[240:243]
    v_mfma_f32_16x16x32_bf16 v[244:247], v[152:155], v[164:167], v[244:247]
    ds_read_b64_tr_b16 v[152:153], v38 offset:16384
    ds_read_b64_tr_b16 v[154:155], v38 offset:20480
    s_waitcnt lgkmcnt(14)
    v_mfma_f32_16x16x32_bf16 v[252:255], v[156:159], v[164:167], v[252:255]
    v_mfma_f32_16x16x32_bf16 v[248:251], v[156:159], v[160:163], v[248:251]
    ds_read_b64_tr_b16 v[156:157], v39 offset:16384
    ds_read_b64_tr_b16 v[158:159], v39 offset:20480
    s_add_u32 s67, s14, 6291456
    buffer_load_dwordx4 v[160:163], v21, s[32:35], s67 offen sc1
    buffer_load_dwordx4 v[164:167], v22, s[32:35], s67 offen sc1
    s_waitcnt vmcnt(13) lgkmcnt(14)
    v_mfma_f32_16x16x32_bf16 v[192:195], v[128:131], v[168:171], v[192:195]
    v_mfma_f32_16x16x32_bf16 v[196:199], v[128:131], v[172:175], v[196:199]
    s_waitcnt vmcnt(10) lgkmcnt(0)
    s_barrier
    v_mfma_f32_16x16x32_bf16 v[204:207], v[132:135], v[172:175], v[204:207]
    ds_read_b64_tr_b16 v[128:129], v23 offset:0
    ds_read_b64_tr_b16 v[130:131], v23 offset:4096
    s_add_u32 m0, s66, 65536
    v_mfma_f32_16x16x32_bf16 v[200:203], v[132:135], v[168:171], v[200:203]
    ds_read_b64_tr_b16 v[132:133], v24 offset:0
    ds_read_b64_tr_b16 v[134:135], v24 offset:4096
    s_add_u32 s67, s13, 3407872
    v_mfma_f32_16x16x32_bf16 v[208:211], v[136:139], v[168:171], v[208:211]
    buffer_load_dwordx4 v20, s[52:55], s67 offen  lds
    v_mfma_f32_16x16x32_bf16 v[212:215], v[136:139], v[172:175], v[212:215]
    ds_read_b64_tr_b16 v[136:137], v25 offset:0
    ds_read_b64_tr_b16 v[138:139], v25 offset:4096
    s_add_u32 m0, s66, 73728
    v_mfma_f32_16x16x32_bf16 v[220:223], v[140:143], v[172:175], v[220:223]
    s_add_u32 s67, s13, 3473408
    v_mfma_f32_16x16x32_bf16 v[216:219], v[140:143], v[168:171], v[216:219]
    ds_read_b64_tr_b16 v[140:141], v26 offset:0
    ds_read_b64_tr_b16 v[142:143], v26 offset:4096
    buffer_load_dwordx4 v20, s[52:55], s67 offen  lds
    v_mfma_f32_16x16x32_bf16 v[224:227], v[144:147], v[168:171], v[224:227]
    v_mfma_f32_16x16x32_bf16 v[228:231], v[144:147], v[172:175], v[228:231]
    ds_read_b64_tr_b16 v[144:145], v27 offset:0
    ds_read_b64_tr_b16 v[146:147], v27 offset:4096
    v_mfma_f32_16x16x32_bf16 v[236:239], v[148:151], v[172:175], v[236:239]
    v_mfma_f32_16x16x32_bf16 v[232:235], v[148:151], v[168:171], v[232:235]
    ds_read_b64_tr_b16 v[148:149], v28 offset:0
    ds_read_b64_tr_b16 v[150:151], v28 offset:4096
    v_mfma_f32_16x16x32_bf16 v[240:243], v[152:155], v[168:171], v[240:243]
    v_mfma_f32_16x16x32_bf16 v[244:247], v[152:155], v[172:175], v[244:247]
    ds_read_b64_tr_b16 v[152:153], v29 offset:0
    ds_read_b64_tr_b16 v[154:155], v29 offset:4096
    v_mfma_f32_16x16x32_bf16 v[252:255], v[156:159], v[172:175], v[252:255]
    v_mfma_f32_16x16x32_bf16 v[248:251], v[156:159], v[168:171], v[248:251]
    ds_read_b64_tr_b16 v[156:157], v30 offset:0
    ds_read_b64_tr_b16 v[158:159], v30 offset:4096
    s_add_u32 s67, s14, 6553600
    buffer_load_dwordx4 v[168:171], v21, s[32:35], s67 offen sc1
    buffer_load_dwordx4 v[172:175], v22, s[32:35], s67 offen sc1
    s_waitcnt vmcnt(12) lgkmcnt(14)
    v_mfma_f32_16x16x32_bf16 v[192:195], v[128:131], v[176:179], v[192:195]
    s_add_u32 m0, s66, 81920
    v_mfma_f32_16x16x32_bf16 v[196:199], v[128:131], v[180:183], v[196:199]
    ds_read_b64_tr_b16 v[128:129], v23 offset:16384
    ds_read_b64_tr_b16 v[130:131], v23 offset:20480
    s_add_u32 s67, s13, 3538944
    s_waitcnt lgkmcnt(14)
    v_mfma_f32_16x16x32_bf16 v[204:207], v[132:135], v[180:183], v[204:207]
    buffer_load_dwordx4 v20, s[52:55], s67 offen  lds
    v_mfma_f32_16x16x32_bf16 v[200:203], v[132:135], v[176:179], v[200:203]
    ds_read_b64_tr_b16 v[132:133], v24 offset:16384
    ds_read_b64_tr_b16 v[134:135], v24 offset:20480
    s_add_u32 m0, s66, 90112
    s_waitcnt lgkmcnt(14)
    v_mfma_f32_16x16x32_bf16 v[208:211], v[136:139], v[176:179], v[208:211]
    s_add_u32 s67, s13, 3604480
    v_mfma_f32_16x16x32_bf16 v[212:215], v[136:139], v[180:183], v[212:215]
    ds_read_b64_tr_b16 v[136:137], v25 offset:16384
    ds_read_b64_tr_b16 v[138:139], v25 offset:20480
    buffer_load_dwordx4 v20, s[52:55], s67 offen  lds
    s_waitcnt lgkmcnt(14)
    v_mfma_f32_16x16x32_bf16 v[220:223], v[140:143], v[180:183], v[220:223]
    v_mfma_f32_16x16x32_bf16 v[216:219], v[140:143], v[176:179], v[216:219]
    ds_read_b64_tr_b16 v[140:141], v26 offset:16384
    ds_read_b64_tr_b16 v[142:143], v26 offset:20480
    s_waitcnt lgkmcnt(14)
    v_mfma_f32_16x16x32_bf16 v[224:227], v[144:147], v[176:179], v[224:227]
    v_mfma_f32_16x16x32_bf16 v[228:231], v[144:147], v[180:183], v[228:231]
    ds_read_b64_tr_b16 v[144:145], v27 offset:16384
    ds_read_b64_tr_b16 v[146:147], v27 offset:20480
    s_waitcnt lgkmcnt(14)
    v_mfma_f32_16x16x32_bf16 v[236:239], v[148:151], v[180:183], v[236:239]
    v_mfma_f32_16x16x32_bf16 v[232:235], v[148:151], v[176:179], v[232:235]
    ds_read_b64_tr_b16 v[148:149], v28 offset:16384
    ds_read_b64_tr_b16 v[150:151], v28 offset:20480
    s_waitcnt lgkmcnt(14)
    v_mfma_f32_16x16x32_bf16 v[240:243], v[152:155], v[176:179], v[240:243]
    v_mfma_f32_16x16x32_bf16 v[244:247], v[152:155], v[180:183], v[244:247]
    ds_read_b64_tr_b16 v[152:153], v29 offset:16384
    ds_read_b64_tr_b16 v[154:155], v29 offset:20480
    s_waitcnt lgkmcnt(14)
    v_mfma_f32_16x16x32_bf16 v[252:255], v[156:159], v[180:183], v[252:255]
    v_mfma_f32_16x16x32_bf16 v[248:251], v[156:159], v[176:179], v[248:251]
    ds_read_b64_tr_b16 v[156:157], v30 offset:16384
    ds_read_b64_tr_b16 v[158:159], v30 offset:20480
    s_add_u32 s67, s14, 6815744
    buffer_load_dwordx4 v[176:179], v21, s[32:35], s67 offen sc1
    buffer_load_dwordx4 v[180:183], v22, s[32:35], s67 offen sc1
    s_waitcnt vmcnt(12) lgkmcnt(14)
    v_mfma_f32_16x16x32_bf16 v[192:195], v[128:131], v[184:187], v[192:195]
    v_mfma_f32_16x16x32_bf16 v[196:199], v[128:131], v[188:191], v[196:199]
    v_cmp_ne_u32 vcc, 1, v6
    s_cmp_eq_u32 s3, 0
    s_cselect_b64 s[18:19], vcc, 0
    s_cmp_lg_u64 s[18:19], 0
    s_cbranch_scc1 L_zzsl
L_zzok:
    s_waitcnt vmcnt(10) lgkmcnt(0)
    s_barrier
    v_mfma_f32_16x16x32_bf16 v[204:207], v[132:135], v[188:191], v[204:207]
    ds_read_b64_tr_b16 v[128:129], v23 offset:32768
    ds_read_b64_tr_b16 v[130:131], v23 offset:36864
    s_lshl_b32 s16, s9, 7
    s_lshl_b32 s17, s12, 5
    v_mfma_f32_16x16x32_bf16 v[200:203], v[132:135], v[184:187], v[200:203]
    ds_read_b64_tr_b16 v[132:133], v24 offset:32768
    ds_read_b64_tr_b16 v[134:135], v24 offset:36864
    s_add_u32 s16, s16, s17
    s_lshl_b32 s17, s11, 4
    v_mfma_f32_16x16x32_bf16 v[208:211], v[136:139], v[184:187], v[208:211]
    s_add_u32 s16, s16, s17
    v_add_u32 v5, s16, v4
    v_mfma_f32_16x16x32_bf16 v[212:215], v[136:139], v[188:191], v[212:215]
    ds_read_b64_tr_b16 v[136:137], v25 offset:32768
    ds_read_b64_tr_b16 v[138:139], v25 offset:36864
    v_lshlrev_b32 v5, 3, v5
    s_mov_b32 s17, 4194304
    v_mfma_f32_16x16x32_bf16 v[220:223], v[140:143], v[188:191], v[220:223]
    buffer_load_dwordx2 v[40:41], v5, s[32:35], s17 offen sc1
    s_lshl_b32 s16, s16, 11
    v_mfma_f32_16x16x32_bf16 v[216:219], v[140:143], v[184:187], v[216:219]
    ds_read_b64_tr_b16 v[140:141], v26 offset:32768
    ds_read_b64_tr_b16 v[142:143], v26 offset:36864
    s_lshl_b32 s17, s15, 7
    s_add_u32 s64, s16, s17
    v_mfma_f32_16x16x32_bf16 v[224:227], v[144:147], v[184:187], v[224:227]
    s_add_u32 s65, s64, 16384
    v_lshrrev_b32 v5, 3, v2
    v_mfma_f32_16x16x32_bf16 v[228:231], v[144:147], v[188:191], v[228:231]
    ds_read_b64_tr_b16 v[144:145], v27 offset:32768
    ds_read_b64_tr_b16 v[146:147], v27 offset:36864
    v_and_b32 v6, 7, v2
    v_xor_b32 v6, v6, v3
    v_mfma_f32_16x16x32_bf16 v[236:239], v[148:151], v[188:191], v[236:239]
    v_lshlrev_b32 v5, 11, v5
    v_lshl_add_u32 v42, v6, 4, v5
    v_mfma_f32_16x16x32_bf16 v[232:235], v[148:151], v[184:187], v[232:235]
    ds_read_b64_tr_b16 v[148:149], v28 offset:32768
    ds_read_b64_tr_b16 v[150:151], v28 offset:36864
    v_xor_b32 v43, 64, v42
    s_lshl_b32 s18, s3, 11
    v_mfma_f32_16x16x32_bf16 v[240:243], v[152:155], v[184:187], v[240:243]
    s_add_u32 m0, s18, 114688
    s_nop 0
    v_mfma_f32_16x16x32_bf16 v[244:247], v[152:155], v[188:191], v[244:247]
    ds_read_b64_tr_b16 v[152:153], v29 offset:32768
    ds_read_b64_tr_b16 v[154:155], v29 offset:36864
    buffer_load_dwordx4 v42, s[28:31], s64 offen lds
    s_add_u32 m0, s18, 115712
    v_mfma_f32_16x16x32_bf16 v[252:255], v[156:159], v[188:191], v[252:255]
    s_nop 0
    v_mfma_f32_16x16x32_bf16 v[248:251], v[156:159], v[184:187], v[248:251]
    ds_read_b64_tr_b16 v[156:157], v30 offset:32768
    ds_read_b64_tr_b16 v[158:159], v30 offset:36864
    buffer_load_dwordx4 v43, s[28:31], s65 offen lds
    s_add_u32 s67, s14, 7077888
    buffer_load_dwordx4 v[184:187], v21, s[32:35], s67 offen sc1
    buffer_load_dwordx4 v[188:191], v22, s[32:35], s67 offen sc1
    s_waitcnt vmcnt(13) lgkmcnt(14)
    v_mfma_f32_16x16x32_bf16 v[192:195], v[128:131], v[160:163], v[192:195]
    v_mfma_f32_16x16x32_bf16 v[196:199], v[128:131], v[164:167], v[196:199]
    ds_read_b64_tr_b16 v[128:129], v23 offset:49152
    ds_read_b64_tr_b16 v[130:131], v23 offset:53248
    s_waitcnt lgkmcnt(14)
    v_mfma_f32_16x16x32_bf16 v[204:207], v[132:135], v[164:167], v[204:207]
    v_mfma_f32_16x16x32_bf16 v[200:203], v[132:135], v[160:163], v[200:203]
    ds_read_b64_tr_b16 v[132:133], v24 offset:49152
    ds_read_b64_tr_b16 v[134:135], v24 offset:53248
    s_waitcnt lgkmcnt(14)
    v_mfma_f32_16x16x32_bf16 v[208:211], v[136:139], v[160:163], v[208:211]
    v_mfma_f32_16x16x32_bf16 v[212:215], v[136:139], v[164:167], v[212:215]
    ds_read_b64_tr_b16 v[136:137], v25 offset:49152
    ds_read_b64_tr_b16 v[138:139], v25 offset:53248
    s_waitcnt lgkmcnt(14)
    v_mfma_f32_16x16x32_bf16 v[220:223], v[140:143], v[164:167], v[220:223]
    v_mfma_f32_16x16x32_bf16 v[216:219], v[140:143], v[160:163], v[216:219]
    ds_read_b64_tr_b16 v[140:141], v26 offset:49152
    ds_read_b64_tr_b16 v[142:143], v26 offset:53248
    s_waitcnt lgkmcnt(14)
    v_mfma_f32_16x16x32_bf16 v[224:227], v[144:147], v[160:163], v[224:227]
    v_mfma_f32_16x16x32_bf16 v[228:231], v[144:147], v[164:167], v[228:231]
    ds_read_b64_tr_b16 v[144:145], v27 offset:49152
    ds_read_b64_tr_b16 v[146:147], v27 offset:53248
    s_waitcnt lgkmcnt(14)
    v_mfma_f32_16x16x32_bf16 v[236:239], v[148:151], v[164:167], v[236:239]
    v_mfma_f32_16x16x32_bf16 v[232:235], v[148:151], v[160:163], v[232:235]
    ds_read_b64_tr_b16 v[148:149], v28 offset:49152
    ds_read_b64_tr_b16 v[150:151], v28 offset:53248
    s_waitcnt lgkmcnt(14)
    v_mfma_f32_16x16x32_bf16 v[240:243], v[152:155], v[160:163], v[240:243]
    v_mfma_f32_16x16x32_bf16 v[244:247], v[152:155], v[164:167], v[244:247]
    ds_read_b64_tr_b16 v[152:153], v29 offset:49152
    ds_read_b64_tr_b16 v[154:155], v29 offset:53248
    s_waitcnt lgkmcnt(14)
    v_mfma_f32_16x16x32_bf16 v[252:255], v[156:159], v[164:167], v[252:255]
    v_mfma_f32_16x16x32_bf16 v[248:251], v[156:159], v[160:163], v[248:251]
    ds_read_b64_tr_b16 v[156:157], v30 offset:49152
    ds_read_b64_tr_b16 v[158:159], v30 offset:53248
    s_waitcnt vmcnt(9) lgkmcnt(14)
    v_mfma_f32_16x16x32_bf16 v[192:195], v[128:131], v[168:171], v[192:195]
    v_mfma_f32_16x16x32_bf16 v[196:199], v[128:131], v[172:175], v[196:199]
    s_waitcnt vmcnt(7) lgkmcnt(0)
    s_barrier
    v_mfma_f32_16x16x32_bf16 v[204:207], v[132:135], v[172:175], v[204:207]
    ds_read_b64_tr_b16 v[128:129], v36 offset:0
    ds_read_b64_tr_b16 v[130:131], v36 offset:4096
    v_lshlrev_b32 v5, 1, v3
    v_xor_b32 v5, v5, v4
    v_lshlrev_b32 v5, 4, v5
    v_mfma_f32_16x16x32_bf16 v[200:203], v[132:135], v[168:171], v[200:203]
    ds_read_b64_tr_b16 v[132:133], v37 offset:0
    ds_read_b64_tr_b16 v[134:135], v37 offset:4096
    v_lshl_add_u32 v5, v3, 12, v5
    v_xor_b32 v6, 0x80, v5
    s_lshl_b32 s16, s15, 6
    v_mfma_f32_16x16x32_bf16 v[208:211], v[136:139], v[168:171], v[208:211]
    s_lshl_b32 s17, s3, 3
    s_add_u32 s16, s16, s17
    s_lshl_b32 s16, s16, 12
    v_mfma_f32_16x16x32_bf16 v[212:215], v[136:139], v[172:175], v[212:215]
    ds_read_b64_tr_b16 v[136:137], v38 offset:0
    ds_read_b64_tr_b16 v[138:139], v38 offset:4096
    s_lshl_b32 s17, s9, 8
    s_add_u32 s16, s16, s17
    s_add_u32 s16, s16, 5242880
    v_mfma_f32_16x16x32_bf16 v[220:223], v[140:143], v[172:175], v[220:223]
    s_add_u32 s17, s16, 16384
    s_lshl_b32 s18, s3, 11
    s_add_u32 m0, s18, 98304
    v_mfma_f32_16x16x32_bf16 v[216:219], v[140:143], v[168:171], v[216:219]
    ds_read_b64_tr_b16 v[140:141], v39 offset:0
    ds_read_b64_tr_b16 v[142:143], v39 offset:4096
    s_nop 0
    buffer_load_dwordx4 v5, s[32:35], s16 offen sc1 lds
    s_add_u32 m0, s18, 99328
    v_mfma_f32_16x16x32_bf16 v[224:227], v[144:147], v[168:171], v[224:227]
    s_nop 0
    buffer_load_dwordx4 v6, s[32:35], s17 offen sc1 lds
    v_mfma_f32_16x16x32_bf16 v[228:231], v[144:147], v[172:175], v[228:231]
    ds_read_b64_tr_b16 v[144:145], v36 offset:16384
    ds_read_b64_tr_b16 v[146:147], v36 offset:20480
    v_lshlrev_b32 v31, 4, v2
    s_lshl_b32 s16, s3, 12
    v_mfma_f32_16x16x32_bf16 v[236:239], v[148:151], v[172:175], v[236:239]
    v_add_u32 v7, s16, v31
    v_add_u32 v8, 131072, v7
    v_mfma_f32_16x16x32_bf16 v[232:235], v[148:151], v[168:171], v[232:235]
    ds_read_b64_tr_b16 v[148:149], v37 offset:16384
    ds_read_b64_tr_b16 v[150:151], v37 offset:20480
    s_xor_b32 s16, s16, 16384
    v_add_u32 v15, s16, v31
    v_mfma_f32_16x16x32_bf16 v[240:243], v[152:155], v[168:171], v[240:243]
    v_add_u32 v9, 131072, v15
    s_lshl_b32 s16, s101, 3
    v_mfma_f32_16x16x32_bf16 v[244:247], v[152:155], v[172:175], v[244:247]
    ds_read_b64_tr_b16 v[152:153], v38 offset:16384
    ds_read_b64_tr_b16 v[154:155], v38 offset:20480
    s_add_u32 s16, s16, s3
    s_xor_b32 s17, s16, 8
    v_mfma_f32_16x16x32_bf16 v[252:255], v[156:159], v[172:175], v[252:255]
    s_lshl_b32 s68, s17, 11
    s_add_u32 s68, s68, 41943040
    v_mfma_f32_16x16x32_bf16 v[248:251], v[156:159], v[168:171], v[248:251]
    ds_read_b64_tr_b16 v[156:157], v39 offset:16384
    ds_read_b64_tr_b16 v[158:159], v39 offset:20480
    s_lshl_b32 s69, s16, 11
    s_add_u32 s69, s69, 41943040
    s_waitcnt vmcnt(7) lgkmcnt(14)
    v_mfma_f32_16x16x32_bf16 v[224:227], v[128:131], v[176:179], v[224:227]
    v_mfma_f32_16x16x32_bf16 v[228:231], v[128:131], v[180:183], v[228:231]
    ds_read_b64_tr_b16 v[128:129], v32 offset:0
    ds_read_b64_tr_b16 v[130:131], v32 offset:4096
    s_waitcnt lgkmcnt(14)
    v_mfma_f32_16x16x32_bf16 v[236:239], v[132:135], v[180:183], v[236:239]
    v_mfma_f32_16x16x32_bf16 v[232:235], v[132:135], v[176:179], v[232:235]
    ds_read_b64_tr_b16 v[132:133], v33 offset:0
    ds_read_b64_tr_b16 v[134:135], v33 offset:4096
    s_waitcnt lgkmcnt(14)
    v_mfma_f32_16x16x32_bf16 v[240:243], v[136:139], v[176:179], v[240:243]
    v_mfma_f32_16x16x32_bf16 v[244:247], v[136:139], v[180:183], v[244:247]
    ds_read_b64_tr_b16 v[136:137], v34 offset:0
    ds_read_b64_tr_b16 v[138:139], v34 offset:4096
    s_waitcnt lgkmcnt(14)
    v_mfma_f32_16x16x32_bf16 v[252:255], v[140:143], v[180:183], v[252:255]
    v_mfma_f32_16x16x32_bf16 v[248:251], v[140:143], v[176:179], v[248:251]
    ds_read_b64_tr_b16 v[140:141], v35 offset:0
    ds_read_b64_tr_b16 v[142:143], v35 offset:4096
    s_waitcnt vmcnt(2) lgkmcnt(14)
    v_mfma_f32_16x16x32_bf16 v[224:227], v[144:147], v[184:187], v[224:227]
    v_mfma_f32_16x16x32_bf16 v[228:231], v[144:147], v[188:191], v[228:231]
    ds_read_b64_tr_b16 v[144:145], v32 offset:16384
    ds_read_b64_tr_b16 v[146:147], v32 offset:20480
    s_waitcnt lgkmcnt(14)
    v_mfma_f32_16x16x32_bf16 v[236:239], v[148:151], v[188:191], v[236:239]
    v_mfma_f32_16x16x32_bf16 v[232:235], v[148:151], v[184:187], v[232:235]
    ds_read_b64_tr_b16 v[148:149], v33 offset:16384
    ds_read_b64_tr_b16 v[150:151], v33 offset:20480
    s_waitcnt lgkmcnt(14)
    v_mfma_f32_16x16x32_bf16 v[240:243], v[152:155], v[184:187], v[240:243]
    v_mfma_f32_16x16x32_bf16 v[244:247], v[152:155], v[188:191], v[244:247]
    ds_read_b64_tr_b16 v[152:153], v34 offset:16384
    ds_read_b64_tr_b16 v[154:155], v34 offset:20480
    s_waitcnt lgkmcnt(14)
    v_mfma_f32_16x16x32_bf16 v[252:255], v[156:159], v[188:191], v[252:255]
    v_mfma_f32_16x16x32_bf16 v[248:251], v[156:159], v[184:187], v[248:251]
    ds_read_b64_tr_b16 v[156:157], v35 offset:16384
    ds_read_b64_tr_b16 v[158:159], v35 offset:20480
    s_waitcnt lgkmcnt(14)
    v_mfma_f32_16x16x32_bf16 v[192:195], v[128:131], v[176:179], v[192:195]
    v_mfma_f32_16x16x32_bf16 v[196:199], v[128:131], v[180:183], v[196:199]
    s_nop 1
    ds_write_b128 v7, v[228:231] offset:0
    ds_write_b128 v7, v[236:239] offset:1024
    ds_write_b128 v7, v[244:247] offset:2048
    ds_write_b128 v7, v[252:255] offset:3072
    s_waitcnt lgkmcnt(15)
    v_mfma_f32_16x16x32_bf16 v[204:207], v[132:135], v[180:183], v[204:207]
    v_mfma_f32_16x16x32_bf16 v[200:203], v[132:135], v[176:179], v[200:203]
    s_waitcnt lgkmcnt(0)
    s_barrier
    ds_read_b128 v[64:67], v15 offset:0
    ds_read_b128 v[68:71], v15 offset:1024
    ds_read_b128 v[72:75], v15 offset:2048
    ds_read_b128 v[76:79], v15 offset:3072
    v_mfma_f32_16x16x32_bf16 v[208:211], v[136:139], v[176:179], v[208:211]
    v_mfma_f32_16x16x32_bf16 v[212:215], v[136:139], v[180:183], v[212:215]
    s_waitcnt lgkmcnt(0)
    v_mfma_f32_16x16x32_bf16 v[220:223], v[140:143], v[180:183], v[220:223]
    v_add_f32 v64, v64, v224
    v_add_f32 v65, v65, v225
    v_add_f32 v66, v66, v226
    v_add_f32 v67, v67, v227
    v_add_f32 v68, v68, v232
    v_add_f32 v69, v69, v233
    v_add_f32 v70, v70, v234
    v_add_f32 v71, v71, v235
    v_add_f32 v72, v72, v240
    v_add_f32 v73, v73, v241
    v_add_f32 v74, v74, v242
    v_add_f32 v75, v75, v243
    v_add_f32 v76, v76, v248
    v_add_f32 v77, v77, v249
    v_add_f32 v78, v78, v250
    v_add_f32 v79, v79, v251
    v_cvt_pk_bf16_f32 v48, v64, v65
    v_cvt_pk_bf16_f32 v49, v66, v67
    v_cvt_pk_bf16_f32 v50, v68, v69
    v_cvt_pk_bf16_f32 v51, v70, v71
    v_cvt_pk_bf16_f32 v52, v72, v73
    v_cvt_pk_bf16_f32 v53, v74, v75
    v_cvt_pk_bf16_f32 v54, v76, v77
    v_cvt_pk_bf16_f32 v55, v78, v79
    buffer_store_dwordx4 v[48:51], v31, s[32:35], s68 offen offset:0 sc1
    buffer_store_dwordx4 v[52:55], v31, s[32:35], s68 offen offset:1024 sc1
    v_mfma_f32_16x16x32_bf16 v[216:219], v[140:143], v[176:179], v[216:219]
    v_mfma_f32_16x16x32_bf16 v[192:195], v[144:147], v[184:187], v[192:195]
    v_mfma_f32_16x16x32_bf16 v[196:199], v[144:147], v[188:191], v[196:199]
    v_mfma_f32_16x16x32_bf16 v[204:207], v[148:151], v[188:191], v[204:207]
    v_mfma_f32_16x16x32_bf16 v[200:203], v[148:151], v[184:187], v[200:203]
    v_mfma_f32_16x16x32_bf16 v[208:211], v[152:155], v[184:187], v[208:211]
    v_mfma_f32_16x16x32_bf16 v[212:215], v[152:155], v[188:191], v[212:215]
    v_mfma_f32_16x16x32_bf16 v[220:223], v[156:159], v[188:191], v[220:223]
    v_mfma_f32_16x16x32_bf16 v[216:219], v[156:159], v[184:187], v[216:219]
    s_lshl_b32 s16, s12, 1
    s_add_u32 s16, s16, s11
    s_lshl_b32 s16, s16, 5
    v_xor_b32 v14, s16, v10
    v_add_u32 v14, 98304, v14
    v_lshrrev_b32 v11, 1, v4
    v_lshrrev_b32 v12, 1, v3
    v_xor_b32 v11, v11, v12
    v_lshlrev_b32 v11, 4, v11
    v_lshl_add_u32 v11, v4, 7, v11
    v_and_b32 v12, 1, v3
    v_lshl_add_u32 v11, v12, 3, v11
    s_lshl_b32 s16, s3, 11
    s_add_u32 s16, s16, 114688
    v_add_u32 v11, s16, v11
    v_add_u32 v13, s16, v31
    ds_write_b128 v8, v[196:199] offset:0
    ds_write_b128 v8, v[204:207] offset:1024
    ds_write_b128 v8, v[212:215] offset:2048
    ds_write_b128 v8, v[220:223] offset:3072
    s_lshl_b32 s70, s101, 7
    s_add_u32 s70, s70, 32669696
    s_xor_b32 s72, s70, 128
    v_mov_b32 v7, 0
    s_waitcnt vmcnt(0) lgkmcnt(0)
    s_barrier
    s_cmp_eq_u32 s3, 0
    s_cselect_b32 s70, s70, 0x20000000
    v_mov_b32 v16, 1
    v_mov_b32 v17, 0
    buffer_store_dword v16, v17, s[32:35], s70 offen sc1
    s_cmp_eq_u32 s3, 0
    s_cselect_b32 s72, s72, 0x20000000
    ds_read_b128 v[80:83], v9 offset:0
    ds_read_b128 v[84:87], v9 offset:1024
    ds_read_b128 v[88:91], v9 offset:2048
    ds_read_b128 v[92:95], v9 offset:3072
    v_xor_b32 v44, 0, v11
    v_xor_b32 v45, 32, v11
    v_xor_b32 v46, 64, v11
    v_xor_b32 v47, 96, v11
    ds_read_b64_tr_b16 v[48:49], v14 offset:0
    ds_read_b64_tr_b16 v[50:51], v14 offset:4096
    ds_read_b64_tr_b16 v[52:53], v14 offset:8192
    ds_read_b64_tr_b16 v[54:55], v14 offset:12288
    ds_read_b64 v[56:57], v44
    ds_read_b64 v[58:59], v45
    ds_read_b64 v[60:61], v46
    ds_read_b64 v[62:63], v47
    s_waitcnt lgkmcnt(8)
    v_pk_add_f32 v[80:81], v[80:81], v[192:193]
    v_pk_add_f32 v[82:83], v[82:83], v[194:195]
    v_pk_add_f32 v[84:85], v[84:85], v[200:201]
    v_pk_add_f32 v[86:87], v[86:87], v[202:203]
    v_pk_add_f32 v[88:89], v[88:89], v[208:209]
    v_pk_add_f32 v[90:91], v[90:91], v[210:211]
    v_pk_add_f32 v[92:93], v[92:93], v[216:217]
    v_pk_add_f32 v[94:95], v[94:95], v[218:219]
    s_waitcnt lgkmcnt(0)
    buffer_load_dword v6, v7, s[32:35], s72 offen sc1
    v_lshlrev_b32 v96, 16, v56
    v_and_b32 v97, 0xffff0000, v56
    v_lshlrev_b32 v98, 16, v57
    v_and_b32 v99, 0xffff0000, v57
    v_lshlrev_b32 v16, 16, v48
    v_and_b32 v17, 0xffff0000, v48
    v_lshlrev_b32 v18, 16, v49
    v_and_b32 v19, 0xffff0000, v49
    v_pk_add_f32 v[112:113], v[96:97], v[40:41] op_sel_hi:[1,0] neg_lo:[0,1] neg_hi:[0,1]
    v_pk_add_f32 v[114:115], v[98:99], v[40:41] op_sel_hi:[1,0] neg_lo:[0,1] neg_hi:[0,1]
    v_pk_mul_f32 v[16:17], v[16:17], v[40:41] op_sel:[0,1] op_sel_hi:[1,1]
    v_pk_mul_f32 v[18:19], v[18:19], v[40:41] op_sel:[0,1] op_sel_hi:[1,1]
    v_pk_mul_f32 v[112:113], v[112:113], v[16:17]
    v_pk_mul_f32 v[114:115], v[114:115], v[18:19]
    v_lshlrev_b32 v100, 16, v58
    v_and_b32 v101, 0xffff0000, v58
    v_lshlrev_b32 v102, 16, v59
    v_and_b32 v103, 0xffff0000, v59
    v_lshlrev_b32 v16, 16, v50
    v_and_b32 v17, 0xffff0000, v50
    v_lshlrev_b32 v18, 16, v51
    v_and_b32 v19, 0xffff0000, v51
    v_pk_add_f32 v[116:117], v[100:101], v[40:41] op_sel_hi:[1,0] neg_lo:[0,1] neg_hi:[0,1]
    v_pk_add_f32 v[118:119], v[102:103], v[40:41] op_sel_hi:[1,0] neg_lo:[0,1] neg_hi:[0,1]
    v_pk_mul_f32 v[16:17], v[16:17], v[40:41] op_sel:[0,1] op_sel_hi:[1,1]
    v_pk_mul_f32 v[18:19], v[18:19], v[40:41] op_sel:[0,1] op_sel_hi:[1,1]
    v_pk_mul_f32 v[116:117], v[116:117], v[16:17]
    v_pk_mul_f32 v[118:119], v[118:119], v[18:19]
    v_lshlrev_b32 v104, 16, v60
    v_and_b32 v105, 0xffff0000, v60
    v_lshlrev_b32 v106, 16, v61
    v_and_b32 v107, 0xffff0000, v61
    v_lshlrev_b32 v16, 16, v52
    v_and_b32 v17, 0xffff0000, v52
    v_lshlrev_b32 v18, 16, v53
    v_and_b32 v19, 0xffff0000, v53
    v_pk_add_f32 v[120:121], v[104:105], v[40:41] op_sel_hi:[1,0] neg_lo:[0,1] neg_hi:[0,1]
    v_pk_add_f32 v[122:123], v[106:107], v[40:41] op_sel_hi:[1,0] neg_lo:[0,1] neg_hi:[0,1]
    v_pk_mul_f32 v[16:17], v[16:17], v[40:41] op_sel:[0,1] op_sel_hi:[1,1]
    v_pk_mul_f32 v[18:19], v[18:19], v[40:41] op_sel:[0,1] op_sel_hi:[1,1]
    v_pk_mul_f32 v[120:121], v[120:121], v[16:17]
    v_pk_mul_f32 v[122:123], v[122:123], v[18:19]
    v_lshlrev_b32 v108, 16, v62
    v_and_b32 v109, 0xffff0000, v62
    v_lshlrev_b32 v110, 16, v63
    v_and_b32 v111, 0xffff0000, v63
    v_lshlrev_b32 v16, 16, v54
    v_and_b32 v17, 0xffff0000, v54
    v_lshlrev_b32 v18, 16, v55
    v_and_b32 v19, 0xffff0000, v55
    v_pk_add_f32 v[124:125], v[108:109], v[40:41] op_sel_hi:[1,0] neg_lo:[0,1] neg_hi:[0,1]
    v_pk_add_f32 v[126:127], v[110:111], v[40:41] op_sel_hi:[1,0] neg_lo:[0,1] neg_hi:[0,1]
    v_pk_mul_f32 v[16:17], v[16:17], v[40:41] op_sel:[0,1] op_sel_hi:[1,1]
    v_pk_mul_f32 v[18:19], v[18:19], v[40:41] op_sel:[0,1] op_sel_hi:[1,1]
    v_pk_mul_f32 v[124:125], v[124:125], v[16:17]
    v_pk_mul_f32 v[126:127], v[126:127], v[18:19]
    s_waitcnt vmcnt(0)
    v_cmp_ne_u32 vcc, 1, v6
    s_cmp_eq_u32 s3, 0
    s_cselect_b64 s[18:19], vcc, 0
    s_cmp_lg_u64 s[18:19], 0
    s_cbranch_scc1 L_xsl
L_xok:
    s_barrier
    buffer_load_dwordx4 v[176:179], v31, s[32:35], s69 offen offset:0 sc1
    buffer_load_dwordx4 v[180:183], v31, s[32:35], s69 offen offset:1024 sc1
    s_mov_b32 s16, 0xbfb8aa3b
    s_mov_b32 s17, 0xbfb8aa3b
    s_waitcnt vmcnt(1)
    v_lshlrev_b32 v64, 16, v176
    v_and_b32 v65, 0xffff0000, v176
    v_lshlrev_b32 v66, 16, v177
    v_and_b32 v67, 0xffff0000, v177
    v_pk_add_f32 v[80:81], v[80:81], v[64:65]
    v_pk_add_f32 v[82:83], v[82:83], v[66:67]
    v_pk_mul_f32 v[128:129], v[80:81], s[16:17]
    v_pk_mul_f32 v[130:131], v[82:83], s[16:17]
    v_pk_mul_f32 v[112:113], v[112:113], v[80:81]
    v_exp_f32 v128, v128
    v_exp_f32 v129, v129
    v_exp_f32 v130, v130
    v_exp_f32 v131, v131
    v_pk_mul_f32 v[114:115], v[114:115], v[82:83]
    v_pk_add_f32 v[128:129], v[128:129], 1.0 op_sel_hi:[1,0]
    v_pk_add_f32 v[130:131], v[130:131], 1.0 op_sel_hi:[1,0]
    v_rcp_f32 v128, v128
    v_rcp_f32 v129, v129
    v_rcp_f32 v130, v130
    v_rcp_f32 v131, v131
    s_nop 0
    v_pk_fma_f32 v[96:97], v[112:113], v[128:129], v[96:97]
    v_pk_fma_f32 v[98:99], v[114:115], v[130:131], v[98:99]
    v_cvt_pk_bf16_f32 v144, v96, v97
    v_cvt_pk_bf16_f32 v145, v98, v99
    ds_write_b64 v44, v[144:145]
    s_waitcnt vmcnt(1)
    v_lshlrev_b32 v68, 16, v178
    v_and_b32 v69, 0xffff0000, v178
    v_lshlrev_b32 v70, 16, v179
    v_and_b32 v71, 0xffff0000, v179
    v_pk_add_f32 v[84:85], v[84:85], v[68:69]
    v_pk_add_f32 v[86:87], v[86:87], v[70:71]
    v_pk_mul_f32 v[132:133], v[84:85], s[16:17]
    v_pk_mul_f32 v[134:135], v[86:87], s[16:17]
    v_pk_mul_f32 v[116:117], v[116:117], v[84:85]
    v_exp_f32 v132, v132
    v_exp_f32 v133, v133
    v_exp_f32 v134, v134
    v_exp_f32 v135, v135
    v_pk_mul_f32 v[118:119], v[118:119], v[86:87]
    v_pk_add_f32 v[132:133], v[132:133], 1.0 op_sel_hi:[1,0]
    v_pk_add_f32 v[134:135], v[134:135], 1.0 op_sel_hi:[1,0]
    v_rcp_f32 v132, v132
    v_rcp_f32 v133, v133
    v_rcp_f32 v134, v134
    v_rcp_f32 v135, v135
    s_nop 0
    v_pk_fma_f32 v[100:101], v[116:117], v[132:133], v[100:101]
    v_pk_fma_f32 v[102:103], v[118:119], v[134:135], v[102:103]
    v_cvt_pk_bf16_f32 v146, v100, v101
    v_cvt_pk_bf16_f32 v147, v102, v103
    ds_write_b64 v45, v[146:147]
    s_waitcnt vmcnt(0)
    v_lshlrev_b32 v72, 16, v180
    v_and_b32 v73, 0xffff0000, v180
    v_lshlrev_b32 v74, 16, v181
    v_and_b32 v75, 0xffff0000, v181
    v_pk_add_f32 v[88:89], v[88:89], v[72:73]
    v_pk_add_f32 v[90:91], v[90:91], v[74:75]
    v_pk_mul_f32 v[136:137], v[88:89], s[16:17]
    v_pk_mul_f32 v[138:139], v[90:91], s[16:17]
    v_pk_mul_f32 v[120:121], v[120:121], v[88:89]
    v_exp_f32 v136, v136
    v_exp_f32 v137, v137
    v_exp_f32 v138, v138
    v_exp_f32 v139, v139
    v_pk_mul_f32 v[122:123], v[122:123], v[90:91]
    v_pk_add_f32 v[136:137], v[136:137], 1.0 op_sel_hi:[1,0]
    v_pk_add_f32 v[138:139], v[138:139], 1.0 op_sel_hi:[1,0]
    v_rcp_f32 v136, v136
    v_rcp_f32 v137, v137
    v_rcp_f32 v138, v138
    v_rcp_f32 v139, v139
    s_nop 0
    v_pk_fma_f32 v[104:105], v[120:121], v[136:137], v[104:105]
    v_pk_fma_f32 v[106:107], v[122:123], v[138:139], v[106:107]
    v_cvt_pk_bf16_f32 v148, v104, v105
    v_cvt_pk_bf16_f32 v149, v106, v107
    ds_write_b64 v46, v[148:149]
    s_waitcnt vmcnt(0)
    v_lshlrev_b32 v76, 16, v182
    v_and_b32 v77, 0xffff0000, v182
    v_lshlrev_b32 v78, 16, v183
    v_and_b32 v79, 0xffff0000, v183
    v_pk_add_f32 v[92:93], v[92:93], v[76:77]
    v_pk_add_f32 v[94:95], v[94:95], v[78:79]
    v_pk_mul_f32 v[140:141], v[92:93], s[16:17]
    v_pk_mul_f32 v[142:143], v[94:95], s[16:17]
    v_pk_mul_f32 v[124:125], v[124:125], v[92:93]
    v_exp_f32 v140, v140
    v_exp_f32 v141, v141
    v_exp_f32 v142, v142
    v_exp_f32 v143, v143
    v_pk_mul_f32 v[126:127], v[126:127], v[94:95]
    v_pk_add_f32 v[140:141], v[140:141], 1.0 op_sel_hi:[1,0]
    v_pk_add_f32 v[142:143], v[142:143], 1.0 op_sel_hi:[1,0]
    v_rcp_f32 v140, v140
    v_rcp_f32 v141, v141
    v_rcp_f32 v142, v142
    v_rcp_f32 v143, v143
    s_nop 0
    v_pk_fma_f32 v[108:109], v[124:125], v[140:141], v[108:109]
    v_pk_fma_f32 v[110:111], v[126:127], v[142:143], v[110:111]
    v_cvt_pk_bf16_f32 v150, v108, v109
    v_cvt_pk_bf16_f32 v151, v110, v111
    ds_write_b64 v47, v[150:151]
    s_waitcnt lgkmcnt(0)
    ds_read_b128 v[152:155], v13
    ds_read_b128 v[156:159], v13 offset:1024
    s_waitcnt lgkmcnt(1)
    buffer_store_dwordx4 v[152:155], v42, s[4:7], s64 offen sc1
    s_waitcnt lgkmcnt(0)
    buffer_store_dwordx4 v[156:159], v43, s[4:7], s65 offen sc1
L_fin:
L_end:
    s_endpgm
L_hzsl:
    s_mov_b32 s19, 0
L_hzsp:
    s_add_u32 s19, s19, 1
    s_cmp_ge_u32 s19, 0x20000
    s_cbranch_scc1 L_hzok
    s_sleep 32
    buffer_load_dword v253, v252, s[36:39], 0 offen sc1
    s_waitcnt vmcnt(0)
    v_cmp_gt_u32 vcc, 32, v253
    s_nop 1
    s_cmp_eq_u64 vcc, 0
    s_cbranch_scc0 L_hzsp
    s_branch L_hzok
L_ok2hsl:
    s_mov_b32 s19, 0
L_ok2hsp:
    s_add_u32 s19, s19, 1
    s_cmp_ge_u32 s19, 0x20000
    s_cbranch_scc1 L_ok2hok
    s_sleep 48
    buffer_load_dword v7, v6, s[32:35], s72 offen sc1
    s_waitcnt vmcnt(0)
    v_cmp_ne_u32 vcc, 1, v7
    s_nop 1
    s_cmp_eq_u64 vcc, 0
    s_cbranch_scc0 L_ok2hsp
    s_branch L_ok2hok
L_dsl:
    s_mov_b32 s19, 0
L_dsp:
    s_add_u32 s19, s19, 1
    s_cmp_ge_u32 s19, 0x20000
    s_cbranch_scc1 L_dok
    s_sleep 4
    buffer_load_dword v6, v5, s[32:35], s72 offen sc1
    s_waitcnt vmcnt(0)
    v_cmp_ne_u32 vcc, 1, v6
    s_nop 1
    s_cmp_eq_u64 vcc, 0
    s_cbranch_scc0 L_dsp
    s_branch L_dok
L_zzsl:
    s_mov_b32 s19, 0
L_zzsp:
    s_add_u32 s19, s19, 1
    s_cmp_ge_u32 s19, 0x20000
    s_cbranch_scc1 L_zzok
    s_sleep 32
    buffer_load_dword v6, v5, s[32:35], s72 offen sc1
    s_waitcnt vmcnt(0)
    v_cmp_ne_u32 vcc, 1, v6
    s_nop 1
    s_cmp_eq_u64 vcc, 0
    s_cbranch_scc0 L_zzsp
    s_branch L_zzok
L_xsl:
    s_mov_b32 s19, 0
L_xsp:
    s_add_u32 s19, s19, 1
    s_cmp_ge_u32 s19, 0x20000
    s_cbranch_scc1 L_xok
    s_sleep 1
    buffer_load_dword v6, v7, s[32:35], s72 offen sc1
    s_waitcnt vmcnt(0)
    v_cmp_ne_u32 vcc, 1, v6
    s_nop 1
    s_cmp_eq_u64 vcc, 0
    s_cbranch_scc0 L_xsp
    s_branch L_xok
.section .rodata,"a"
.p2align 6
.amdhsa_kernel recurrent_scan__ssm_conv_h3__geglu_ffn__prompt_kernel
  .amdhsa_next_free_vgpr 256
  .amdhsa_next_free_sgpr 102
  .amdhsa_accum_offset 256
  .amdhsa_group_segment_fixed_size 0
  .amdhsa_kernarg_size 104
  .amdhsa_user_sgpr_count 2
  .amdhsa_user_sgpr_kernarg_segment_ptr 1
  .amdhsa_system_sgpr_workgroup_id_x 1
  .amdhsa_float_denorm_mode_32 3
.end_amdhsa_kernel
```
